```python
import torch

def _softmax(x, axis=-1):
    return torch.softmax(x, dim=axis)
def _gelu(x):
    return torch.nn.functional.gelu(x, approximate="tanh")
def _silu(x):
    return torch.nn.functional.silu(x)
def _sigmoid(x):
    return torch.sigmoid(x)
def _layernorm(x, axis=-1, eps=1e-5):
    m = x.mean(dim=axis, keepdim=True)
    v = x.var(dim=axis, keepdim=True, unbiased=False)
    return (x - m) / torch.sqrt(v + eps)
def _scatter_add(tgt, idx, src, axis=0):
    return tgt.clone().index_add_(axis, idx, src)
def _segment_sum(src, seg, n):
    out = torch.zeros((n,) + src.shape[1:], dtype=src.dtype)
    return out.index_add_(0, seg, src)
def _pad(x, pw):
    flat = tuple(v for pair in reversed(pw) for v in pair)
    return torch.nn.functional.pad(x, flat)

kernel_name = 'recurrent_scan__mha_block__moe_arch_mod__prompt'

def setup_inputs():

    _w = (lambda a: (lambda t: t.to(torch.bfloat16) if t.is_floating_point() else t)(torch.as_tensor(a)))
    def _A_setup():
        B, S, D, H = 1, 2048, 448, 16
        return {
            "x": _w((lambda *s: torch.randn(*s, dtype=torch.bfloat16) * 0.05)(B, S, D)),
            "wqkv": _w((lambda *s: torch.randn(*s, dtype=torch.bfloat16) * 0.05)(D, 3 * D)),
            "wo": _w((lambda *s: torch.randn(*s, dtype=torch.bfloat16) * 0.05)(D, D)),
        }
    _A_in = _A_setup()

    def _B_setup():
        B, S, D, F, C = 1, 2048, 448, 1792, 2
        return {
            "x": _w((lambda *s: torch.randn(*s, dtype=torch.bfloat16) * 0.05)(B, S, D)),
            "w_r": _w((lambda *s: torch.randn(*s, dtype=torch.bfloat16) * 0.05)(D)),
            "w_gate": _w((lambda *s: torch.randn(*s, dtype=torch.bfloat16) * 0.05)(D, F)),
            "w_up": _w((lambda *s: torch.randn(*s, dtype=torch.bfloat16) * 0.05)(D, F)),
            "w_down": _w((lambda *s: torch.randn(*s, dtype=torch.bfloat16) * 0.05)(F, D)),
        }
    _B_in = _B_setup()

    return {
        "A_x": _A_in["x"],
        "A_wqkv": _A_in["wqkv"],
        "A_wo": _A_in["wo"],
        "B_x": _B_in["x"],
        "B_w_r": _B_in["w_r"],
        "B_w_gate": _B_in["w_gate"],
        "B_w_up": _B_in["w_up"],
        "B_w_down": _B_in["w_down"],
    }

def reference(A_x, A_wqkv, A_wo, B_x, B_w_r, B_w_gate, B_w_up, B_w_down):
    def _A_ref(x, wqkv, wo):
        B, S, D = x.shape
        H = 16
        Dh = D // H
        qkv = (lambda x, *d: x.permute(*d))((x @ wqkv).reshape(B, S, 3, H, Dh), 2, 0, 3, 1, 4)
        q, k, v = qkv[0], qkv[1], qkv[2]
        scores = torch.einsum("bhqd,bhkd->bhqk", q, k) * (Dh ** -0.5)
        p = _softmax(scores, axis=-1)
        o = torch.einsum("bhqk,bhkd->bhqd", p, v)
        return (lambda x, *d: x.permute(*d))(o, 0, 2, 1, 3).reshape(B, S, D) @ wo

    def _B_ref(x, w_r, w_gate, w_up, w_down):
        B, S, D = x.shape
        C = 2
        r = x @ w_r
        idx = torch.argsort(-r, axis=-1)[:, :C]
        idx_e = (lambda x, n, axis: torch.repeat_interleave(x, n, dim=axis))(idx.reshape(B, C, 1), D, axis=2)
        x_sel = (lambda x, i, axis: torch.take_along_dim(x, i, dim=axis))(x, idx_e, axis=1)
        g = _silu(x_sel @ w_gate)
        u = x_sel @ w_up
        y = (g * u) @ w_down
        r_sel = _sigmoid((lambda x, i, axis: torch.take_along_dim(x, i, dim=axis))(r, idx, axis=1))
        y = y * r_sel.reshape(B, C, 1)
        b_off = (torch.arange(B) * S).reshape(B, 1)
        flat_idx = (idx + b_off).reshape(B * C)
        zero = (x * 0.0).reshape(B * S, D)
        upd = _scatter_add(zero, flat_idx, y.reshape(B * C, D), axis=0)
        return x + upd.reshape(B, S, D)

    x = A_x
    xn = _layernorm(x, axis=-1)
    s = _A_ref(xn, A_wqkv, A_wo)
    g = _silu(_B_ref(xn, B_w_r, B_w_gate, B_w_up, B_w_down))
    return x + s * g
```

```asm
; @launch grid=(256,1,1) block=(256,1,1) lds=163840
.amdgcn_target "amdgcn-amd-amdhsa--gfx950"
.text
.globl recurrent_scan__mha_block__moe_arch_mod__prompt_kernel
.p2align 12
.p2align 8
.type recurrent_scan__mha_block__moe_arch_mod__prompt_kernel,@function
recurrent_scan__mha_block__moe_arch_mod__prompt_kernel:
    s_cmp_ge_u32 s2, 256
    s_cbranch_scc1 L_end
    s_load_dwordx2 s[28:29], s[0:1], 0
    s_load_dwordx2 s[32:33], s[0:1], 8
    s_load_dwordx2 s[36:37], s[0:1], 80
    s_load_dwordx2 s[40:41], s[0:1], 32
    s_getpc_b64 s[26:27]
L_pc:
    s_lshr_b32 s5, s2, 3
    v_lshrrev_b32 v10, 6, v0
    v_and_b32 v1, 63, v0
    v_readfirstlane_b32 s3, v10
    v_lshl_add_u32 v10, s5, 2, v10
    v_and_b32 v11, 3, v0
    v_lshl_add_u32 v10, v10, 2, v11
    v_lshlrev_b32 v10, 7, v10
    v_min_u32 v10, L_tabend - L_pc - 4, v10
    global_load_dword a0, v10, s[26:27]
    s_load_dwordx2 s[44:45], s[0:1], 72
    s_load_dwordx2 s[52:53], s[0:1], 16
    s_load_dwordx2 s[56:57], s[0:1], 40
    s_load_dwordx2 s[60:61], s[0:1], 48
    s_load_dwordx2 s[64:65], s[0:1], 56
    s_load_dwordx2 s[48:49], s[0:1], 64
    s_and_b32 s4, s2, 7
    s_and_b32 s6, s5, 1
    s_lshr_b32 s7, s5, 1
    s_mul_i32 s11, s6, 0
    s_add_u32 s11, s11, s7
    s_add_u32 s11, s11, 0
    s_mul_i32 s12, s11, 37
    s_lshr_b32 s12, s12, 8
    s_mul_i32 s12, s12, 7
    s_sub_u32 s76, s11, s12
    v_lshrrev_b32 v10, 3, v1
    v_and_b32 v11, 7, v1
    v_lshrrev_b32 v12, 4, v1
    v_xor_b32 v13, v11, v12
    v_mul_u32_u24 v3, 896, v10
    v_lshl_add_u32 v3, v13, 4, v3
    v_xor_b32 v4, 64, v3
    v_add_u32 v4, 6144, v4
    v_add_u32 v5, 12288, v3
    v_add_u32 v6, 12288, v4
    v_and_b32 v12, 1, v12
    v_lshlrev_b32 v12, 2, v12
    v_xor_b32 v12, v11, v12
    v_mul_u32_u24 v7, 2688, v10
    v_lshl_add_u32 v7, v12, 4, v7
    v_lshlrev_b32 v2, 4, v1
    s_mov_b32 s30, 1835008
    s_mov_b32 s31, 0x20000
    s_mov_b32 s34, 1204224
    s_mov_b32 s35, 0x20000
    s_mov_b32 s38, 16777216
    s_mov_b32 s39, 0x20000
    s_cmp_eq_u32 s6, 0
    s_cselect_b32 s42, 896, 0
    s_mov_b32 s43, 0x20000
    s_mov_b32 s18, 0xF7F77F7F
    s_mov_b32 s19, s18
    s_lshl2_add_u32 s13, s7, s3
    s_mul_i32 s11, s13, 28672
    s_lshl_b32 s12, s76, 7
    s_add_u32 s68, s11, s12
    s_mul_i32 s11, s4, 112
    s_lshl2_add_u32 s12, s76, s3
    s_mul_i32 s12, s12, 43008
    s_add_u32 s11, s11, s12
    s_mul_i32 s12, s6, 48
    s_add_u32 s9, s11, s12
    s_mul_i32 s12, s6, 848
    s_add_u32 s12, s12, 896
    v_add_u32 v7, s12, v7
    v_add_u32 v8, 20480, v7
    s_mul_i32 s17, s3, 24576
    s_add_u32 s17, s17, 57344
    s_lshl_b32 s80, s3, 11
    s_or_b32 s86, s5, s3
    s_lshl_b32 s25, s4, 12
    s_add_u32 s25, s25, 12582912
    s_lshl_b32 s11, s76, 6
    v_add_u32 v24, s11, v0
    v_add_u32 v25, 192, v24
    v_subrev_u32 v12, 448, v24
    v_subrev_u32 v13, 448, v25
    v_min_u32 v24, v24, v12
    v_min_u32 v25, v25, v13
    v_lshlrev_b32 v24, 1, v24
    v_lshlrev_b32 v25, 1, v25
    v_and_b32 v21, 2, v0
    v_lshlrev_b32 v21, 5, v21
    v_xor_b32 v21, 112, v21
    v_lshl_add_u32 v21, v0, 7, v21
    s_sub_u32 s78, s68, 896
    s_sub_u32 s79, s9, 1204224
    s_cmp_ge_u32 s76, 6
    s_cselect_b32 s69, s78, s68
    s_cselect_b32 s15, s79, s9
    s_add_u32 s69, s69, 128
    s_add_u32 s15, s15, 172032
    s_waitcnt lgkmcnt(0)
    s_add_u32 m0, s17, 0
    s_nop 0
    buffer_load_dwordx4 v3, s[28:31], s68 offen offset:0 lds
    buffer_load_dwordx4 v4, s[28:31], s68 offen offset:1024 lds
    buffer_load_dwordx4 v5, s[28:31], s68 offen offset:2048 lds
    buffer_load_dwordx4 v6, s[28:31], s68 offen offset:3072 lds
    buffer_load_ushort v250, v24, s[40:43], 0 offen
    buffer_load_ushort v254, v25, s[40:43], 0 offen
    s_add_u32 m0, s80, 0
    s_mov_b64 exec, s[18:19]
    buffer_load_dwordx4 v7, s[32:35], s9 offen lds
    buffer_load_dwordx4 v8, s[32:35], s9 offen offset:1024 lds
    s_mov_b64 exec, -1
    s_lshl2_add_u32 s11, s2, s3
    s_mul_i32 s11, s11, 1792
    v_lshlrev_b32 v22, 7, v1
    s_mov_b64 exec, 0x3fff
    buffer_load_dword a2, v22, s[28:31], s11 offen
    s_mov_b64 exec, -1
    s_add_u32 m0, s17, 4096
    s_nop 0
    buffer_load_dwordx4 v3, s[28:31], s69 offen offset:0 lds
    buffer_load_dwordx4 v4, s[28:31], s69 offen offset:1024 lds
    buffer_load_dwordx4 v5, s[28:31], s69 offen offset:2048 lds
    buffer_load_dwordx4 v6, s[28:31], s69 offen offset:3072 lds
    v_and_b32 v26, 31, v1
    v_lshrrev_b32 v15, 5, v1
    v_bfe_u32 v16, v1, 1, 3
    v_xor_b32 v16, v16, v15
    v_lshlrev_b32 v16, 4, v16
    v_lshl_add_u32 v16, v26, 7, v16
    v_add_u32 v10, s17, v16
    v_xor_b32 v11, 32, v10
    v_xor_b32 v12, 64, v10
    v_xor_b32 v13, 96, v10
    s_lshl_b32 s14, s3, 2
    s_add_u32 s14, s14, 156160
    v_lshl_add_u32 v23, v26, 4, s14
    v_bfe_u32 v16, v1, 2, 2
    v_lshl_add_u32 v16, v15, 3, v16
    v_bfe_u32 v17, v1, 4, 1
    v_and_b32 v18, 3, v1
    v_lshl_add_u32 v17, v17, 2, v18
    v_lshlrev_b32 v17, 3, v17
    s_lshl_b32 s14, s6, 3
    v_add_u32 v18, s14, v17
    v_and_b32 v18, 63, v18
    v_lshl_add_u32 v18, v16, 6, v18
    v_add_u32 v20, s17, v18
    v_add_u32 v18, 73728, v18
    v_add_u32 v19, 49152, v18
    v_add_u32 v15, 56, v17
    v_cmp_eq_u32 vcc, 56, v17
    v_mov_b32 v14, 120
    v_and_b32 v27, 8, v1
    v_cndmask_b32 v14, v17, v14, vcc
    v_lshlrev_b32 v27, 3, v27
    v_lshl_add_u32 v27, v16, 7, v27
    v_xor_b32 v14, v14, v27
    v_xor_b32 v15, v15, v27
    v_add_u32 v16, s80, v14
    v_add_u32 v17, s80, v15
    v_mov_b32 v248, 0
    v_mov_b32 v249, 0
    v_mov_b32 v251, 0
    v_mov_b32 v252, 0
    v_mov_b32 v253, 0
    v_mov_b32 v255, 0
    s_mov_b32 s22, 0x3f803f80
    v_lshrrev_b32 v26, 2, v1
    v_xor_b32 v27, v26, v1
    v_and_b32 v27, 4, v27
    v_cmp_eq_u32 vcc, 0, v27
    v_mov_b32 v27, s22
    v_mov_b32 v60, 0
    v_cndmask_b32 v44, 0, v27, vcc
    v_cndmask_b32 v45, 0, v27, vcc
    v_cndmask_b32 v46, 0, v27, vcc
    v_cndmask_b32 v47, 0, v27, vcc
    v_mov_b32 v61, 0
    v_mov_b32 v62, 0
    v_mov_b32 v63, 0
    s_cmp_ge_u32 s76, 5
    s_cselect_b32 s71, s78, s68
    s_cselect_b32 s16, s79, s9
    s_add_u32 s71, s71, 256
    s_add_u32 s16, s16, 344064
    s_cmp_ge_u32 s76, 4
    s_cselect_b32 s72, s78, s68
    s_cselect_b32 s26, s79, s9
    s_add_u32 s72, s72, 384
    s_add_u32 s26, s26, 516096
    s_cmp_ge_u32 s76, 3
    s_cselect_b32 s73, s78, s68
    s_cselect_b32 s27, s79, s9
    s_add_u32 s73, s73, 512
    s_add_u32 s27, s27, 688128
    s_cmp_ge_u32 s76, 2
    s_cselect_b32 s74, s78, s68
    s_cselect_b32 s84, s79, s9
    s_add_u32 s74, s74, 640
    s_add_u32 s84, s84, 860160
    s_cmp_ge_u32 s76, 1
    s_cselect_b32 s75, s78, s68
    s_cselect_b32 s87, s79, s9
    s_add_u32 s75, s75, 768
    s_add_u32 s87, s87, 1032192
    v_lshlrev_b32 v31, 2, v1
    v_and_b32 v27, 3, v1
    v_mul_u32_u24 v9, 2688, v26
    v_lshl_add_u32 v9, v27, 4, v9
    v_cmp_eq_u32 vcc, 0, v1
    v_mov_b32 v29, 1073741824
    s_getreg_b32 s10, hwreg(HW_REG_XCC_ID, 0, 4)
    v_cndmask_b32 v29, v29, 0, vcc
    s_add_u32 s10, s10, 1
    s_lshl1_add_u32 s8, s4, s6
    s_mov_b32 s46, 256
    s_mov_b32 s47, 0x20000
    s_mov_b32 s20, -1
    s_mov_b32 s21, 0
    s_mov_b32 s81, 0xffff0000
    s_lshl_b32 s23, s4, 19
    s_lshl_b32 s14, s13, 12
    s_add_u32 s23, s23, s14
    s_lshl_b32 s14, s6, 11
    s_add_u32 s23, s23, s14
    s_add_u32 s24, s23, 0x40000
    v_mov_b32 v50, 0
    v_mov_b32 v51, 0
    v_mov_b32 v54, 0
    v_mov_b32 v55, 0
    v_mov_b32 v58, 0
    v_mov_b32 v59, 0
    s_mul_i32 s11, s5, 37
    s_lshr_b32 s11, s11, 8
    s_mul_i32 s12, s11, 7
    s_sub_u32 s40, s5, s12
    s_and_b32 s12, s11, 1
    s_lshr_b32 s11, s11, 1
    s_lshl1_add_u32 s11, s4, s11
    s_lshl3_add_u32 s41, s11, s12
    s_lshl_b32 s93, s40, 7
    s_mul_i32 s11, s41, 14336
    s_add_u32 s85, s11, s93
    s_lshl2_add_u32 s96, s8, s3
    s_lshl_b32 s88, s96, 16
    s_add_u32 s12, s88, 4096
    s_add_u32 s42, s36, s12
    s_addc_u32 s43, s37, 0
    s_lshl_b32 s98, s4, 13
    s_add_u32 s98, s98, 4194304
    s_lshl_b32 s11, s13, 7
    s_add_u32 s100, s11, s98
    s_cmp_eq_u32 s6, 0
    s_cselect_b32 s100, s100, 1073741824
    s_lshl4_add_u32 s99, s13, s25
    v_add_u32 v28, s17, v2
    v_and_b32 v26, -16, v23
    v_and_b32 v24, 31, v1
    v_cmp_eq_u32 vcc, 28, v24
    v_mov_b32 v30, 0x3f80
    v_and_b32 v27, 124, v31
    v_cndmask_b32 v30, 0, v30, vcc
    v_mov_b32 v52, s22
    v_mov_b32 v53, s22
    s_mov_b64 exec, 0
    s_cmp_eq_u32 s3, 0
    s_cbranch_scc1 L_tch0
    s_cmp_eq_u32 s3, 1
    s_cbranch_scc1 L_tch1
    s_cmp_eq_u32 s3, 2
    s_cbranch_scc1 L_tch2
    s_branch L_tch3
L_tch_ret:
    s_mov_b64 exec, -1
    s_add_u32 m0, s80, 8192
    s_mov_b64 exec, s[18:19]
    buffer_load_dwordx4 v7, s[32:35], s15 offen lds
    buffer_load_dwordx4 v8, s[32:35], s15 offen offset:1024 lds
    s_mov_b64 exec, -1
    s_cmp_eq_u32 s86, 0
    s_cbranch_scc1 L_clrF
L_clrF_ret:
    s_cmp_eq_u32 s6, 0
    s_cbranch_scc0 L_typeV
    s_waitcnt vmcnt(11)
    ds_read_b128 v[128:131], v10 offset:0
    ds_read_b128 v[132:135], v11 offset:0
    ds_read_b128 v[136:139], v12 offset:0
    ds_read_b128 v[140:143], v13 offset:0
    s_waitcnt vmcnt(9)
    ds_write_b128 v21, v[248:251]
    ds_write_b128 v21, v[252:255] offset:24576
    s_waitcnt lgkmcnt(2)
    v_dot2c_f32_bf16 v61, v128, v128
    v_dot2c_f32_bf16 v60, s22, v128
    v_dot2c_f32_bf16 v63, v129, v129
    v_dot2c_f32_bf16 v62, s22, v129
    v_dot2c_f32_bf16 v61, v130, v130
    v_dot2c_f32_bf16 v60, s22, v130
    v_dot2c_f32_bf16 v63, v131, v131
    v_dot2c_f32_bf16 v62, s22, v131
    v_dot2c_f32_bf16 v61, v132, v132
    v_dot2c_f32_bf16 v60, s22, v132
    v_dot2c_f32_bf16 v63, v133, v133
    v_dot2c_f32_bf16 v62, s22, v133
    v_dot2c_f32_bf16 v61, v134, v134
    v_dot2c_f32_bf16 v60, s22, v134
    v_dot2c_f32_bf16 v63, v135, v135
    v_dot2c_f32_bf16 v62, s22, v135
    v_dot2c_f32_bf16 v61, v136, v136
    v_dot2c_f32_bf16 v60, s22, v136
    v_dot2c_f32_bf16 v63, v137, v137
    v_dot2c_f32_bf16 v62, s22, v137
    v_dot2c_f32_bf16 v61, v138, v138
    v_dot2c_f32_bf16 v60, s22, v138
    v_dot2c_f32_bf16 v63, v139, v139
    v_dot2c_f32_bf16 v62, s22, v139
    v_dot2c_f32_bf16 v61, v140, v140
    v_dot2c_f32_bf16 v60, s22, v140
    v_dot2c_f32_bf16 v63, v141, v141
    v_dot2c_f32_bf16 v62, s22, v141
    v_dot2c_f32_bf16 v61, v142, v142
    v_dot2c_f32_bf16 v60, s22, v142
    v_dot2c_f32_bf16 v63, v143, v143
    v_dot2c_f32_bf16 v62, s22, v143
    s_waitcnt vmcnt(7) lgkmcnt(0)
    s_barrier
    ds_read_b64_tr_b16 a[224:225], v16 offset:0
    ds_read_b64_tr_b16 a[226:227], v16 offset:512
    ds_read_b64_tr_b16 a[228:229], v17 offset:0
    ds_read_b64_tr_b16 a[230:231], v17 offset:512
    ds_read_b64_tr_b16 a[192:193], v14 offset:0
    ds_read_b64_tr_b16 a[194:195], v14 offset:512
    ds_read_b64_tr_b16 a[196:197], v15 offset:0
    ds_read_b64_tr_b16 a[198:199], v15 offset:512
    ds_read_b64_tr_b16 a[200:201], v14 offset:2048
    ds_read_b64_tr_b16 a[202:203], v14 offset:2560
    ds_read_b64_tr_b16 a[204:205], v15 offset:2048
    ds_read_b64_tr_b16 a[206:207], v15 offset:2560
    s_waitcnt lgkmcnt(8)
    v_mfma_f32_16x16x32_bf16 v[32:35], v[44:47], a[224:227], 0
    s_add_u32 m0, s17, 8192
    v_mfma_f32_16x16x32_bf16 v[36:39], v[44:47], a[228:231], 0
    buffer_load_dwordx4 v3, s[28:31], s71 offen offset:0 lds
    s_waitcnt lgkmcnt(4)
    v_mfma_f32_32x32x16_bf16 v[64:79], a[192:195], v[128:131], 0
    ds_read_b64_tr_b16 a[208:209], v14 offset:4096
    ds_read_b64_tr_b16 a[210:211], v14 offset:4608
    buffer_load_dwordx4 v4, s[28:31], s71 offen offset:1024 lds
    v_mfma_f32_32x32x16_bf16 v[80:95], a[196:199], v[128:131], 0
    s_waitcnt lgkmcnt(2)
    ds_read_b64_tr_b16 a[212:213], v15 offset:4096
    ds_read_b64_tr_b16 a[214:215], v15 offset:4608
    buffer_load_dwordx4 v5, s[28:31], s71 offen offset:2048 lds
    v_mfma_f32_32x32x16_bf16 v[64:79], a[200:203], v[132:135], v[64:79]
    ds_read_b64_tr_b16 a[216:217], v14 offset:6144
    ds_read_b64_tr_b16 a[218:219], v14 offset:6656
    buffer_load_dwordx4 v6, s[28:31], s71 offen offset:3072 lds
    v_mfma_f32_32x32x16_bf16 v[80:95], a[204:207], v[132:135], v[80:95]
    s_waitcnt lgkmcnt(2)
    ds_read_b64_tr_b16 a[220:221], v15 offset:6144
    ds_read_b64_tr_b16 a[222:223], v15 offset:6656
    s_add_u32 m0, s80, 16384
    s_mov_b64 exec, s[18:19]
    buffer_load_dwordx4 v7, s[32:35], s16 offen lds
    buffer_load_dwordx4 v8, s[32:35], s16 offen offset:1024 lds
    s_mov_b64 exec, -1
    s_waitcnt vmcnt(6)
    s_barrier
    v_mfma_f32_32x32x16_bf16 v[64:79], a[208:211], v[136:139], v[64:79]
    ds_read_b128 v[144:147], v10 offset:4096
    ds_read_b128 v[148:151], v11 offset:4096
    ds_read_b128 v[152:155], v12 offset:4096
    ds_read_b128 v[156:159], v13 offset:4096
    s_add_u32 m0, s17, 12288
    s_nop 0
    buffer_load_dwordx4 v3, s[28:31], s72 offen offset:0 lds
    v_mfma_f32_32x32x16_bf16 v[80:95], a[212:215], v[136:139], v[80:95]
    s_waitcnt lgkmcnt(4)
    ds_read_b64_tr_b16 a[224:225], v16 offset:8192
    ds_read_b64_tr_b16 a[226:227], v16 offset:8704
    ds_read_b64_tr_b16 a[228:229], v17 offset:8192
    ds_read_b64_tr_b16 a[230:231], v17 offset:8704
    buffer_load_dwordx4 v4, s[28:31], s72 offen offset:1024 lds
    v_mfma_f32_32x32x16_bf16 v[64:79], a[216:219], v[140:143], v[64:79]
    ds_read_b64_tr_b16 a[192:193], v14 offset:8192
    ds_read_b64_tr_b16 a[194:195], v14 offset:8704
    ds_read_b64_tr_b16 a[196:197], v15 offset:8192
    ds_read_b64_tr_b16 a[198:199], v15 offset:8704
    buffer_load_dwordx4 v5, s[28:31], s72 offen offset:2048 lds
    v_mfma_f32_32x32x16_bf16 v[80:95], a[220:223], v[140:143], v[80:95]
    ds_read_b64_tr_b16 a[200:201], v14 offset:10240
    ds_read_b64_tr_b16 a[202:203], v14 offset:10752
    ds_read_b64_tr_b16 a[204:205], v15 offset:10240
    ds_read_b64_tr_b16 a[206:207], v15 offset:10752
    buffer_load_dwordx4 v6, s[28:31], s72 offen offset:3072 lds
    s_waitcnt lgkmcnt(12)
    v_dot2c_f32_bf16 v61, v144, v144
    v_dot2c_f32_bf16 v60, s22, v144
    v_dot2c_f32_bf16 v63, v145, v145
    v_dot2c_f32_bf16 v62, s22, v145
    v_dot2c_f32_bf16 v61, v146, v146
    v_dot2c_f32_bf16 v60, s22, v146
    v_dot2c_f32_bf16 v63, v147, v147
    v_dot2c_f32_bf16 v62, s22, v147
    v_dot2c_f32_bf16 v61, v148, v148
    v_dot2c_f32_bf16 v60, s22, v148
    v_dot2c_f32_bf16 v63, v149, v149
    v_dot2c_f32_bf16 v62, s22, v149
    v_dot2c_f32_bf16 v61, v150, v150
    v_dot2c_f32_bf16 v60, s22, v150
    v_dot2c_f32_bf16 v63, v151, v151
    v_dot2c_f32_bf16 v62, s22, v151
    v_dot2c_f32_bf16 v61, v152, v152
    v_dot2c_f32_bf16 v60, s22, v152
    v_dot2c_f32_bf16 v63, v153, v153
    v_dot2c_f32_bf16 v62, s22, v153
    v_dot2c_f32_bf16 v61, v154, v154
    v_dot2c_f32_bf16 v60, s22, v154
    v_dot2c_f32_bf16 v63, v155, v155
    v_dot2c_f32_bf16 v62, s22, v155
    v_dot2c_f32_bf16 v61, v156, v156
    v_dot2c_f32_bf16 v60, s22, v156
    v_dot2c_f32_bf16 v63, v157, v157
    v_dot2c_f32_bf16 v62, s22, v157
    v_dot2c_f32_bf16 v61, v158, v158
    v_dot2c_f32_bf16 v60, s22, v158
    v_dot2c_f32_bf16 v63, v159, v159
    v_dot2c_f32_bf16 v62, s22, v159
    s_waitcnt lgkmcnt(8)
    v_mfma_f32_16x16x32_bf16 v[32:35], v[44:47], a[224:227], v[32:35]
    s_add_u32 m0, s80, 24576
    s_mov_b64 exec, s[18:19]
    buffer_load_dwordx4 v7, s[32:35], s26 offen lds
    buffer_load_dwordx4 v8, s[32:35], s26 offen offset:1024 lds
    s_mov_b64 exec, -1
    v_mfma_f32_16x16x32_bf16 v[36:39], v[44:47], a[228:231], v[36:39]
    s_waitcnt lgkmcnt(4)
    v_mfma_f32_32x32x16_bf16 v[64:79], a[192:195], v[144:147], v[64:79]
    ds_read_b64_tr_b16 a[208:209], v14 offset:12288
    ds_read_b64_tr_b16 a[210:211], v14 offset:12800
    v_mfma_f32_32x32x16_bf16 v[80:95], a[196:199], v[144:147], v[80:95]
    s_waitcnt lgkmcnt(2)
    ds_read_b64_tr_b16 a[212:213], v15 offset:12288
    ds_read_b64_tr_b16 a[214:215], v15 offset:12800
    v_mfma_f32_32x32x16_bf16 v[64:79], a[200:203], v[148:151], v[64:79]
    ds_read_b64_tr_b16 a[216:217], v14 offset:14336
    ds_read_b64_tr_b16 a[218:219], v14 offset:14848
    v_mfma_f32_32x32x16_bf16 v[80:95], a[204:207], v[148:151], v[80:95]
    s_waitcnt lgkmcnt(2)
    ds_read_b64_tr_b16 a[220:221], v15 offset:14336
    ds_read_b64_tr_b16 a[222:223], v15 offset:14848
    s_waitcnt vmcnt(6)
    s_cmp_eq_u32 s86, 0
    s_cbranch_scc1 L_sgA0
L_sgA_ret0:
    s_barrier
    v_mfma_f32_32x32x16_bf16 v[64:79], a[208:211], v[152:155], v[64:79]
    ds_read_b128 v[160:163], v10 offset:8192
    ds_read_b128 v[164:167], v11 offset:8192
    ds_read_b128 v[168:171], v12 offset:8192
    ds_read_b128 v[172:175], v13 offset:8192
    s_add_u32 m0, s17, 0
    s_nop 0
    buffer_load_dwordx4 v3, s[28:31], s73 offen offset:0 lds
    v_mfma_f32_32x32x16_bf16 v[80:95], a[212:215], v[152:155], v[80:95]
    s_waitcnt lgkmcnt(4)
    ds_read_b64_tr_b16 a[224:225], v16 offset:16384
    ds_read_b64_tr_b16 a[226:227], v16 offset:16896
    ds_read_b64_tr_b16 a[228:229], v17 offset:16384
    ds_read_b64_tr_b16 a[230:231], v17 offset:16896
    buffer_load_dwordx4 v4, s[28:31], s73 offen offset:1024 lds
    v_mfma_f32_32x32x16_bf16 v[64:79], a[216:219], v[156:159], v[64:79]
    ds_read_b64_tr_b16 a[192:193], v14 offset:16384
    ds_read_b64_tr_b16 a[194:195], v14 offset:16896
    ds_read_b64_tr_b16 a[196:197], v15 offset:16384
    ds_read_b64_tr_b16 a[198:199], v15 offset:16896
    buffer_load_dwordx4 v5, s[28:31], s73 offen offset:2048 lds
    v_mfma_f32_32x32x16_bf16 v[80:95], a[220:223], v[156:159], v[80:95]
    ds_read_b64_tr_b16 a[200:201], v14 offset:18432
    ds_read_b64_tr_b16 a[202:203], v14 offset:18944
    ds_read_b64_tr_b16 a[204:205], v15 offset:18432
    ds_read_b64_tr_b16 a[206:207], v15 offset:18944
    buffer_load_dwordx4 v6, s[28:31], s73 offen offset:3072 lds
    s_waitcnt lgkmcnt(12)
    v_dot2c_f32_bf16 v61, v160, v160
    v_dot2c_f32_bf16 v60, s22, v160
    v_dot2c_f32_bf16 v63, v161, v161
    v_dot2c_f32_bf16 v62, s22, v161
    v_dot2c_f32_bf16 v61, v162, v162
    v_dot2c_f32_bf16 v60, s22, v162
    v_dot2c_f32_bf16 v63, v163, v163
    v_dot2c_f32_bf16 v62, s22, v163
    v_dot2c_f32_bf16 v61, v164, v164
    v_dot2c_f32_bf16 v60, s22, v164
    v_dot2c_f32_bf16 v63, v165, v165
    v_dot2c_f32_bf16 v62, s22, v165
    v_dot2c_f32_bf16 v61, v166, v166
    v_dot2c_f32_bf16 v60, s22, v166
    v_dot2c_f32_bf16 v63, v167, v167
    v_dot2c_f32_bf16 v62, s22, v167
    v_dot2c_f32_bf16 v61, v168, v168
    v_dot2c_f32_bf16 v60, s22, v168
    v_dot2c_f32_bf16 v63, v169, v169
    v_dot2c_f32_bf16 v62, s22, v169
    v_dot2c_f32_bf16 v61, v170, v170
    v_dot2c_f32_bf16 v60, s22, v170
    v_dot2c_f32_bf16 v63, v171, v171
    v_dot2c_f32_bf16 v62, s22, v171
    v_dot2c_f32_bf16 v61, v172, v172
    v_dot2c_f32_bf16 v60, s22, v172
    v_dot2c_f32_bf16 v63, v173, v173
    v_dot2c_f32_bf16 v62, s22, v173
    v_dot2c_f32_bf16 v61, v174, v174
    v_dot2c_f32_bf16 v60, s22, v174
    v_dot2c_f32_bf16 v63, v175, v175
    v_dot2c_f32_bf16 v62, s22, v175
    s_waitcnt lgkmcnt(8)
    v_mfma_f32_16x16x32_bf16 v[32:35], v[44:47], a[224:227], v[32:35]
    s_add_u32 m0, s80, 32768
    s_mov_b64 exec, s[18:19]
    buffer_load_dwordx4 v7, s[32:35], s27 offen lds
    buffer_load_dwordx4 v8, s[32:35], s27 offen offset:1024 lds
    s_mov_b64 exec, -1
    v_mfma_f32_16x16x32_bf16 v[36:39], v[44:47], a[228:231], v[36:39]
    s_waitcnt lgkmcnt(4)
    v_mfma_f32_32x32x16_bf16 v[64:79], a[192:195], v[160:163], v[64:79]
    ds_read_b64_tr_b16 a[208:209], v14 offset:20480
    ds_read_b64_tr_b16 a[210:211], v14 offset:20992
    v_mfma_f32_32x32x16_bf16 v[80:95], a[196:199], v[160:163], v[80:95]
    s_waitcnt lgkmcnt(2)
    ds_read_b64_tr_b16 a[212:213], v15 offset:20480
    ds_read_b64_tr_b16 a[214:215], v15 offset:20992
    v_mfma_f32_32x32x16_bf16 v[64:79], a[200:203], v[164:167], v[64:79]
    ds_read_b64_tr_b16 a[216:217], v14 offset:22528
    ds_read_b64_tr_b16 a[218:219], v14 offset:23040
    v_mfma_f32_32x32x16_bf16 v[80:95], a[204:207], v[164:167], v[80:95]
    s_waitcnt lgkmcnt(2)
    ds_read_b64_tr_b16 a[220:221], v15 offset:22528
    ds_read_b64_tr_b16 a[222:223], v15 offset:23040
    s_waitcnt vmcnt(6)
    s_barrier
    v_mfma_f32_32x32x16_bf16 v[64:79], a[208:211], v[168:171], v[64:79]
    ds_read_b128 v[176:179], v10 offset:12288
    ds_read_b128 v[180:183], v11 offset:12288
    ds_read_b128 v[184:187], v12 offset:12288
    ds_read_b128 v[188:191], v13 offset:12288
    s_add_u32 m0, s17, 4096
    s_nop 0
    buffer_load_dwordx4 v3, s[28:31], s74 offen offset:0 lds
    v_mfma_f32_32x32x16_bf16 v[80:95], a[212:215], v[168:171], v[80:95]
    s_waitcnt lgkmcnt(4)
    ds_read_b64_tr_b16 a[224:225], v16 offset:24576
    ds_read_b64_tr_b16 a[226:227], v16 offset:25088
    ds_read_b64_tr_b16 a[228:229], v17 offset:24576
    ds_read_b64_tr_b16 a[230:231], v17 offset:25088
    buffer_load_dwordx4 v4, s[28:31], s74 offen offset:1024 lds
    v_mfma_f32_32x32x16_bf16 v[64:79], a[216:219], v[172:175], v[64:79]
    ds_read_b64_tr_b16 a[192:193], v14 offset:24576
    ds_read_b64_tr_b16 a[194:195], v14 offset:25088
    ds_read_b64_tr_b16 a[196:197], v15 offset:24576
    ds_read_b64_tr_b16 a[198:199], v15 offset:25088
    buffer_load_dwordx4 v5, s[28:31], s74 offen offset:2048 lds
    v_mfma_f32_32x32x16_bf16 v[80:95], a[220:223], v[172:175], v[80:95]
    ds_read_b64_tr_b16 a[200:201], v14 offset:26624
    ds_read_b64_tr_b16 a[202:203], v14 offset:27136
    ds_read_b64_tr_b16 a[204:205], v15 offset:26624
    ds_read_b64_tr_b16 a[206:207], v15 offset:27136
    buffer_load_dwordx4 v6, s[28:31], s74 offen offset:3072 lds
    s_waitcnt lgkmcnt(12)
    v_dot2c_f32_bf16 v61, v176, v176
    v_dot2c_f32_bf16 v60, s22, v176
    v_dot2c_f32_bf16 v63, v177, v177
    v_dot2c_f32_bf16 v62, s22, v177
    v_dot2c_f32_bf16 v61, v178, v178
    v_dot2c_f32_bf16 v60, s22, v178
    v_dot2c_f32_bf16 v63, v179, v179
    v_dot2c_f32_bf16 v62, s22, v179
    v_dot2c_f32_bf16 v61, v180, v180
L_tch0:
    s_cbranch_execz L_tch4
    v_dot2c_f32_bf16 v60, s22, v180
    v_dot2c_f32_bf16 v63, v181, v181
    v_dot2c_f32_bf16 v62, s22, v181
    v_dot2c_f32_bf16 v61, v182, v182
    v_dot2c_f32_bf16 v60, s22, v182
    v_dot2c_f32_bf16 v63, v183, v183
    v_dot2c_f32_bf16 v62, s22, v183
    v_dot2c_f32_bf16 v61, v184, v184
    v_dot2c_f32_bf16 v60, s22, v184
    v_dot2c_f32_bf16 v63, v185, v185
    v_dot2c_f32_bf16 v62, s22, v185
    v_dot2c_f32_bf16 v61, v186, v186
    v_dot2c_f32_bf16 v60, s22, v186
    v_dot2c_f32_bf16 v63, v187, v187
    v_dot2c_f32_bf16 v62, s22, v187
    v_dot2c_f32_bf16 v61, v188, v188
    v_dot2c_f32_bf16 v60, s22, v188
    v_dot2c_f32_bf16 v63, v189, v189
    v_dot2c_f32_bf16 v62, s22, v189
    v_dot2c_f32_bf16 v61, v190, v190
    v_dot2c_f32_bf16 v60, s22, v190
    v_dot2c_f32_bf16 v63, v191, v191
    v_dot2c_f32_bf16 v62, s22, v191
    s_waitcnt lgkmcnt(8)
    v_mfma_f32_16x16x32_bf16 v[32:35], v[44:47], a[224:227], v[32:35]
    s_add_u32 m0, s80, 40960
    s_mov_b64 exec, s[18:19]
    buffer_load_dwordx4 v7, s[32:35], s84 offen lds
    buffer_load_dwordx4 v8, s[32:35], s84 offen offset:1024 lds
    s_mov_b64 exec, -1
    v_mfma_f32_16x16x32_bf16 v[36:39], v[44:47], a[228:231], v[36:39]
    s_waitcnt lgkmcnt(4)
    v_mfma_f32_32x32x16_bf16 v[64:79], a[192:195], v[176:179], v[64:79]
    ds_read_b64_tr_b16 a[208:209], v14 offset:28672
    ds_read_b64_tr_b16 a[210:211], v14 offset:29184
    v_mfma_f32_32x32x16_bf16 v[80:95], a[196:199], v[176:179], v[80:95]
    s_waitcnt lgkmcnt(2)
    ds_read_b64_tr_b16 a[212:213], v15 offset:28672
    ds_read_b64_tr_b16 a[214:215], v15 offset:29184
    v_mfma_f32_32x32x16_bf16 v[64:79], a[200:203], v[180:183], v[64:79]
    ds_read_b64_tr_b16 a[216:217], v14 offset:30720
    ds_read_b64_tr_b16 a[218:219], v14 offset:31232
    v_mfma_f32_32x32x16_bf16 v[80:95], a[204:207], v[180:183], v[80:95]
    s_waitcnt lgkmcnt(2)
    ds_read_b64_tr_b16 a[220:221], v15 offset:30720
    ds_read_b64_tr_b16 a[222:223], v15 offset:31232
    s_waitcnt vmcnt(6)
    s_barrier
    v_mfma_f32_32x32x16_bf16 v[64:79], a[208:211], v[184:187], v[64:79]
    ds_read_b128 v[192:195], v10 offset:0
    ds_read_b128 v[196:199], v11 offset:0
    ds_read_b128 v[200:203], v12 offset:0
    ds_read_b128 v[204:207], v13 offset:0
    s_add_u32 m0, s17, 8192
    s_nop 0
    buffer_load_dwordx4 v3, s[28:31], s75 offen offset:0 lds
    v_mfma_f32_32x32x16_bf16 v[80:95], a[212:215], v[184:187], v[80:95]
    s_waitcnt lgkmcnt(4)
    ds_read_b64_tr_b16 a[224:225], v16 offset:32768
    ds_read_b64_tr_b16 a[226:227], v16 offset:33280
    ds_read_b64_tr_b16 a[228:229], v17 offset:32768
    ds_read_b64_tr_b16 a[230:231], v17 offset:33280
    buffer_load_dwordx4 v4, s[28:31], s75 offen offset:1024 lds
    v_mfma_f32_32x32x16_bf16 v[64:79], a[216:219], v[188:191], v[64:79]
    ds_read_b64_tr_b16 a[192:193], v14 offset:32768
    ds_read_b64_tr_b16 a[194:195], v14 offset:33280
    ds_read_b64_tr_b16 a[196:197], v15 offset:32768
    ds_read_b64_tr_b16 a[198:199], v15 offset:33280
    buffer_load_dwordx4 v5, s[28:31], s75 offen offset:2048 lds
    v_mfma_f32_32x32x16_bf16 v[80:95], a[220:223], v[188:191], v[80:95]
    ds_read_b64_tr_b16 a[200:201], v14 offset:34816
    ds_read_b64_tr_b16 a[202:203], v14 offset:35328
    ds_read_b64_tr_b16 a[204:205], v15 offset:34816
    ds_read_b64_tr_b16 a[206:207], v15 offset:35328
    buffer_load_dwordx4 v6, s[28:31], s75 offen offset:3072 lds
    s_waitcnt lgkmcnt(12)
    v_dot2c_f32_bf16 v61, v192, v192
    v_dot2c_f32_bf16 v60, s22, v192
    v_dot2c_f32_bf16 v63, v193, v193
    v_dot2c_f32_bf16 v62, s22, v193
    v_dot2c_f32_bf16 v61, v194, v194
    v_dot2c_f32_bf16 v60, s22, v194
    v_dot2c_f32_bf16 v63, v195, v195
    v_dot2c_f32_bf16 v62, s22, v195
    v_dot2c_f32_bf16 v61, v196, v196
    v_dot2c_f32_bf16 v60, s22, v196
    v_dot2c_f32_bf16 v63, v197, v197
    v_dot2c_f32_bf16 v62, s22, v197
    v_dot2c_f32_bf16 v61, v198, v198
    v_dot2c_f32_bf16 v60, s22, v198
    v_dot2c_f32_bf16 v63, v199, v199
    v_dot2c_f32_bf16 v62, s22, v199
    v_dot2c_f32_bf16 v61, v200, v200
    v_dot2c_f32_bf16 v60, s22, v200
    v_dot2c_f32_bf16 v63, v201, v201
    v_dot2c_f32_bf16 v62, s22, v201
    v_dot2c_f32_bf16 v61, v202, v202
    v_dot2c_f32_bf16 v60, s22, v202
    v_dot2c_f32_bf16 v63, v203, v203
    v_dot2c_f32_bf16 v62, s22, v203
    v_dot2c_f32_bf16 v61, v204, v204
    v_dot2c_f32_bf16 v60, s22, v204
    v_dot2c_f32_bf16 v63, v205, v205
    v_dot2c_f32_bf16 v62, s22, v205
    v_dot2c_f32_bf16 v61, v206, v206
    v_dot2c_f32_bf16 v60, s22, v206
    v_dot2c_f32_bf16 v63, v207, v207
    v_dot2c_f32_bf16 v62, s22, v207
    s_waitcnt lgkmcnt(8)
    v_mfma_f32_16x16x32_bf16 v[32:35], v[44:47], a[224:227], v[32:35]
    buffer_load_dword v22, v31, s[44:47], 0 offen sc1
    v_mfma_f32_16x16x32_bf16 v[36:39], v[44:47], a[228:231], v[36:39]
    buffer_load_dword a1, v2, s[36:39], s25 offen
    s_waitcnt lgkmcnt(4)
    v_mfma_f32_32x32x16_bf16 v[64:79], a[192:195], v[192:195], v[64:79]
    ds_read_b64_tr_b16 a[208:209], v14 offset:36864
    ds_read_b64_tr_b16 a[210:211], v14 offset:37376
    s_add_u32 m0, s80, 49152
    s_mov_b64 exec, s[18:19]
    buffer_load_dwordx4 v7, s[32:35], s87 offen lds
    buffer_load_dwordx4 v8, s[32:35], s87 offen offset:1024 lds
    s_mov_b64 exec, -1
    v_mfma_f32_32x32x16_bf16 v[80:95], a[196:199], v[192:195], v[80:95]
    s_waitcnt lgkmcnt(2)
    ds_read_b64_tr_b16 a[212:213], v15 offset:36864
    ds_read_b64_tr_b16 a[214:215], v15 offset:37376
    v_mfma_f32_32x32x16_bf16 v[64:79], a[200:203], v[196:199], v[64:79]
    ds_read_b64_tr_b16 a[216:217], v14 offset:38912
    ds_read_b64_tr_b16 a[218:219], v14 offset:39424
    v_mfma_f32_32x32x16_bf16 v[80:95], a[204:207], v[196:199], v[80:95]
    s_waitcnt lgkmcnt(2)
    ds_read_b64_tr_b16 a[220:221], v15 offset:38912
    ds_read_b64_tr_b16 a[222:223], v15 offset:39424
    s_waitcnt vmcnt(8)
    s_barrier
    v_mfma_f32_32x32x16_bf16 v[64:79], a[208:211], v[200:203], v[64:79]
    ds_read_b128 v[208:211], v10 offset:4096
    ds_read_b128 v[212:215], v11 offset:4096
    ds_read_b128 v[216:219], v12 offset:4096
    ds_read_b128 v[220:223], v13 offset:4096
    s_add_u32 m0, s17, 19456
    v_mfma_f32_32x32x16_bf16 v[80:95], a[212:215], v[200:203], v[80:95]
    s_waitcnt lgkmcnt(4)
    ds_read_b64_tr_b16 a[224:225], v16 offset:40960
    ds_read_b64_tr_b16 a[226:227], v16 offset:41472
    ds_read_b64_tr_b16 a[228:229], v17 offset:40960
    ds_read_b64_tr_b16 a[230:231], v17 offset:41472
    v_mfma_f32_32x32x16_bf16 v[64:79], a[216:219], v[204:207], v[64:79]
    ds_read_b64_tr_b16 a[192:193], v14 offset:40960
    ds_read_b64_tr_b16 a[194:195], v14 offset:41472
    ds_read_b64_tr_b16 a[196:197], v15 offset:40960
    ds_read_b64_tr_b16 a[198:199], v15 offset:41472
    buffer_load_dwordx4 v9, s[32:35], s26 offen lds
    v_mfma_f32_32x32x16_bf16 v[80:95], a[220:223], v[204:207], v[80:95]
    ds_read_b64_tr_b16 a[200:201], v14 offset:43008
    ds_read_b64_tr_b16 a[202:203], v14 offset:43520
    ds_read_b64_tr_b16 a[204:205], v15 offset:43008
    ds_read_b64_tr_b16 a[206:207], v15 offset:43520
    s_waitcnt lgkmcnt(12)
    v_dot2c_f32_bf16 v61, v208, v208
    v_dot2c_f32_bf16 v60, s22, v208
    v_dot2c_f32_bf16 v63, v209, v209
    v_dot2c_f32_bf16 v62, s22, v209
    v_dot2c_f32_bf16 v61, v210, v210
    v_dot2c_f32_bf16 v60, s22, v210
    v_dot2c_f32_bf16 v63, v211, v211
    v_dot2c_f32_bf16 v62, s22, v211
    v_dot2c_f32_bf16 v61, v212, v212
    v_dot2c_f32_bf16 v60, s22, v212
    v_dot2c_f32_bf16 v63, v213, v213
    v_dot2c_f32_bf16 v62, s22, v213
    v_dot2c_f32_bf16 v61, v214, v214
    v_dot2c_f32_bf16 v60, s22, v214
    v_dot2c_f32_bf16 v63, v215, v215
    v_dot2c_f32_bf16 v62, s22, v215
    v_dot2c_f32_bf16 v61, v216, v216
    v_dot2c_f32_bf16 v60, s22, v216
    v_dot2c_f32_bf16 v63, v217, v217
    v_dot2c_f32_bf16 v62, s22, v217
    v_dot2c_f32_bf16 v61, v218, v218
    v_dot2c_f32_bf16 v60, s22, v218
    v_dot2c_f32_bf16 v63, v219, v219
    v_dot2c_f32_bf16 v62, s22, v219
    v_dot2c_f32_bf16 v61, v220, v220
    v_dot2c_f32_bf16 v60, s22, v220
    v_dot2c_f32_bf16 v63, v221, v221
    v_dot2c_f32_bf16 v62, s22, v221
    v_dot2c_f32_bf16 v61, v222, v222
    v_dot2c_f32_bf16 v60, s22, v222
    v_dot2c_f32_bf16 v63, v223, v223
    v_dot2c_f32_bf16 v62, s22, v223
    s_waitcnt lgkmcnt(8)
    v_mfma_f32_16x16x32_bf16 v[32:35], v[44:47], a[224:227], v[32:35]
    s_add_u32 m0, s17, 20480
    v_mfma_f32_16x16x32_bf16 v[36:39], v[44:47], a[228:231], v[36:39]
    buffer_load_dwordx4 v9, s[32:35], s27 offen lds
    s_waitcnt lgkmcnt(4)
    v_mfma_f32_32x32x16_bf16 v[64:79], a[192:195], v[208:211], v[64:79]
    ds_read_b64_tr_b16 a[208:209], v14 offset:45056
    ds_read_b64_tr_b16 a[210:211], v14 offset:45568
    ds_read_b64_tr_b16 a[212:213], v15 offset:45056
    ds_read_b64_tr_b16 a[214:215], v15 offset:45568
    s_waitcnt vmcnt(6)
    v_mfma_f32_32x32x16_bf16 v[80:95], a[196:199], v[208:211], v[80:95]
    s_waitcnt lgkmcnt(4)
    ds_read_b128 v[224:227], v10 offset:8192
    ds_read_b128 v[228:231], v11 offset:8192
    ds_read_b128 v[232:235], v12 offset:8192
    ds_read_b128 v[236:239], v13 offset:8192
    v_mfma_f32_32x32x16_bf16 v[64:79], a[200:203], v[212:215], v[64:79]
    ds_read_b64_tr_b16 a[216:217], v14 offset:47104
    ds_read_b64_tr_b16 a[218:219], v14 offset:47616
    v_mfma_f32_32x32x16_bf16 v[80:95], a[204:207], v[212:215], v[80:95]
    s_waitcnt lgkmcnt(6)
    ds_read_b64_tr_b16 a[220:221], v15 offset:47104
    ds_read_b64_tr_b16 a[222:223], v15 offset:47616
    s_waitcnt vmcnt(5)
    v_cmp_eq_u32 vcc, 0, v22
    s_waitcnt lgkmcnt(4)
    v_dot2c_f32_bf16 v61, v224, v224
    v_dot2c_f32_bf16 v60, s22, v224
    v_dot2c_f32_bf16 v63, v225, v225
    v_dot2c_f32_bf16 v62, s22, v225
    v_dot2c_f32_bf16 v61, v226, v226
    v_dot2c_f32_bf16 v60, s22, v226
    v_dot2c_f32_bf16 v63, v227, v227
    v_dot2c_f32_bf16 v62, s22, v227
    v_dot2c_f32_bf16 v61, v228, v228
    v_dot2c_f32_bf16 v60, s22, v228
    v_dot2c_f32_bf16 v63, v229, v229
    v_dot2c_f32_bf16 v62, s22, v229
    v_dot2c_f32_bf16 v61, v230, v230
    v_dot2c_f32_bf16 v60, s22, v230
    v_dot2c_f32_bf16 v63, v231, v231
    v_dot2c_f32_bf16 v62, s22, v231
    v_dot2c_f32_bf16 v61, v232, v232
    v_dot2c_f32_bf16 v60, s22, v232
    v_dot2c_f32_bf16 v63, v233, v233
    v_dot2c_f32_bf16 v62, s22, v233
    v_dot2c_f32_bf16 v61, v234, v234
    v_dot2c_f32_bf16 v60, s22, v234
    v_dot2c_f32_bf16 v63, v235, v235
    v_dot2c_f32_bf16 v62, s22, v235
    v_dot2c_f32_bf16 v61, v236, v236
    v_dot2c_f32_bf16 v60, s22, v236
    v_dot2c_f32_bf16 v63, v237, v237
    v_dot2c_f32_bf16 v62, s22, v237
    v_dot2c_f32_bf16 v61, v238, v238
    v_dot2c_f32_bf16 v60, s22, v238
    v_dot2c_f32_bf16 v63, v239, v239
    v_dot2c_f32_bf16 v62, s22, v239
    s_and_b32 s11, vcc_lo, 0xff
    s_cbranch_scc1 L_sigA0
L_sigA_ok0:
    v_mfma_f32_32x32x16_bf16 v[64:79], a[208:211], v[216:219], v[64:79]
    s_add_u32 m0, s17, 21504
    s_nop 0
    buffer_load_dwordx4 v9, s[32:35], s84 offen lds
    v_add_f32 v60, v60, v62
    v_add_f32 v61, v61, v63
    s_nop 1
    v_permlane32_swap_b32 v60, v61
    v_add_f32 v60, v60, v61
    v_mul_f32 v60, 0x3b124925, v60
    v_mov_b32 v61, v60
    v_mfma_f32_32x32x16_bf16 v[80:95], a[212:215], v[216:219], v[80:95]
    s_waitcnt lgkmcnt(0)
    s_mul_i32 s14, s3, 28672
    s_add_u32 m0, s17, 12288
    s_add_u32 s14, s14, s85
    v_permlane32_swap_b32 v60, v61
    v_fma_f32 v61, -v60, v60, v61
    v_cvt_pk_bf16_f32 v60, v60, v60
    v_max_f32 v61, 0, v61
    v_cvt_pk_bf16_f32 v61, v61, v61
    v_and_b32 v61, s81, v61
    v_mfma_f32_32x32x16_bf16 v[64:79], a[216:219], v[220:223], v[64:79]
    buffer_load_dwordx4 v3, s[28:31], s14 offen offset:0 lds
    v_add_f32 v61, 0x3727c5ac, v61
    v_cvt_pk_bf16_f32 v61, v61, v61
    v_and_b32 v61, s81, v61
    v_sqrt_f32 v61, v61
    v_xor_b32 v24, 0x80008000, v60
    v_cvt_pk_bf16_f32 v61, v61, v61
    v_mfma_f32_32x32x16_bf16 v[80:95], a[220:223], v[220:223], v[80:95]
    buffer_load_dwordx4 v4, s[28:31], s14 offen offset:1024 lds
    v_and_b32 v62, s81, v61
    v_bfi_b32 v21, s81, v61, v60
    v_rcp_f32 v62, v62
    v_bfi_b32 v25, s81, v61, v24
    v_cndmask_b32 v48, 0, v24, s[20:21]
    v_cndmask_b32 v49, 0, v25, s[20:21]
    buffer_store_dword v21, v27, s[36:39], s100 offen sc1
    s_waitcnt vmcnt(6)
    ds_read_b64_tr_b16 a[224:225], v16 offset:49152
    ds_read_b64_tr_b16 a[226:227], v16 offset:49664
    ds_read_b64_tr_b16 a[228:229], v17 offset:49152
    ds_read_b64_tr_b16 a[230:231], v17 offset:49664
    s_barrier
    ds_read_b64_tr_b16 a[192:193], v14 offset:49152
    ds_read_b64_tr_b16 a[194:195], v14 offset:49664
    ds_read_b64_tr_b16 a[200:201], v14 offset:51200
    ds_read_b64_tr_b16 a[202:203], v14 offset:51712
    ds_read_b64_tr_b16 a[208:209], v14 offset:53248
    ds_read_b64_tr_b16 a[210:211], v14 offset:53760
    ds_read_b64_tr_b16 a[216:217], v14 offset:55296
    ds_read_b64_tr_b16 a[218:219], v14 offset:55808
    s_waitcnt lgkmcnt(8)
    v_mfma_f32_16x16x32_bf16 v[32:35], v[44:47], a[224:227], v[32:35]
    v_mfma_f32_16x16x32_bf16 v[36:39], v[44:47], a[228:231], v[36:39]
    s_waitcnt lgkmcnt(6)
    v_mfma_f32_32x32x16_bf16 v[64:79], a[192:195], v[224:227], v[64:79]
    ds_read_b64_tr_b16 a[196:197], v15 offset:49152
    ds_read_b64_tr_b16 a[198:199], v15 offset:49664
    ds_read_b64_tr_b16 a[204:205], v15 offset:51200
    ds_read_b64_tr_b16 a[206:207], v15 offset:51712
    s_waitcnt lgkmcnt(4)
    s_nop 0
    ds_write2st64_b32 v23, v32, v36 offset0:0 offset1:2
    v_mfma_f32_32x32x16_bf16 v[64:79], a[200:203], v[228:231], v[64:79]
    ds_read_b64_tr_b16 a[212:213], v15 offset:53248
    ds_read_b64_tr_b16 a[214:215], v15 offset:53760
    ds_read_b64_tr_b16 a[220:221], v15 offset:55296
    ds_read_b64_tr_b16 a[222:223], v15 offset:55808
    v_mfma_f32_32x32x16_bf16 v[64:79], a[208:211], v[232:235], v[64:79]
    s_add_u32 m0, s17, 22528
    s_nop 0
    buffer_load_dwordx4 v9, s[32:35], s87 offen lds
    v_mfma_f32_32x32x16_bf16 v[64:79], a[216:219], v[236:239], v[64:79]
    s_waitcnt lgkmcnt(4)
    s_barrier
    ds_read_b128 v[32:35], v26
    ds_read_b128 v[36:39], v26 offset:512
    s_waitcnt lgkmcnt(2)
    v_mfma_f32_32x32x16_bf16 v[80:95], a[196:199], v[224:227], v[80:95]
    v_mfma_f32_32x32x16_bf16 v[80:95], a[204:207], v[228:231], v[80:95]
    s_waitcnt lgkmcnt(0)
    v_add_f32 v32, v32, v33
    v_add_f32 v34, v34, v35
    v_add_f32 v32, v32, v34
    v_and_b32 v60, s81, v32
    v_sub_f32 v61, v32, v60
    v_lshrrev_b32 v60, 16, v60
    v_and_b32 v32, s81, v61
    v_sub_f32 v61, v61, v32
    v_or_b32 v52, v60, v32
    v_lshrrev_b32 v53, 16, v61
    v_add_f32 v36, v36, v37
    v_add_f32 v38, v38, v39
    v_mfma_f32_32x32x16_bf16 v[64:79], v[52:55], v[48:51], v[64:79]
    v_add_f32 v36, v36, v38
    v_and_b32 v60, s81, v36
    v_sub_f32 v61, v36, v60
    v_lshrrev_b32 v60, 16, v60
    v_and_b32 v36, s81, v61
    v_sub_f32 v61, v61, v36
    v_mfma_f32_32x32x16_bf16 v[80:95], a[212:215], v[232:235], v[80:95]
    v_or_b32 v56, v60, v36
    v_lshrrev_b32 v57, 16, v61
    v_mfma_f32_32x32x16_bf16 v[80:95], a[220:223], v[236:239], v[80:95]
    s_nop 1
    v_mul_f32 v64, v64, v62
    v_mul_f32 v65, v65, v62
    v_cvt_pk_bf16_f32 v240, v64, v65
    v_mul_f32 v66, v66, v62
    v_mul_f32 v67, v67, v62
    v_cvt_pk_bf16_f32 v241, v66, v67
    v_mfma_f32_32x32x16_bf16 v[80:95], v[56:59], v[48:51], v[80:95]
    v_mul_f32 v68, v68, v62
    v_mul_f32 v69, v69, v62
    v_cvt_pk_bf16_f32 v242, v68, v69
    v_pk_mul_f32 v[70:71], v[70:71], v[62:63] op_sel_hi:[1,0]
    v_cvt_pk_bf16_f32 v243, v70, v71
    buffer_store_dwordx4 v[240:243], v2, s[36:39], s23 offen offset:0 sc1
    v_pk_mul_f32 v[72:73], v[72:73], v[62:63] op_sel_hi:[1,0]
    v_cvt_pk_bf16_f32 v244, v72, v73
    v_pk_mul_f32 v[74:75], v[74:75], v[62:63] op_sel_hi:[1,0]
    v_cvt_pk_bf16_f32 v245, v74, v75
    v_pk_mul_f32 v[76:77], v[76:77], v[62:63] op_sel_hi:[1,0]
    v_cvt_pk_bf16_f32 v246, v76, v77
    v_cndmask_b32 v246, 0, v246, s[20:21]
    v_pk_mul_f32 v[78:79], v[78:79], v[62:63] op_sel_hi:[1,0]
    v_cvt_pk_bf16_f32 v247, v78, v79
    buffer_store_dwordx4 v[244:247], v2, s[36:39], s23 offen offset:1024 sc1
    v_pk_mul_f32 v[80:81], v[80:81], v[62:63] op_sel_hi:[1,0]
    v_cvt_pk_bf16_f32 v248, v80, v81
    v_pk_mul_f32 v[82:83], v[82:83], v[62:63] op_sel_hi:[1,0]
    v_cvt_pk_bf16_f32 v249, v82, v83
    v_pk_mul_f32 v[84:85], v[84:85], v[62:63] op_sel_hi:[1,0]
    v_cvt_pk_bf16_f32 v250, v84, v85
    v_pk_mul_f32 v[86:87], v[86:87], v[62:63] op_sel_hi:[1,0]
    v_cvt_pk_bf16_f32 v251, v86, v87
    buffer_store_dwordx4 v[248:251], v2, s[36:39], s24 offen offset:0 sc1
    v_pk_mul_f32 v[88:89], v[88:89], v[62:63] op_sel_hi:[1,0]
    v_cvt_pk_bf16_f32 v252, v88, v89
    v_pk_mul_f32 v[90:91], v[90:91], v[62:63] op_sel_hi:[1,0]
    v_cvt_pk_bf16_f32 v253, v90, v91
    v_pk_mul_f32 v[92:93], v[92:93], v[62:63] op_sel_hi:[1,0]
    v_cvt_pk_bf16_f32 v254, v92, v93
    v_pk_mul_f32 v[94:95], v[94:95], v[62:63] op_sel_hi:[1,0]
    v_cvt_pk_bf16_f32 v255, v94, v95
    buffer_store_dwordx4 v[252:255], v2, s[36:39], s24 offen offset:1024 sc1
    s_branch L_join
L_typeV:
    s_waitcnt vmcnt(11)
    ds_read_b128 v[128:131], v10 offset:0
    ds_read_b128 v[132:135], v11 offset:0
    ds_read_b128 v[136:139], v12 offset:0
    ds_read_b128 v[140:143], v13 offset:0
    s_waitcnt vmcnt(9)
    ds_write_b128 v21, v[248:251]
    ds_write_b128 v21, v[252:255] offset:24576
    s_waitcnt lgkmcnt(2)
    v_dot2c_f32_bf16 v61, v128, v128
    v_dot2c_f32_bf16 v60, s22, v128
    v_dot2c_f32_bf16 v63, v129, v129
    v_dot2c_f32_bf16 v62, s22, v129
    v_dot2c_f32_bf16 v61, v130, v130
    v_dot2c_f32_bf16 v60, s22, v130
    v_dot2c_f32_bf16 v63, v131, v131
    v_dot2c_f32_bf16 v62, s22, v131
    v_dot2c_f32_bf16 v61, v132, v132
    v_dot2c_f32_bf16 v60, s22, v132
    v_dot2c_f32_bf16 v63, v133, v133
    v_dot2c_f32_bf16 v62, s22, v133
    v_dot2c_f32_bf16 v61, v134, v134
    v_dot2c_f32_bf16 v60, s22, v134
    v_dot2c_f32_bf16 v63, v135, v135
    v_dot2c_f32_bf16 v62, s22, v135
    v_dot2c_f32_bf16 v61, v136, v136
    v_dot2c_f32_bf16 v60, s22, v136
    v_dot2c_f32_bf16 v63, v137, v137
    v_dot2c_f32_bf16 v62, s22, v137
    v_dot2c_f32_bf16 v61, v138, v138
    v_dot2c_f32_bf16 v60, s22, v138
    v_dot2c_f32_bf16 v63, v139, v139
    v_dot2c_f32_bf16 v62, s22, v139
    v_dot2c_f32_bf16 v61, v140, v140
    v_dot2c_f32_bf16 v60, s22, v140
    v_dot2c_f32_bf16 v63, v141, v141
    v_dot2c_f32_bf16 v62, s22, v141
    v_dot2c_f32_bf16 v61, v142, v142
    v_dot2c_f32_bf16 v60, s22, v142
    v_dot2c_f32_bf16 v63, v143, v143
    v_dot2c_f32_bf16 v62, s22, v143
    s_waitcnt vmcnt(7) lgkmcnt(0)
    s_barrier
    ds_read_b64_tr_b16 a[224:225], v16 offset:0
    ds_read_b64_tr_b16 a[226:227], v16 offset:512
    ds_read_b64_tr_b16 a[228:229], v17 offset:0
    ds_read_b64_tr_b16 a[230:231], v17 offset:512
    ds_read_b64_tr_b16 a[192:193], v14 offset:0
    ds_read_b64_tr_b16 a[194:195], v14 offset:512
    ds_read_b64_tr_b16 a[196:197], v15 offset:0
    ds_read_b64_tr_b16 a[198:199], v15 offset:512
    ds_read_b64_tr_b16 a[200:201], v14 offset:2048
    ds_read_b64_tr_b16 a[202:203], v14 offset:2560
    ds_read_b64_tr_b16 a[204:205], v15 offset:2048
    ds_read_b64_tr_b16 a[206:207], v15 offset:2560
    s_waitcnt lgkmcnt(8)
    v_mfma_f32_16x16x32_bf16 v[32:35], v[44:47], a[224:227], 0
    s_add_u32 m0, s17, 8192
    v_mfma_f32_16x16x32_bf16 v[36:39], v[44:47], a[228:231], 0
    buffer_load_dwordx4 v3, s[28:31], s71 offen offset:0 lds
    s_waitcnt lgkmcnt(4)
    v_mfma_f32_32x32x16_bf16 v[64:79], v[128:131], a[192:195], 0
    ds_read_b64_tr_b16 a[208:209], v14 offset:4096
    ds_read_b64_tr_b16 a[210:211], v14 offset:4608
    buffer_load_dwordx4 v4, s[28:31], s71 offen offset:1024 lds
    v_mfma_f32_32x32x16_bf16 v[80:95], v[128:131], a[196:199], 0
    s_waitcnt lgkmcnt(2)
    ds_read_b64_tr_b16 a[212:213], v15 offset:4096
    ds_read_b64_tr_b16 a[214:215], v15 offset:4608
    buffer_load_dwordx4 v5, s[28:31], s71 offen offset:2048 lds
    v_mfma_f32_32x32x16_bf16 v[64:79], v[132:135], a[200:203], v[64:79]
    ds_read_b64_tr_b16 a[216:217], v14 offset:6144
    ds_read_b64_tr_b16 a[218:219], v14 offset:6656
    buffer_load_dwordx4 v6, s[28:31], s71 offen offset:3072 lds
    v_mfma_f32_32x32x16_bf16 v[80:95], v[132:135], a[204:207], v[80:95]
    s_waitcnt lgkmcnt(2)
    ds_read_b64_tr_b16 a[220:221], v15 offset:6144
    ds_read_b64_tr_b16 a[222:223], v15 offset:6656
    s_add_u32 m0, s80, 16384
    s_mov_b64 exec, s[18:19]
    buffer_load_dwordx4 v7, s[32:35], s16 offen lds
    buffer_load_dwordx4 v8, s[32:35], s16 offen offset:1024 lds
    s_mov_b64 exec, -1
    s_waitcnt vmcnt(6)
    s_barrier
    v_mfma_f32_32x32x16_bf16 v[64:79], v[136:139], a[208:211], v[64:79]
    ds_read_b128 v[144:147], v10 offset:4096
    ds_read_b128 v[148:151], v11 offset:4096
    ds_read_b128 v[152:155], v12 offset:4096
    ds_read_b128 v[156:159], v13 offset:4096
    s_add_u32 m0, s17, 12288
    s_nop 0
    buffer_load_dwordx4 v3, s[28:31], s72 offen offset:0 lds
    v_mfma_f32_32x32x16_bf16 v[80:95], v[136:139], a[212:215], v[80:95]
    s_waitcnt lgkmcnt(4)
    ds_read_b64_tr_b16 a[224:225], v16 offset:8192
    ds_read_b64_tr_b16 a[226:227], v16 offset:8704
    ds_read_b64_tr_b16 a[228:229], v17 offset:8192
    ds_read_b64_tr_b16 a[230:231], v17 offset:8704
    buffer_load_dwordx4 v4, s[28:31], s72 offen offset:1024 lds
    v_mfma_f32_32x32x16_bf16 v[64:79], v[140:143], a[216:219], v[64:79]
    ds_read_b64_tr_b16 a[192:193], v14 offset:8192
    ds_read_b64_tr_b16 a[194:195], v14 offset:8704
    ds_read_b64_tr_b16 a[196:197], v15 offset:8192
    ds_read_b64_tr_b16 a[198:199], v15 offset:8704
    buffer_load_dwordx4 v5, s[28:31], s72 offen offset:2048 lds
    v_mfma_f32_32x32x16_bf16 v[80:95], v[140:143], a[220:223], v[80:95]
    ds_read_b64_tr_b16 a[200:201], v14 offset:10240
    ds_read_b64_tr_b16 a[202:203], v14 offset:10752
    ds_read_b64_tr_b16 a[204:205], v15 offset:10240
    ds_read_b64_tr_b16 a[206:207], v15 offset:10752
    buffer_load_dwordx4 v6, s[28:31], s72 offen offset:3072 lds
    s_waitcnt lgkmcnt(12)
    v_dot2c_f32_bf16 v61, v144, v144
    v_dot2c_f32_bf16 v60, s22, v144
    v_dot2c_f32_bf16 v63, v145, v145
    v_dot2c_f32_bf16 v62, s22, v145
    v_dot2c_f32_bf16 v61, v146, v146
    v_dot2c_f32_bf16 v60, s22, v146
    v_dot2c_f32_bf16 v63, v147, v147
    v_dot2c_f32_bf16 v62, s22, v147
    v_dot2c_f32_bf16 v61, v148, v148
    v_dot2c_f32_bf16 v60, s22, v148
    v_dot2c_f32_bf16 v63, v149, v149
    v_dot2c_f32_bf16 v62, s22, v149
    v_dot2c_f32_bf16 v61, v150, v150
    v_dot2c_f32_bf16 v60, s22, v150
    v_dot2c_f32_bf16 v63, v151, v151
    v_dot2c_f32_bf16 v62, s22, v151
    v_dot2c_f32_bf16 v61, v152, v152
    v_dot2c_f32_bf16 v60, s22, v152
    v_dot2c_f32_bf16 v63, v153, v153
    v_dot2c_f32_bf16 v62, s22, v153
    v_dot2c_f32_bf16 v61, v154, v154
    v_dot2c_f32_bf16 v60, s22, v154
    v_dot2c_f32_bf16 v63, v155, v155
    v_dot2c_f32_bf16 v62, s22, v155
    v_dot2c_f32_bf16 v61, v156, v156
    v_dot2c_f32_bf16 v60, s22, v156
    v_dot2c_f32_bf16 v63, v157, v157
    v_dot2c_f32_bf16 v62, s22, v157
    v_dot2c_f32_bf16 v61, v158, v158
    v_dot2c_f32_bf16 v60, s22, v158
    v_dot2c_f32_bf16 v63, v159, v159
    v_dot2c_f32_bf16 v62, s22, v159
    s_waitcnt lgkmcnt(8)
    v_mfma_f32_16x16x32_bf16 v[32:35], v[44:47], a[224:227], v[32:35]
    s_add_u32 m0, s80, 24576
    s_mov_b64 exec, s[18:19]
    buffer_load_dwordx4 v7, s[32:35], s26 offen lds
    buffer_load_dwordx4 v8, s[32:35], s26 offen offset:1024 lds
    s_mov_b64 exec, -1
    v_mfma_f32_16x16x32_bf16 v[36:39], v[44:47], a[228:231], v[36:39]
    s_waitcnt lgkmcnt(4)
    v_mfma_f32_32x32x16_bf16 v[64:79], v[144:147], a[192:195], v[64:79]
    ds_read_b64_tr_b16 a[208:209], v14 offset:12288
    ds_read_b64_tr_b16 a[210:211], v14 offset:12800
    v_mfma_f32_32x32x16_bf16 v[80:95], v[144:147], a[196:199], v[80:95]
    s_waitcnt lgkmcnt(2)
    ds_read_b64_tr_b16 a[212:213], v15 offset:12288
    ds_read_b64_tr_b16 a[214:215], v15 offset:12800
    v_mfma_f32_32x32x16_bf16 v[64:79], v[148:151], a[200:203], v[64:79]
    ds_read_b64_tr_b16 a[216:217], v14 offset:14336
    ds_read_b64_tr_b16 a[218:219], v14 offset:14848
    v_mfma_f32_32x32x16_bf16 v[80:95], v[148:151], a[204:207], v[80:95]
    s_waitcnt lgkmcnt(2)
    ds_read_b64_tr_b16 a[220:221], v15 offset:14336
    ds_read_b64_tr_b16 a[222:223], v15 offset:14848
    s_waitcnt vmcnt(6)
    s_cmp_eq_u32 s86, 0
    s_cbranch_scc1 L_sgA1
L_sgA_ret1:
    s_barrier
    v_mfma_f32_32x32x16_bf16 v[64:79], v[152:155], a[208:211], v[64:79]
    ds_read_b128 v[160:163], v10 offset:8192
    ds_read_b128 v[164:167], v11 offset:8192
    ds_read_b128 v[168:171], v12 offset:8192
    ds_read_b128 v[172:175], v13 offset:8192
    s_add_u32 m0, s17, 0
    s_nop 0
    buffer_load_dwordx4 v3, s[28:31], s73 offen offset:0 lds
    v_mfma_f32_32x32x16_bf16 v[80:95], v[152:155], a[212:215], v[80:95]
    s_waitcnt lgkmcnt(4)
    ds_read_b64_tr_b16 a[224:225], v16 offset:16384
    ds_read_b64_tr_b16 a[226:227], v16 offset:16896
    ds_read_b64_tr_b16 a[228:229], v17 offset:16384
    ds_read_b64_tr_b16 a[230:231], v17 offset:16896
    buffer_load_dwordx4 v4, s[28:31], s73 offen offset:1024 lds
    v_mfma_f32_32x32x16_bf16 v[64:79], v[156:159], a[216:219], v[64:79]
    ds_read_b64_tr_b16 a[192:193], v14 offset:16384
    ds_read_b64_tr_b16 a[194:195], v14 offset:16896
    ds_read_b64_tr_b16 a[196:197], v15 offset:16384
    ds_read_b64_tr_b16 a[198:199], v15 offset:16896
    buffer_load_dwordx4 v5, s[28:31], s73 offen offset:2048 lds
    v_mfma_f32_32x32x16_bf16 v[80:95], v[156:159], a[220:223], v[80:95]
    ds_read_b64_tr_b16 a[200:201], v14 offset:18432
    ds_read_b64_tr_b16 a[202:203], v14 offset:18944
    ds_read_b64_tr_b16 a[204:205], v15 offset:18432
    ds_read_b64_tr_b16 a[206:207], v15 offset:18944
    buffer_load_dwordx4 v6, s[28:31], s73 offen offset:3072 lds
    s_waitcnt lgkmcnt(12)
    v_dot2c_f32_bf16 v61, v160, v160
    v_dot2c_f32_bf16 v60, s22, v160
    v_dot2c_f32_bf16 v63, v161, v161
    v_dot2c_f32_bf16 v62, s22, v161
    v_dot2c_f32_bf16 v61, v162, v162
    v_dot2c_f32_bf16 v60, s22, v162
    v_dot2c_f32_bf16 v63, v163, v163
    v_dot2c_f32_bf16 v62, s22, v163
    v_dot2c_f32_bf16 v61, v164, v164
    v_dot2c_f32_bf16 v60, s22, v164
    v_dot2c_f32_bf16 v63, v165, v165
    v_dot2c_f32_bf16 v62, s22, v165
    v_dot2c_f32_bf16 v61, v166, v166
    v_dot2c_f32_bf16 v60, s22, v166
    v_dot2c_f32_bf16 v63, v167, v167
    v_dot2c_f32_bf16 v62, s22, v167
    v_dot2c_f32_bf16 v61, v168, v168
    v_dot2c_f32_bf16 v60, s22, v168
    v_dot2c_f32_bf16 v63, v169, v169
    v_dot2c_f32_bf16 v62, s22, v169
    v_dot2c_f32_bf16 v61, v170, v170
    v_dot2c_f32_bf16 v60, s22, v170
    v_dot2c_f32_bf16 v63, v171, v171
    v_dot2c_f32_bf16 v62, s22, v171
    v_dot2c_f32_bf16 v61, v172, v172
    v_dot2c_f32_bf16 v60, s22, v172
    v_dot2c_f32_bf16 v63, v173, v173
    v_dot2c_f32_bf16 v62, s22, v173
    v_dot2c_f32_bf16 v61, v174, v174
    v_dot2c_f32_bf16 v60, s22, v174
    v_dot2c_f32_bf16 v63, v175, v175
    v_dot2c_f32_bf16 v62, s22, v175
    s_waitcnt lgkmcnt(8)
    v_mfma_f32_16x16x32_bf16 v[32:35], v[44:47], a[224:227], v[32:35]
    s_add_u32 m0, s80, 32768
    s_mov_b64 exec, s[18:19]
    buffer_load_dwordx4 v7, s[32:35], s27 offen lds
    buffer_load_dwordx4 v8, s[32:35], s27 offen offset:1024 lds
    s_mov_b64 exec, -1
    v_mfma_f32_16x16x32_bf16 v[36:39], v[44:47], a[228:231], v[36:39]
    s_waitcnt lgkmcnt(4)
    v_mfma_f32_32x32x16_bf16 v[64:79], v[160:163], a[192:195], v[64:79]
    ds_read_b64_tr_b16 a[208:209], v14 offset:20480
    ds_read_b64_tr_b16 a[210:211], v14 offset:20992
    v_mfma_f32_32x32x16_bf16 v[80:95], v[160:163], a[196:199], v[80:95]
    s_waitcnt lgkmcnt(2)
    ds_read_b64_tr_b16 a[212:213], v15 offset:20480
    ds_read_b64_tr_b16 a[214:215], v15 offset:20992
    v_mfma_f32_32x32x16_bf16 v[64:79], v[164:167], a[200:203], v[64:79]
    ds_read_b64_tr_b16 a[216:217], v14 offset:22528
    ds_read_b64_tr_b16 a[218:219], v14 offset:23040
    v_mfma_f32_32x32x16_bf16 v[80:95], v[164:167], a[204:207], v[80:95]
    s_waitcnt lgkmcnt(2)
    ds_read_b64_tr_b16 a[220:221], v15 offset:22528
    ds_read_b64_tr_b16 a[222:223], v15 offset:23040
    s_waitcnt vmcnt(6)
    s_barrier
    v_mfma_f32_32x32x16_bf16 v[64:79], v[168:171], a[208:211], v[64:79]
    ds_read_b128 v[176:179], v10 offset:12288
    ds_read_b128 v[180:183], v11 offset:12288
    ds_read_b128 v[184:187], v12 offset:12288
    ds_read_b128 v[188:191], v13 offset:12288
    s_add_u32 m0, s17, 4096
    s_nop 0
    buffer_load_dwordx4 v3, s[28:31], s74 offen offset:0 lds
    v_mfma_f32_32x32x16_bf16 v[80:95], v[168:171], a[212:215], v[80:95]
    s_waitcnt lgkmcnt(4)
    ds_read_b64_tr_b16 a[224:225], v16 offset:24576
    ds_read_b64_tr_b16 a[226:227], v16 offset:25088
    ds_read_b64_tr_b16 a[228:229], v17 offset:24576
    ds_read_b64_tr_b16 a[230:231], v17 offset:25088
    buffer_load_dwordx4 v4, s[28:31], s74 offen offset:1024 lds
    v_mfma_f32_32x32x16_bf16 v[64:79], v[172:175], a[216:219], v[64:79]
    ds_read_b64_tr_b16 a[192:193], v14 offset:24576
    ds_read_b64_tr_b16 a[194:195], v14 offset:25088
    ds_read_b64_tr_b16 a[196:197], v15 offset:24576
    ds_read_b64_tr_b16 a[198:199], v15 offset:25088
    buffer_load_dwordx4 v5, s[28:31], s74 offen offset:2048 lds
    v_mfma_f32_32x32x16_bf16 v[80:95], v[172:175], a[220:223], v[80:95]
    ds_read_b64_tr_b16 a[200:201], v14 offset:26624
L_tch1:
    s_cbranch_execz L_tch5
    ds_read_b64_tr_b16 a[202:203], v14 offset:27136
    ds_read_b64_tr_b16 a[204:205], v15 offset:26624
    ds_read_b64_tr_b16 a[206:207], v15 offset:27136
    buffer_load_dwordx4 v6, s[28:31], s74 offen offset:3072 lds
    s_waitcnt lgkmcnt(12)
    v_dot2c_f32_bf16 v61, v176, v176
    v_dot2c_f32_bf16 v60, s22, v176
    v_dot2c_f32_bf16 v63, v177, v177
    v_dot2c_f32_bf16 v62, s22, v177
    v_dot2c_f32_bf16 v61, v178, v178
    v_dot2c_f32_bf16 v60, s22, v178
    v_dot2c_f32_bf16 v63, v179, v179
    v_dot2c_f32_bf16 v62, s22, v179
    v_dot2c_f32_bf16 v61, v180, v180
    v_dot2c_f32_bf16 v60, s22, v180
    v_dot2c_f32_bf16 v63, v181, v181
    v_dot2c_f32_bf16 v62, s22, v181
    v_dot2c_f32_bf16 v61, v182, v182
    v_dot2c_f32_bf16 v60, s22, v182
    v_dot2c_f32_bf16 v63, v183, v183
    v_dot2c_f32_bf16 v62, s22, v183
    v_dot2c_f32_bf16 v61, v184, v184
    v_dot2c_f32_bf16 v60, s22, v184
    v_dot2c_f32_bf16 v63, v185, v185
    v_dot2c_f32_bf16 v62, s22, v185
    v_dot2c_f32_bf16 v61, v186, v186
    v_dot2c_f32_bf16 v60, s22, v186
    v_dot2c_f32_bf16 v63, v187, v187
    v_dot2c_f32_bf16 v62, s22, v187
    v_dot2c_f32_bf16 v61, v188, v188
    v_dot2c_f32_bf16 v60, s22, v188
    v_dot2c_f32_bf16 v63, v189, v189
    v_dot2c_f32_bf16 v62, s22, v189
    v_dot2c_f32_bf16 v61, v190, v190
    v_dot2c_f32_bf16 v60, s22, v190
    v_dot2c_f32_bf16 v63, v191, v191
    v_dot2c_f32_bf16 v62, s22, v191
    s_waitcnt lgkmcnt(8)
    v_mfma_f32_16x16x32_bf16 v[32:35], v[44:47], a[224:227], v[32:35]
    s_add_u32 m0, s80, 40960
    s_mov_b64 exec, s[18:19]
    buffer_load_dwordx4 v7, s[32:35], s84 offen lds
    buffer_load_dwordx4 v8, s[32:35], s84 offen offset:1024 lds
    s_mov_b64 exec, -1
    v_mfma_f32_16x16x32_bf16 v[36:39], v[44:47], a[228:231], v[36:39]
    s_waitcnt lgkmcnt(4)
    v_mfma_f32_32x32x16_bf16 v[64:79], v[176:179], a[192:195], v[64:79]
    ds_read_b64_tr_b16 a[208:209], v14 offset:28672
    ds_read_b64_tr_b16 a[210:211], v14 offset:29184
    v_mfma_f32_32x32x16_bf16 v[80:95], v[176:179], a[196:199], v[80:95]
    s_waitcnt lgkmcnt(2)
    ds_read_b64_tr_b16 a[212:213], v15 offset:28672
    ds_read_b64_tr_b16 a[214:215], v15 offset:29184
    v_mfma_f32_32x32x16_bf16 v[64:79], v[180:183], a[200:203], v[64:79]
    ds_read_b64_tr_b16 a[216:217], v14 offset:30720
    ds_read_b64_tr_b16 a[218:219], v14 offset:31232
    v_mfma_f32_32x32x16_bf16 v[80:95], v[180:183], a[204:207], v[80:95]
    s_waitcnt lgkmcnt(2)
    ds_read_b64_tr_b16 a[220:221], v15 offset:30720
    ds_read_b64_tr_b16 a[222:223], v15 offset:31232
    s_waitcnt vmcnt(6)
    s_barrier
    v_mfma_f32_32x32x16_bf16 v[64:79], v[184:187], a[208:211], v[64:79]
    ds_read_b128 v[192:195], v10 offset:0
    ds_read_b128 v[196:199], v11 offset:0
    ds_read_b128 v[200:203], v12 offset:0
    ds_read_b128 v[204:207], v13 offset:0
    s_add_u32 m0, s17, 8192
    s_nop 0
    buffer_load_dwordx4 v3, s[28:31], s75 offen offset:0 lds
    v_mfma_f32_32x32x16_bf16 v[80:95], v[184:187], a[212:215], v[80:95]
    s_waitcnt lgkmcnt(4)
    ds_read_b64_tr_b16 a[224:225], v16 offset:32768
    ds_read_b64_tr_b16 a[226:227], v16 offset:33280
    ds_read_b64_tr_b16 a[228:229], v17 offset:32768
    ds_read_b64_tr_b16 a[230:231], v17 offset:33280
    buffer_load_dwordx4 v4, s[28:31], s75 offen offset:1024 lds
    v_mfma_f32_32x32x16_bf16 v[64:79], v[188:191], a[216:219], v[64:79]
    ds_read_b64_tr_b16 a[192:193], v14 offset:32768
    ds_read_b64_tr_b16 a[194:195], v14 offset:33280
    ds_read_b64_tr_b16 a[196:197], v15 offset:32768
    ds_read_b64_tr_b16 a[198:199], v15 offset:33280
    buffer_load_dwordx4 v5, s[28:31], s75 offen offset:2048 lds
    v_mfma_f32_32x32x16_bf16 v[80:95], v[188:191], a[220:223], v[80:95]
    ds_read_b64_tr_b16 a[200:201], v14 offset:34816
    ds_read_b64_tr_b16 a[202:203], v14 offset:35328
    ds_read_b64_tr_b16 a[204:205], v15 offset:34816
    ds_read_b64_tr_b16 a[206:207], v15 offset:35328
    buffer_load_dwordx4 v6, s[28:31], s75 offen offset:3072 lds
    s_waitcnt lgkmcnt(12)
    v_dot2c_f32_bf16 v61, v192, v192
    v_dot2c_f32_bf16 v60, s22, v192
    v_dot2c_f32_bf16 v63, v193, v193
    v_dot2c_f32_bf16 v62, s22, v193
    v_dot2c_f32_bf16 v61, v194, v194
    v_dot2c_f32_bf16 v60, s22, v194
    v_dot2c_f32_bf16 v63, v195, v195
    v_dot2c_f32_bf16 v62, s22, v195
    v_dot2c_f32_bf16 v61, v196, v196
    v_dot2c_f32_bf16 v60, s22, v196
    v_dot2c_f32_bf16 v63, v197, v197
    v_dot2c_f32_bf16 v62, s22, v197
    v_dot2c_f32_bf16 v61, v198, v198
    v_dot2c_f32_bf16 v60, s22, v198
    v_dot2c_f32_bf16 v63, v199, v199
    v_dot2c_f32_bf16 v62, s22, v199
    v_dot2c_f32_bf16 v61, v200, v200
    v_dot2c_f32_bf16 v60, s22, v200
    v_dot2c_f32_bf16 v63, v201, v201
    v_dot2c_f32_bf16 v62, s22, v201
    v_dot2c_f32_bf16 v61, v202, v202
    v_dot2c_f32_bf16 v60, s22, v202
    v_dot2c_f32_bf16 v63, v203, v203
    v_dot2c_f32_bf16 v62, s22, v203
    v_dot2c_f32_bf16 v61, v204, v204
    v_dot2c_f32_bf16 v60, s22, v204
    v_dot2c_f32_bf16 v63, v205, v205
    v_dot2c_f32_bf16 v62, s22, v205
    v_dot2c_f32_bf16 v61, v206, v206
    v_dot2c_f32_bf16 v60, s22, v206
    v_dot2c_f32_bf16 v63, v207, v207
    v_dot2c_f32_bf16 v62, s22, v207
    s_waitcnt lgkmcnt(8)
    v_mfma_f32_16x16x32_bf16 v[32:35], v[44:47], a[224:227], v[32:35]
    buffer_load_dword v22, v31, s[44:47], 0 offen sc1
    v_mfma_f32_16x16x32_bf16 v[36:39], v[44:47], a[228:231], v[36:39]
    buffer_load_dword a1, v2, s[36:39], s25 offen
    s_waitcnt lgkmcnt(4)
    v_mfma_f32_32x32x16_bf16 v[64:79], v[192:195], a[192:195], v[64:79]
    ds_read_b64_tr_b16 a[208:209], v14 offset:36864
    ds_read_b64_tr_b16 a[210:211], v14 offset:37376
    s_add_u32 m0, s80, 49152
    s_mov_b64 exec, s[18:19]
    buffer_load_dwordx4 v7, s[32:35], s87 offen lds
    buffer_load_dwordx4 v8, s[32:35], s87 offen offset:1024 lds
    s_mov_b64 exec, -1
    v_mfma_f32_32x32x16_bf16 v[80:95], v[192:195], a[196:199], v[80:95]
    s_waitcnt lgkmcnt(2)
    ds_read_b64_tr_b16 a[212:213], v15 offset:36864
    ds_read_b64_tr_b16 a[214:215], v15 offset:37376
    v_mfma_f32_32x32x16_bf16 v[64:79], v[196:199], a[200:203], v[64:79]
    ds_read_b64_tr_b16 a[216:217], v14 offset:38912
    ds_read_b64_tr_b16 a[218:219], v14 offset:39424
    v_mfma_f32_32x32x16_bf16 v[80:95], v[196:199], a[204:207], v[80:95]
    s_waitcnt lgkmcnt(2)
    ds_read_b64_tr_b16 a[220:221], v15 offset:38912
    ds_read_b64_tr_b16 a[222:223], v15 offset:39424
    s_waitcnt vmcnt(8)
    s_barrier
    v_mfma_f32_32x32x16_bf16 v[64:79], v[200:203], a[208:211], v[64:79]
    ds_read_b128 v[208:211], v10 offset:4096
    ds_read_b128 v[212:215], v11 offset:4096
    ds_read_b128 v[216:219], v12 offset:4096
    ds_read_b128 v[220:223], v13 offset:4096
    s_add_u32 m0, s17, 19456
    v_mfma_f32_32x32x16_bf16 v[80:95], v[200:203], a[212:215], v[80:95]
    s_waitcnt lgkmcnt(4)
    ds_read_b64_tr_b16 a[224:225], v16 offset:40960
    ds_read_b64_tr_b16 a[226:227], v16 offset:41472
    ds_read_b64_tr_b16 a[228:229], v17 offset:40960
    ds_read_b64_tr_b16 a[230:231], v17 offset:41472
    v_mfma_f32_32x32x16_bf16 v[64:79], v[204:207], a[216:219], v[64:79]
    ds_read_b64_tr_b16 a[192:193], v14 offset:40960
    ds_read_b64_tr_b16 a[194:195], v14 offset:41472
    ds_read_b64_tr_b16 a[196:197], v15 offset:40960
    ds_read_b64_tr_b16 a[198:199], v15 offset:41472
    buffer_load_dwordx4 v9, s[32:35], s26 offen lds
    v_mfma_f32_32x32x16_bf16 v[80:95], v[204:207], a[220:223], v[80:95]
    ds_read_b64_tr_b16 a[200:201], v14 offset:43008
    ds_read_b64_tr_b16 a[202:203], v14 offset:43520
    ds_read_b64_tr_b16 a[204:205], v15 offset:43008
    ds_read_b64_tr_b16 a[206:207], v15 offset:43520
    s_waitcnt lgkmcnt(12)
    v_dot2c_f32_bf16 v61, v208, v208
    v_dot2c_f32_bf16 v60, s22, v208
    v_dot2c_f32_bf16 v63, v209, v209
    v_dot2c_f32_bf16 v62, s22, v209
    v_dot2c_f32_bf16 v61, v210, v210
    v_dot2c_f32_bf16 v60, s22, v210
    v_dot2c_f32_bf16 v63, v211, v211
    v_dot2c_f32_bf16 v62, s22, v211
    v_dot2c_f32_bf16 v61, v212, v212
    v_dot2c_f32_bf16 v60, s22, v212
    v_dot2c_f32_bf16 v63, v213, v213
    v_dot2c_f32_bf16 v62, s22, v213
    v_dot2c_f32_bf16 v61, v214, v214
    v_dot2c_f32_bf16 v60, s22, v214
    v_dot2c_f32_bf16 v63, v215, v215
    v_dot2c_f32_bf16 v62, s22, v215
    v_dot2c_f32_bf16 v61, v216, v216
    v_dot2c_f32_bf16 v60, s22, v216
    v_dot2c_f32_bf16 v63, v217, v217
    v_dot2c_f32_bf16 v62, s22, v217
    v_dot2c_f32_bf16 v61, v218, v218
    v_dot2c_f32_bf16 v60, s22, v218
    v_dot2c_f32_bf16 v63, v219, v219
    v_dot2c_f32_bf16 v62, s22, v219
    v_dot2c_f32_bf16 v61, v220, v220
    v_dot2c_f32_bf16 v60, s22, v220
    v_dot2c_f32_bf16 v63, v221, v221
    v_dot2c_f32_bf16 v62, s22, v221
    v_dot2c_f32_bf16 v61, v222, v222
    v_dot2c_f32_bf16 v60, s22, v222
    v_dot2c_f32_bf16 v63, v223, v223
    v_dot2c_f32_bf16 v62, s22, v223
    s_waitcnt lgkmcnt(8)
    v_mfma_f32_16x16x32_bf16 v[32:35], v[44:47], a[224:227], v[32:35]
    s_add_u32 m0, s17, 20480
    v_mfma_f32_16x16x32_bf16 v[36:39], v[44:47], a[228:231], v[36:39]
    buffer_load_dwordx4 v9, s[32:35], s27 offen lds
    s_waitcnt lgkmcnt(4)
    v_mfma_f32_32x32x16_bf16 v[64:79], v[208:211], a[192:195], v[64:79]
    ds_read_b64_tr_b16 a[208:209], v14 offset:45056
    ds_read_b64_tr_b16 a[210:211], v14 offset:45568
    ds_read_b64_tr_b16 a[212:213], v15 offset:45056
    ds_read_b64_tr_b16 a[214:215], v15 offset:45568
    s_waitcnt vmcnt(6)
    v_mfma_f32_32x32x16_bf16 v[80:95], v[208:211], a[196:199], v[80:95]
    s_waitcnt lgkmcnt(4)
    ds_read_b128 v[224:227], v10 offset:8192
    ds_read_b128 v[228:231], v11 offset:8192
    ds_read_b128 v[232:235], v12 offset:8192
    ds_read_b128 v[236:239], v13 offset:8192
    v_mfma_f32_32x32x16_bf16 v[64:79], v[212:215], a[200:203], v[64:79]
    ds_read_b64_tr_b16 a[216:217], v14 offset:47104
    ds_read_b64_tr_b16 a[218:219], v14 offset:47616
    v_mfma_f32_32x32x16_bf16 v[80:95], v[212:215], a[204:207], v[80:95]
    s_waitcnt lgkmcnt(6)
    ds_read_b64_tr_b16 a[220:221], v15 offset:47104
    ds_read_b64_tr_b16 a[222:223], v15 offset:47616
    s_waitcnt vmcnt(5)
    v_cmp_eq_u32 vcc, 0, v22
    s_waitcnt lgkmcnt(4)
    v_dot2c_f32_bf16 v61, v224, v224
    v_dot2c_f32_bf16 v60, s22, v224
    v_dot2c_f32_bf16 v63, v225, v225
    v_dot2c_f32_bf16 v62, s22, v225
    v_dot2c_f32_bf16 v61, v226, v226
    v_dot2c_f32_bf16 v60, s22, v226
    v_dot2c_f32_bf16 v63, v227, v227
    v_dot2c_f32_bf16 v62, s22, v227
    v_dot2c_f32_bf16 v61, v228, v228
    v_dot2c_f32_bf16 v60, s22, v228
    v_dot2c_f32_bf16 v63, v229, v229
    v_dot2c_f32_bf16 v62, s22, v229
    v_dot2c_f32_bf16 v61, v230, v230
    v_dot2c_f32_bf16 v60, s22, v230
    v_dot2c_f32_bf16 v63, v231, v231
    v_dot2c_f32_bf16 v62, s22, v231
    v_dot2c_f32_bf16 v61, v232, v232
    v_dot2c_f32_bf16 v60, s22, v232
    v_dot2c_f32_bf16 v63, v233, v233
    v_dot2c_f32_bf16 v62, s22, v233
    v_dot2c_f32_bf16 v61, v234, v234
    v_dot2c_f32_bf16 v60, s22, v234
    v_dot2c_f32_bf16 v63, v235, v235
    v_dot2c_f32_bf16 v62, s22, v235
    v_dot2c_f32_bf16 v61, v236, v236
    v_dot2c_f32_bf16 v60, s22, v236
    v_dot2c_f32_bf16 v63, v237, v237
    v_dot2c_f32_bf16 v62, s22, v237
    v_dot2c_f32_bf16 v61, v238, v238
    v_dot2c_f32_bf16 v60, s22, v238
    v_dot2c_f32_bf16 v63, v239, v239
    v_dot2c_f32_bf16 v62, s22, v239
    s_and_b32 s11, vcc_lo, 0xff
    s_cbranch_scc1 L_sigA1
L_sigA_ok1:
    v_mfma_f32_32x32x16_bf16 v[64:79], v[216:219], a[208:211], v[64:79]
    s_add_u32 m0, s17, 21504
    s_nop 0
    buffer_load_dwordx4 v9, s[32:35], s84 offen lds
    v_add_f32 v60, v60, v62
    v_add_f32 v61, v61, v63
    s_nop 1
    v_permlane32_swap_b32 v60, v61
    v_add_f32 v60, v60, v61
    v_mul_f32 v60, 0x3b124925, v60
    v_mov_b32 v61, v60
    v_mfma_f32_32x32x16_bf16 v[80:95], v[216:219], a[212:215], v[80:95]
    s_waitcnt lgkmcnt(0)
    s_mul_i32 s14, s3, 28672
    s_add_u32 m0, s17, 12288
    s_add_u32 s14, s14, s85
    v_permlane32_swap_b32 v60, v61
    v_fma_f32 v61, -v60, v60, v61
    v_cvt_pk_bf16_f32 v60, v60, v60
    v_max_f32 v61, 0, v61
    v_cvt_pk_bf16_f32 v61, v61, v61
    v_and_b32 v61, s81, v61
    v_mfma_f32_32x32x16_bf16 v[64:79], v[220:223], a[216:219], v[64:79]
    buffer_load_dwordx4 v3, s[28:31], s14 offen offset:0 lds
    v_add_f32 v61, 0x3727c5ac, v61
    v_cvt_pk_bf16_f32 v61, v61, v61
    v_and_b32 v61, s81, v61
    v_sqrt_f32 v61, v61
    v_xor_b32 v24, 0x80008000, v60
    v_cvt_pk_bf16_f32 v61, v61, v61
    v_mfma_f32_32x32x16_bf16 v[80:95], v[220:223], a[220:223], v[80:95]
    buffer_load_dwordx4 v4, s[28:31], s14 offen offset:1024 lds
    v_and_b32 v62, s81, v61
    v_bfi_b32 v21, s81, v61, v60
    v_rcp_f32 v62, v62
    v_bfi_b32 v25, s81, v61, v24
    v_cndmask_b32 v48, 0, v24, s[20:21]
    v_cndmask_b32 v49, 0, v25, s[20:21]
    buffer_store_dword v21, v27, s[36:39], s100 offen sc1
    s_waitcnt vmcnt(6)
    ds_read_b64_tr_b16 a[224:225], v16 offset:49152
    ds_read_b64_tr_b16 a[226:227], v16 offset:49664
    ds_read_b64_tr_b16 a[228:229], v17 offset:49152
    ds_read_b64_tr_b16 a[230:231], v17 offset:49664
    s_barrier
    ds_read_b64_tr_b16 a[192:193], v14 offset:49152
    ds_read_b64_tr_b16 a[194:195], v14 offset:49664
    ds_read_b64_tr_b16 a[200:201], v14 offset:51200
    ds_read_b64_tr_b16 a[202:203], v14 offset:51712
    ds_read_b64_tr_b16 a[208:209], v14 offset:53248
    ds_read_b64_tr_b16 a[210:211], v14 offset:53760
    ds_read_b64_tr_b16 a[216:217], v14 offset:55296
    ds_read_b64_tr_b16 a[218:219], v14 offset:55808
    v_mov_b32 v63, v62
    v_and_b32 v60, s81, v63
    v_sub_f32 v61, v63, v60
    v_lshrrev_b32 v60, 16, v60
    v_and_b32 v63, s81, v61
    v_sub_f32 v61, v61, v63
    v_or_b32 v60, v60, v63
    v_lshrrev_b32 v61, 16, v61
    v_cndmask_b32 v56, 0, v60, s[20:21]
    v_cndmask_b32 v57, 0, v61, s[20:21]
    s_waitcnt lgkmcnt(8)
    v_mfma_f32_16x16x32_bf16 v[32:35], v[44:47], a[224:227], v[32:35]
    v_mfma_f32_16x16x32_bf16 v[36:39], v[44:47], a[228:231], v[36:39]
    s_waitcnt lgkmcnt(6)
    v_mfma_f32_32x32x16_bf16 v[64:79], v[224:227], a[192:195], v[64:79]
    ds_read_b64_tr_b16 a[196:197], v15 offset:49152
    ds_read_b64_tr_b16 a[198:199], v15 offset:49664
    ds_read_b64_tr_b16 a[204:205], v15 offset:51200
    ds_read_b64_tr_b16 a[206:207], v15 offset:51712
    v_mfma_f32_32x32x16_bf16 v[112:127], v[56:59], v[52:55], 0
    s_waitcnt lgkmcnt(4)
    ds_write2st64_b32 v23, v32, v36 offset0:0 offset1:2
    v_mfma_f32_32x32x16_bf16 v[64:79], v[228:231], a[200:203], v[64:79]
    ds_read_b64_tr_b16 a[212:213], v15 offset:53248
    ds_read_b64_tr_b16 a[214:215], v15 offset:53760
    ds_read_b64_tr_b16 a[220:221], v15 offset:55296
    ds_read_b64_tr_b16 a[222:223], v15 offset:55808
    v_mfma_f32_32x32x16_bf16 v[64:79], v[232:235], a[208:211], v[64:79]
    s_add_u32 m0, s17, 22528
    s_nop 0
    buffer_load_dwordx4 v9, s[32:35], s87 offen lds
    v_mfma_f32_32x32x16_bf16 v[64:79], v[236:239], a[216:219], v[64:79]
    s_waitcnt lgkmcnt(4)
    s_barrier
    ds_read_b128 v[32:35], v26
    ds_read_b128 v[36:39], v26 offset:512
    s_waitcnt lgkmcnt(2)
    v_mfma_f32_32x32x16_bf16 v[80:95], v[224:227], a[196:199], v[80:95]
    v_mfma_f32_32x32x16_bf16 v[80:95], v[228:231], a[204:207], v[80:95]
    s_waitcnt lgkmcnt(0)
    v_add_f32 v32, v32, v33
    v_add_f32 v34, v34, v35
    v_add_f32 v32, v32, v34
    v_and_b32 v60, s81, v32
    v_sub_f32 v61, v32, v60
    v_lshrrev_b32 v60, 16, v60
    v_and_b32 v32, s81, v61
    v_sub_f32 v61, v61, v32
    v_or_b32 v52, v60, v32
    v_alignbit_b32 v53, v30, v61, 16
    v_add_f32 v36, v36, v37
    v_add_f32 v38, v38, v39
    v_mfma_f32_32x32x16_bf16 v[64:79], v[48:51], v[52:55], v[64:79]
    v_add_f32 v36, v36, v38
    v_and_b32 v60, s81, v36
    v_sub_f32 v61, v36, v60
    v_lshrrev_b32 v60, 16, v60
    v_and_b32 v36, s81, v61
    v_sub_f32 v61, v61, v36
    v_mfma_f32_32x32x16_bf16 v[80:95], v[232:235], a[212:215], v[80:95]
    v_or_b32 v56, v60, v36
    v_alignbit_b32 v57, v30, v61, 16
    v_mfma_f32_32x32x16_bf16 v[80:95], v[236:239], a[220:223], v[80:95]
    s_nop 1
    v_mul_f32 v64, v64, v112
    v_mul_f32 v65, v65, v113
    v_cvt_pk_bf16_f32 v240, v64, v65
    v_mul_f32 v66, v66, v114
    v_mul_f32 v67, v67, v115
    v_cvt_pk_bf16_f32 v241, v66, v67
    v_mfma_f32_32x32x16_bf16 v[80:95], v[48:51], v[56:59], v[80:95]
    v_mul_f32 v68, v68, v116
    v_mul_f32 v69, v69, v117
    v_cvt_pk_bf16_f32 v242, v68, v69
    v_pk_mul_f32 v[70:71], v[70:71], v[118:119]
    v_cvt_pk_bf16_f32 v243, v70, v71
    buffer_store_dwordx4 v[240:243], v2, s[36:39], s23 offen offset:0 sc1
    v_pk_mul_f32 v[72:73], v[72:73], v[120:121]
    v_cvt_pk_bf16_f32 v244, v72, v73
    v_pk_mul_f32 v[74:75], v[74:75], v[122:123]
    v_cvt_pk_bf16_f32 v245, v74, v75
    v_pk_mul_f32 v[76:77], v[76:77], v[124:125]
    v_cvt_pk_bf16_f32 v246, v76, v77
    v_pk_mul_f32 v[78:79], v[78:79], v[126:127]
    v_cvt_pk_bf16_f32 v247, v78, v79
    buffer_store_dwordx4 v[244:247], v2, s[36:39], s23 offen offset:1024 sc1
    v_pk_mul_f32 v[80:81], v[80:81], v[112:113]
    v_cvt_pk_bf16_f32 v248, v80, v81
    v_pk_mul_f32 v[82:83], v[82:83], v[114:115]
    v_cvt_pk_bf16_f32 v249, v82, v83
    v_pk_mul_f32 v[84:85], v[84:85], v[116:117]
    v_cvt_pk_bf16_f32 v250, v84, v85
    v_pk_mul_f32 v[86:87], v[86:87], v[118:119]
    v_cvt_pk_bf16_f32 v251, v86, v87
    buffer_store_dwordx4 v[248:251], v2, s[36:39], s24 offen offset:0 sc1
    v_pk_mul_f32 v[88:89], v[88:89], v[120:121]
    v_cvt_pk_bf16_f32 v252, v88, v89
    v_pk_mul_f32 v[90:91], v[90:91], v[122:123]
    v_cvt_pk_bf16_f32 v253, v90, v91
    v_pk_mul_f32 v[92:93], v[92:93], v[124:125]
    v_cvt_pk_bf16_f32 v254, v92, v93
    v_pk_mul_f32 v[94:95], v[94:95], v[126:127]
    v_cvt_pk_bf16_f32 v255, v94, v95
    buffer_store_dwordx4 v[252:255], v2, s[36:39], s24 offen offset:1024 sc1
L_join:
L_tch2:
    s_cbranch_execz L_tch6
    s_add_u32 m0, s17, 16384
    s_nop 0
    buffer_load_dwordx4 v9, s[32:35], s9 offen lds
    s_waitcnt vmcnt(5)
    ds_read_b64_tr_b16 a[224:225], v20 offset:19456
    ds_read_b64_tr_b16 a[226:227], v20 offset:19712
    ds_read_b64_tr_b16 a[228:229], v20 offset:20480
    ds_read_b64_tr_b16 a[230:231], v20 offset:20736
    ds_read_b64_tr_b16 a[232:233], v20 offset:21504
    ds_read_b64_tr_b16 a[234:235], v20 offset:21760
    ds_read_b64_tr_b16 a[236:237], v20 offset:22528
    ds_read_b64_tr_b16 a[238:239], v20 offset:22784
    s_barrier
    ds_read_b64_tr_b16 a[192:193], v18 offset:3072
    ds_read_b64_tr_b16 a[194:195], v18 offset:3328
    ds_read_b64_tr_b16 a[196:197], v18 offset:27648
    ds_read_b64_tr_b16 a[198:199], v18 offset:27904
    ds_read_b64_tr_b16 a[200:201], v19 offset:3072
    ds_read_b64_tr_b16 a[202:203], v19 offset:3328
    ds_read_b64_tr_b16 a[204:205], v19 offset:27648
    ds_read_b64_tr_b16 a[206:207], v19 offset:27904
    ds_read_b64_tr_b16 a[208:209], v18 offset:4096
    ds_read_b64_tr_b16 a[210:211], v18 offset:4352
    v_ashrrev_i32 v112, 31, v76
    s_lshl2_add_u32 s11, s7, s3
    v_or_b32 v112, 0x80000000, v112
    s_lshl_b32 s11, s11, 5
    v_xor_b32 v112, v112, v76
    s_sub_u32 s11, 2079, s11
    v_and_b32 v112, 0xfffff800, v112
    v_sub_u32 v116, s11, v1
    v_or_b32 v112, v112, v116
    v_max_u32 v112, 1, v112
    v_cndmask_b32 v112, v112, 0, s[20:21]
    s_lshl_b32 s13, s41, 6
    s_and_b32 s13, s13, 1023
    s_lshl_b32 s14, s4, 10
    s_add_u32 s100, s13, s98
    s_add_u32 s100, s100, s14
    v_and_b32 v78, 60, v31
    s_waitcnt lgkmcnt(10)
    v_mfma_f32_16x16x32_bf16 v[40:43], v[44:47], a[224:227], 0
    v_mfma_f32_16x16x32_bf16 v[40:43], v[44:47], a[228:231], v[40:43]
    v_mfma_f32_16x16x32_bf16 v[40:43], v[44:47], a[232:235], v[40:43]
    v_mfma_f32_16x16x32_bf16 v[40:43], v[44:47], a[236:239], v[40:43]
    s_waitcnt lgkmcnt(8)
    v_mfma_f32_32x32x16_bf16 v[96:111], a[192:195], v[176:179], 0
    s_waitcnt lgkmcnt(6)
    ds_read_b64_tr_b16 a[212:213], v18 offset:28672
    ds_read_b64_tr_b16 a[214:215], v18 offset:28928
    v_mov_b32 v113, v112
    v_mov_b32 v115, s10
    s_mul_i32 s11, s6, 12
    v_max_u32_dpp v113, v113, v113 quad_perm:[1,0,3,2] row_mask:0xf bank_mask:0xf
    v_mfma_f32_32x32x16_bf16 v[96:111], a[196:199], v[180:183], v[96:111]
    s_waitcnt lgkmcnt(6)
    ds_read_b64_tr_b16 a[216:217], v19 offset:4096
    ds_read_b64_tr_b16 a[218:219], v19 offset:4352
    v_max_u32_dpp v113, v113, v113 quad_perm:[2,3,0,1] row_mask:0xf bank_mask:0xf
    s_lshl_b32 s12, s6, 1
    s_sub_u32 s12, 3, s12
    v_max_u32_dpp v113, v113, v113 row_half_mirror row_mask:0xf bank_mask:0xf
    v_mfma_f32_32x32x16_bf16 v[96:111], a[200:203], v[184:187], v[96:111]
    s_waitcnt lgkmcnt(6)
    ds_read_b64_tr_b16 a[220:221], v19 offset:28672
    ds_read_b64_tr_b16 a[222:223], v19 offset:28928
    v_max_u32_dpp v113, v113, v113 row_mirror row_mask:0xf bank_mask:0xf
    v_add_u32 v114, s11, v31
    v_cmp_gt_u32 s[82:83], s12, v1
    v_max_u32_dpp v113, v113, v113 row_bcast:15 row_mask:0xa bank_mask:0xf
    v_mfma_f32_32x32x16_bf16 v[96:111], a[204:207], v[188:191], v[96:111]
    s_waitcnt lgkmcnt(6)
    ds_read_b64_tr_b16 a[192:193], v18 offset:5120
    ds_read_b64_tr_b16 a[194:195], v18 offset:5376
    v_readlane_b32 s71, v113, 63
    v_mov_b32 v116, 1073741824
    v_add_u32 v86, 57344, v2
    v_cmp_eq_u32 vcc, s71, v112
    v_mfma_f32_32x32x16_bf16 v[96:111], a[208:211], v[192:195], v[96:111]
    s_waitcnt lgkmcnt(6)
    ds_read_b64_tr_b16 a[196:197], v18 offset:29696
    ds_read_b64_tr_b16 a[198:199], v18 offset:29952
    s_add_u32 m0, s17, 17408
    s_nop 0
    buffer_load_dwordx4 v9, s[32:35], s15 offen lds
    v_cndmask_b32 v113, v112, 0, vcc
    v_cndmask_b32 v114, v116, v114, s[82:83]
    v_add_u32 v87, 106496, v2
    v_max_u32_dpp v113, v113, v113 quad_perm:[1,0,3,2] row_mask:0xf bank_mask:0xf
    v_mfma_f32_32x32x16_bf16 v[96:111], a[212:215], v[196:199], v[96:111]
    s_waitcnt lgkmcnt(6)
    ds_read_b64_tr_b16 a[200:201], v19 offset:5120
    ds_read_b64_tr_b16 a[202:203], v19 offset:5376
    v_max_u32_dpp v113, v113, v113 quad_perm:[2,3,0,1] row_mask:0xf bank_mask:0xf
    v_lshrrev_b32 v117, 3, v1
    v_and_b32 v118, 7, v1
    v_max_u32_dpp v113, v113, v113 row_half_mirror row_mask:0xf bank_mask:0xf
    v_mfma_f32_32x32x16_bf16 v[96:111], a[216:219], v[200:203], v[96:111]
    s_waitcnt lgkmcnt(6)
    ds_read_b64_tr_b16 a[204:205], v19 offset:29696
    ds_read_b64_tr_b16 a[206:207], v19 offset:29952
    buffer_load_dword v64, v78, s[36:39], s100 offen offset:0 sc1
    buffer_load_dword v65, v78, s[36:39], s100 offen offset:128 sc1
    buffer_load_dword v66, v78, s[36:39], s100 offen offset:256 sc1
    buffer_load_dword v67, v78, s[36:39], s100 offen offset:384 sc1
    v_mfma_f32_32x32x16_bf16 v[96:111], a[220:223], v[204:207], v[96:111]
    s_waitcnt lgkmcnt(6)
    ds_read_b64_tr_b16 a[208:209], v18 offset:6144
    ds_read_b64_tr_b16 a[210:211], v18 offset:6400
    v_max_u32_dpp v113, v113, v113 row_mirror row_mask:0xf bank_mask:0xf
    v_add_u32 v117, s3, v117
    v_cmp_eq_u32 s[18:19], 7, v118
    v_max_u32_dpp v113, v113, v113 row_bcast:15 row_mask:0xa bank_mask:0xf
    v_mfma_f32_32x32x16_bf16 v[96:111], a[192:195], v[208:211], v[96:111]
    s_waitcnt lgkmcnt(6)
    ds_read_b64_tr_b16 a[212:213], v18 offset:30720
    ds_read_b64_tr_b16 a[214:215], v18 offset:30976
    v_readlane_b32 s72, v113, 63
    v_and_b32 v117, 3, v117
    v_mad_u32_u24 v117, v117, 7, v118
    v_writelane_b32 v115, s71, 1
    v_mfma_f32_32x32x16_bf16 v[96:111], a[196:199], v[212:215], v[96:111]
    s_waitcnt lgkmcnt(6)
    ds_read_b64_tr_b16 a[216:217], v19 offset:6144
    ds_read_b64_tr_b16 a[218:219], v19 offset:6400
    s_add_u32 m0, s17, 18432
    s_nop 0
    buffer_load_dwordx4 v9, s[32:35], s16 offen lds
    v_and_b32 v118, 32, v1
    v_writelane_b32 v115, s72, 2
    v_cndmask_b32 v117, v117, 28, s[18:19]
    v_add_lshl_u32 v3, v117, v118, 4
    v_mfma_f32_32x32x16_bf16 v[96:111], a[200:203], v[216:219], v[96:111]
    s_waitcnt lgkmcnt(6)
    ds_read_b64_tr_b16 a[220:221], v19 offset:30720
    ds_read_b64_tr_b16 a[222:223], v19 offset:30976
    v_bfe_u32 v117, v1, 1, 3
    v_lshrrev_b32 v118, 5, v1
    v_lshl_add_u32 v118, s3, 1, v118
    v_xor_b32 v117, v117, v118
    s_waitcnt vmcnt(7)
    buffer_store_dword v115, v114, s[36:39], s99 offen
    v_mfma_f32_32x32x16_bf16 v[96:111], a[204:207], v[220:223], v[96:111]
    s_waitcnt lgkmcnt(6)
    v_bfe_u32 v118, v1, 4, 1
    v_lshl_add_u32 v117, v117, 1, v118
    v_and_b32 v118, 15, v1
    v_lshl_add_u32 v117, v118, 4, v117
    v_lshlrev_b32 v117, 3, v117
    v_add_u32 v84, 69632, v117
    v_mfma_f32_32x32x16_bf16 v[96:111], a[208:211], v[224:227], v[96:111]
    s_waitcnt lgkmcnt(4)
    v_mov_b32 v76, 0xbfb8aa3b
    v_add_u32 v85, 49152, v84
    v_mfma_f32_32x32x16_bf16 v[96:111], a[212:215], v[228:231], v[96:111]
    s_waitcnt lgkmcnt(2)
    v_mfma_f32_32x32x16_bf16 v[96:111], a[216:219], v[232:235], v[96:111]
    s_waitcnt lgkmcnt(0)
    v_mfma_f32_32x32x16_bf16 v[96:111], a[220:223], v[236:239], v[96:111]
    ds_read_b64 v[210:211], v84 offset:0
    ds_read_b64 v[214:215], v84 offset:24576
    ds_read_b64 v[218:219], v85 offset:0
    ds_read_b64 v[222:223], v85 offset:24576
    s_mov_b32 s70, 0
    v_mov_b32 v192, s22
    v_mov_b32 v193, s22
    v_mov_b32 v194, s22
    v_mov_b32 v195, s22
    v_mov_b32 v196, s22
    v_mov_b32 v197, s22
    v_mov_b32 v198, s22
    v_mov_b32 v199, s22
    v_mov_b32 v244, -1
    v_mov_b32 v245, -1
    v_mov_b32 v246, -1
    v_mov_b32 v247, -1
    s_waitcnt vmcnt(2)
L_tchk:
    v_min3_u32 v116, v64, v65, v66
    v_min_u32 v116, v116, v67
    v_cmp_eq_u32 vcc, 0, v116
    s_cbranch_vccnz L_trt
L_tok:
    s_waitcnt lgkmcnt(0)
    v_and_b32 v68, s81, v64
    v_lshlrev_b32 v70, 16, v64
    v_rcp_f32 v68, v68
    v_lshlrev_b32 v208, 16, v210
    v_and_b32 v209, s81, v210
    v_mul_f32 v70, v70, v68
    v_lshlrev_b32 v210, 16, v211
    v_and_b32 v211, s81, v211
    v_pk_fma_f32 v[224:225], v[208:209], v[68:69], v[70:71] op_sel_hi:[1,0,0] neg_lo:[0,0,1] neg_hi:[0,0,1]
    v_pk_fma_f32 v[226:227], v[210:211], v[68:69], v[70:71] op_sel_hi:[1,0,0] neg_lo:[0,0,1] neg_hi:[0,0,1]
    v_pk_mul_f32 v[72:73], v[224:225], v[76:77] op_sel_hi:[1,0]
    v_pk_mul_f32 v[74:75], v[226:227], v[76:77] op_sel_hi:[1,0]
    v_exp_f32 v72, v72
    v_exp_f32 v73, v73
    v_exp_f32 v74, v74
    v_exp_f32 v75, v75
    v_pk_add_f32 v[72:73], v[72:73], 1.0 op_sel_hi:[1,0]
    v_pk_add_f32 v[74:75], v[74:75], 1.0 op_sel_hi:[1,0]
    v_rcp_f32 v72, v72
    v_rcp_f32 v73, v73
    v_rcp_f32 v74, v74
    v_rcp_f32 v75, v75
    v_pk_mul_f32 v[224:225], v[224:225], v[72:73]
    v_pk_mul_f32 v[226:227], v[226:227], v[74:75]
    s_waitcnt vmcnt(1)
    ds_read_b64_tr_b16 a[240:241], v20 offset:16384
    ds_read_b64_tr_b16 a[242:243], v20 offset:16640
    ds_read_b64_tr_b16 a[244:245], v20 offset:17408
    ds_read_b64_tr_b16 a[246:247], v20 offset:17664
    ds_read_b64_tr_b16 a[248:249], v20 offset:18432
    ds_read_b64_tr_b16 a[250:251], v20 offset:18688
    s_barrier
    ds_read_b64_tr_b16 a[192:193], v18 offset:0
    ds_read_b64_tr_b16 a[194:195], v18 offset:256
    ds_read_b64_tr_b16 a[196:197], v18 offset:24576
    ds_read_b64_tr_b16 a[198:199], v18 offset:24832
    ds_read_b64_tr_b16 a[200:201], v19 offset:0
    ds_read_b64_tr_b16 a[202:203], v19 offset:256
    ds_read_b64_tr_b16 a[204:205], v19 offset:24576
    ds_read_b64_tr_b16 a[206:207], v19 offset:24832
    ds_read_b64_tr_b16 a[208:209], v18 offset:1024
    ds_read_b64_tr_b16 a[210:211], v18 offset:1280
    v_and_b32 v68, s81, v65
    v_lshlrev_b32 v70, 16, v65
    v_rcp_f32 v68, v68
    v_lshlrev_b32 v212, 16, v214
    v_and_b32 v213, s81, v214
    v_mul_f32 v70, v70, v68
    v_lshlrev_b32 v214, 16, v215
    v_and_b32 v215, s81, v215
    v_pk_fma_f32 v[228:229], v[212:213], v[68:69], v[70:71] op_sel_hi:[1,0,0] neg_lo:[0,0,1] neg_hi:[0,0,1]
    v_pk_fma_f32 v[230:231], v[214:215], v[68:69], v[70:71] op_sel_hi:[1,0,0] neg_lo:[0,0,1] neg_hi:[0,0,1]
    v_pk_mul_f32 v[72:73], v[228:229], v[76:77] op_sel_hi:[1,0]
    v_pk_mul_f32 v[74:75], v[230:231], v[76:77] op_sel_hi:[1,0]
    v_exp_f32 v72, v72
    v_exp_f32 v73, v73
    v_exp_f32 v74, v74
    v_exp_f32 v75, v75
    v_pk_add_f32 v[72:73], v[72:73], 1.0 op_sel_hi:[1,0]
    v_pk_add_f32 v[74:75], v[74:75], 1.0 op_sel_hi:[1,0]
    v_rcp_f32 v72, v72
    v_rcp_f32 v73, v73
    v_rcp_f32 v74, v74
    v_rcp_f32 v75, v75
    v_pk_mul_f32 v[228:229], v[228:229], v[72:73]
    v_pk_mul_f32 v[230:231], v[230:231], v[74:75]
L_tch3:
    s_cbranch_execz L_tch7
    s_waitcnt lgkmcnt(10)
    v_mfma_f32_16x16x32_bf16 v[40:43], v[44:47], a[240:243], v[40:43]
    v_mfma_f32_16x16x32_bf16 v[40:43], v[44:47], a[244:247], v[40:43]
    v_mfma_f32_16x16x32_bf16 v[40:43], v[44:47], a[248:251], v[40:43]
    s_waitcnt lgkmcnt(8)
    v_mfma_f32_32x32x16_bf16 v[96:111], a[192:195], v[128:131], v[96:111]
    s_waitcnt lgkmcnt(6)
    ds_read_b64_tr_b16 a[212:213], v18 offset:25600
    ds_read_b64_tr_b16 a[214:215], v18 offset:25856
    buffer_load_dwordx4 v[80:83], v2, s[36:39], s25 offen sc1
    v_mov_b32 v232, v66
    v_mov_b32 v236, v67
    v_and_b32 v241, 48, v1
    v_mfma_f32_32x32x16_bf16 v[96:111], a[196:199], v[132:135], v[96:111]
    s_waitcnt lgkmcnt(6)
    ds_read_b64_tr_b16 a[216:217], v19 offset:1024
    ds_read_b64_tr_b16 a[218:219], v19 offset:1280
    ds_write_b32 v23, v40 offset:1024
    v_and_b32 v23, -16, v23
    v_mfma_f32_32x32x16_bf16 v[96:111], a[200:203], v[136:139], v[96:111]
    s_waitcnt lgkmcnt(7)
    ds_read_b64_tr_b16 a[220:221], v19 offset:25600
    ds_read_b64_tr_b16 a[222:223], v19 offset:25856
    v_mfma_f32_32x32x16_bf16 v[96:111], a[204:207], v[140:143], v[96:111]
    s_waitcnt lgkmcnt(7)
    ds_read_b64_tr_b16 a[192:193], v18 offset:2048
    ds_read_b64_tr_b16 a[194:195], v18 offset:2304
    v_mfma_f32_32x32x16_bf16 v[96:111], a[208:211], v[144:147], v[96:111]
    s_waitcnt lgkmcnt(7)
    ds_read_b64_tr_b16 a[196:197], v18 offset:26624
    ds_read_b64_tr_b16 a[198:199], v18 offset:26880
    s_waitcnt lgkmcnt(6)
    s_barrier
    ds_read_b128 v[40:43], v23 offset:1024
    v_mfma_f32_32x32x16_bf16 v[96:111], a[212:215], v[148:151], v[96:111]
    ds_read_b64_tr_b16 a[200:201], v19 offset:2048
    ds_read_b64_tr_b16 a[202:203], v19 offset:2304
    s_waitcnt vmcnt(0)
L_fchk:
    v_min3_u32 v116, v81, v82, 1
    v_xor_b32 v80, s10, v80
    v_xor_b32 v83, s10, v83
    v_xor_b32 v116, 1, v116
    v_or3_b32 v116, v116, v80, v83
    v_cmp_ne_u32 vcc, 0, v116
    s_cbranch_vccnz L_fretry
L_fok:
    global_load_dwordx4 a[0:3], v2, s[42:43] offset:-4096 sc1
    global_load_dwordx4 a[4:7], v2, s[42:43] offset:-3072 sc1
    global_load_dwordx4 a[8:11], v3, s[42:43] offset:-2048 sc1
    global_load_dwordx4 a[12:15], v3, s[42:43] offset:-1024 sc1
    v_mfma_f32_32x32x16_bf16 v[96:111], a[216:219], v[152:155], v[96:111]
    s_waitcnt lgkmcnt(7)
    ds_read_b64_tr_b16 a[204:205], v19 offset:26624
    ds_read_b64_tr_b16 a[206:207], v19 offset:26880
    global_load_dwordx4 a[16:19], v2, s[42:43] offset:0 sc1
    v_mov_b32 v113, v81
    v_mfma_f32_32x32x16_bf16 v[96:111], a[220:223], v[156:159], v[96:111]
    s_waitcnt lgkmcnt(7)
    global_load_dwordx4 a[20:23], v2, s[42:43] offset:1024 sc1
    s_waitcnt lgkmcnt(4)
    v_max_u32_dpp v113, v113, v113 quad_perm:[1,0,3,2] row_mask:0xf bank_mask:0xf
    v_add_f32 v40, v40, v41
    v_add_f32 v42, v42, v43
    v_add_f32 v40, v40, v42
    v_and_b32 v60, s81, v40
    v_mfma_f32_32x32x16_bf16 v[96:111], a[192:195], v[160:163], v[96:111]
    global_load_dwordx4 a[24:27], v3, s[42:43] offset:2048 sc1
    v_max_u32_dpp v113, v113, v113 quad_perm:[2,3,0,1] row_mask:0xf bank_mask:0xf
    v_sub_f32 v61, v40, v60
    v_lshrrev_b32 v60, 16, v60
    v_and_b32 v40, s81, v61
    v_sub_f32 v61, v61, v40
    v_mfma_f32_32x32x16_bf16 v[96:111], a[196:199], v[164:167], v[96:111]
    s_waitcnt lgkmcnt(2)
    global_load_dwordx4 a[28:31], v3, s[42:43] offset:3072 sc1
    v_max_u32_dpp v113, v113, v113 row_half_mirror row_mask:0xf bank_mask:0xf
    v_or_b32 v56, v60, v40
    v_lshrrev_b32 v57, 16, v61
    v_mul_f32 v62, 0x3e8b97f6, v62
    v_mfma_f32_32x32x16_bf16 v[96:111], a[200:203], v[168:171], v[96:111]
    s_waitcnt lgkmcnt(0)
    v_max_u32_dpp v113, v113, v113 row_mirror row_mask:0xf bank_mask:0xf
    v_mfma_f32_32x32x16_bf16 v[96:111], a[204:207], v[172:175], v[96:111]
    s_nop 0
    v_max_u32_dpp v113, v113, v113 row_bcast:15 row_mask:0xa bank_mask:0xf
    v_mfma_f32_32x32x16_bf16 v[96:111], v[56:59], v[48:51], v[96:111]
    s_nop 0
    v_max_u32_dpp v113, v113, v113 row_bcast:31 row_mask:0xc bank_mask:0xf
    s_mov_b32 s18, 0x33333333
    s_mov_b32 s19, s18
    v_readlane_b32 s71, v113, 63
    s_mul_i32 s16, s4, 112
    s_movk_i32 s14, 896
    v_cmp_eq_u32 vcc, s71, v81
    s_or_b32 s86, s8, s3
    s_cselect_b32 s86, 0, -1
    v_cndmask_b32 v113, v81, v82, vcc
    v_and_b32 v30, 60, v31
    s_mov_b32 s77, -1
    v_max_u32_dpp v113, v113, v113 quad_perm:[1,0,3,2] row_mask:0xf bank_mask:0xf
    s_nop 0
    s_mul_i32 s11, s3, 7168
    v_pk_mul_f32 v[96:97], v[96:97], v[62:63] op_sel_hi:[1,0]
    v_cvt_pk_bf16_f32 v248, v96, v97
    v_max_u32_dpp v113, v113, v113 quad_perm:[2,3,0,1] row_mask:0xf bank_mask:0xf
    v_pk_mul_f32 v[98:99], v[98:99], v[62:63] op_sel_hi:[1,0]
    v_cvt_pk_bf16_f32 v249, v98, v99
    v_max_u32_dpp v113, v113, v113 row_half_mirror row_mask:0xf bank_mask:0xf
    v_pk_mul_f32 v[100:101], v[100:101], v[62:63] op_sel_hi:[1,0]
    v_cvt_pk_bf16_f32 v250, v100, v101
    v_max_u32_dpp v113, v113, v113 row_mirror row_mask:0xf bank_mask:0xf
    v_pk_mul_f32 v[102:103], v[102:103], v[62:63] op_sel_hi:[1,0]
    v_cvt_pk_bf16_f32 v251, v102, v103
    v_max_u32_dpp v113, v113, v113 row_bcast:15 row_mask:0xa bank_mask:0xf
    ds_write_b128 v28, v[248:251] offset:0
    v_pk_mul_f32 v[104:105], v[104:105], v[62:63] op_sel_hi:[1,0]
    v_cvt_pk_bf16_f32 v252, v104, v105
    v_max_u32_dpp v113, v113, v113 row_bcast:31 row_mask:0xc bank_mask:0xf
    v_pk_mul_f32 v[106:107], v[106:107], v[62:63] op_sel_hi:[1,0]
    v_cvt_pk_bf16_f32 v253, v106, v107
    v_readlane_b32 s72, v113, 63
    v_pk_mul_f32 v[108:109], v[108:109], v[62:63] op_sel_hi:[1,0]
    v_cvt_pk_bf16_f32 v254, v108, v109
    v_cndmask_b32 v254, 0, v254, s[20:21]
    v_pk_mul_f32 v[110:111], v[110:111], v[62:63] op_sel_hi:[1,0]
    v_cvt_pk_bf16_f32 v255, v110, v111
    v_cndmask_b32 v255, 0, v255, s[20:21]
    ds_write_b128 v28, v[252:255] offset:1024
    s_getpc_b64 s[26:27]
L_pc2:
    s_add_u32 s11, s11, L_tab - L_pc2 + 3072
    s_add_u32 s26, s26, s11
    s_addc_u32 s27, s27, 0
    s_lshl_b32 s12, s7, 7
    s_add_u32 s12, s12, s8
    s_lshl_b32 s12, s12, 10
    s_add_u32 s78, s12, 9437184
    s_lshl_b32 s12, s3, 15
    s_add_u32 s101, s78, s12
    s_lshl2_add_u32 s13, s5, s3
    s_lshl_b32 s95, s13, 11
    s_add_u32 s95, s95, 5242880
    s_lshl_b32 s12, s4, 8
    s_add_u32 s87, s95, s12
    s_waitcnt lgkmcnt(0)
    s_barrier
    ds_read_b128 v[32:35], v86 offset:0
    ds_read_b128 v[36:39], v86 offset:1024
    ds_read_b128 v[40:43], v86 offset:24576
    ds_read_b128 v[44:47], v86 offset:25600
    s_mul_i32 s91, s13, 14336
    s_lshl_b32 s12, s4, 7
    s_add_u32 s91, s91, s12
    s_add_u32 s92, s91, 6144
    s_mul_i32 s12, s4, 56
    s_lshl4_add_u32 s12, s3, s12
    s_mul_i32 s12, s12, 28
    s_add_u32 s12, s12, s5
    s_lshl_b32 s89, s12, 7
    s_add_u32 s90, s89, 27648
    s_cmp_eq_u32 s3, 3
    s_cselect_b32 s90, 1073741824, s90
    s_add_u32 s42, s42, 8192
    s_addc_u32 s43, s43, 0
    global_load_dwordx4 a[32:35], v2, s[42:43] offset:-4096 sc1
    global_load_dwordx4 a[36:39], v2, s[42:43] offset:-3072 sc1
    global_load_dwordx4 a[40:43], v3, s[42:43] offset:-2048 sc1
    global_load_dwordx4 a[44:47], v3, s[42:43] offset:-1024 sc1
    global_load_dwordx4 v[4:7], v2, s[26:27] offset:-3072
    s_waitcnt vmcnt(11) lgkmcnt(2)
    v_mfma_f32_32x32x16_bf16 v[128:143], a[0:3], v[32:35], 0
    s_lshr_b32 s12, s7, 1
    s_lshl_b32 s12, s12, 4
    s_and_b32 s13, s7, 1
    s_add_u32 s12, s12, s13
    s_lshl_b32 s12, s12, 8
    s_add_u32 s97, s12, 12584960
    s_lshl2_add_u32 s96, s96, s97
    v_mfma_f32_32x32x16_bf16 v[128:143], a[4:7], v[36:39], v[128:143]
    s_mov_b32 s58, 1605632
    s_mov_b32 s59, 0x20000
    s_mov_b32 s62, 1605632
    s_mov_b32 s63, 0x20000
    s_mov_b32 s66, 1605632
    s_mov_b32 s67, 0x20000
    s_mov_b32 s54, 401408
    s_mov_b32 s55, 0x20000
    s_lshl_b32 s84, s2, 11
    s_waitcnt lgkmcnt(0)
    v_mfma_f32_32x32x16_bf16 v[144:159], a[0:3], v[40:43], 0
    ds_read_b128 v[48:51], v87 offset:0
    ds_read_b128 v[52:55], v87 offset:1024
    v_exp_f32 v128, v128
    v_exp_f32 v129, v129
    v_exp_f32 v130, v130
    v_exp_f32 v131, v131
    v_cvt_pk_bf16_f32 v160, v128, v129
    v_cvt_pk_bf16_f32 v161, v130, v131
    v_mfma_f32_32x32x16_bf16 v[144:159], a[4:7], v[44:47], v[144:159]
    ds_read_b128 v[56:59], v87 offset:24576
    ds_read_b128 v[60:63], v87 offset:25600
    v_exp_f32 v132, v132
    v_exp_f32 v133, v133
    v_exp_f32 v134, v134
    v_exp_f32 v135, v135
    v_cvt_pk_bf16_f32 v162, v132, v133
    v_cvt_pk_bf16_f32 v163, v134, v135
    global_load_dwordx4 a[48:51], v2, s[42:43] offset:0 sc1
    v_exp_f32 v136, v136
    v_exp_f32 v137, v137
    v_exp_f32 v138, v138
    v_exp_f32 v139, v139
    v_cvt_pk_bf16_f32 v164, v136, v137
    v_cvt_pk_bf16_f32 v165, v138, v139
    s_waitcnt lgkmcnt(0)
    v_exp_f32 v140, v140
    v_exp_f32 v141, v141
    v_exp_f32 v142, v142
    v_exp_f32 v143, v143
    v_cvt_pk_bf16_f32 v166, v140, v141
    v_cvt_pk_bf16_f32 v167, v142, v143
    v_mfma_f32_32x32x16_bf16 v[128:143], a[0:3], v[48:51], 0
    global_load_dwordx4 a[52:55], v2, s[42:43] offset:1024 sc1
    v_exp_f32 v144, v144
    v_exp_f32 v145, v145
    v_exp_f32 v146, v146
    v_exp_f32 v147, v147
    v_cvt_pk_bf16_f32 v168, v144, v145
    v_cvt_pk_bf16_f32 v169, v146, v147
    v_mfma_f32_32x32x16_bf16 v[128:143], a[4:7], v[52:55], v[128:143]
    s_waitcnt vmcnt(11)
    v_exp_f32 v148, v148
    v_exp_f32 v149, v149
    v_exp_f32 v150, v150
    v_exp_f32 v151, v151
    v_cvt_pk_bf16_f32 v170, v148, v149
    v_cvt_pk_bf16_f32 v171, v150, v151
    v_mfma_f32_32x32x16_bf16 v[64:79], a[8:11], v[160:163], 0
    global_load_dwordx4 a[56:59], v3, s[42:43] offset:2048 sc1
    v_exp_f32 v152, v152
    v_exp_f32 v153, v153
    v_exp_f32 v154, v154
    v_exp_f32 v155, v155
    v_cvt_pk_bf16_f32 v172, v152, v153
    v_cvt_pk_bf16_f32 v173, v154, v155
    v_mfma_f32_32x32x16_bf16 v[64:79], a[12:15], v[164:167], v[64:79]
    s_waitcnt vmcnt(8)
    v_exp_f32 v156, v156
    v_exp_f32 v157, v157
    v_exp_f32 v158, v158
    v_exp_f32 v159, v159
    v_cvt_pk_bf16_f32 v174, v156, v157
    v_cvt_pk_bf16_f32 v175, v158, v159
    v_mfma_f32_32x32x16_bf16 v[144:159], a[16:19], v[32:35], 0
    global_load_dwordx4 a[60:63], v3, s[42:43] offset:3072 sc1
    v_exp_f32 v128, v128
    v_exp_f32 v129, v129
    v_exp_f32 v130, v130
    v_exp_f32 v131, v131
    v_cvt_pk_bf16_f32 v160, v128, v129
    v_cvt_pk_bf16_f32 v161, v130, v131
    v_mfma_f32_32x32x16_bf16 v[144:159], a[20:23], v[36:39], v[144:159]
    s_add_u32 s42, s42, 8192
    s_addc_u32 s43, s43, 0
    v_exp_f32 v132, v132
    v_exp_f32 v133, v133
    v_exp_f32 v134, v134
    v_exp_f32 v135, v135
    v_cvt_pk_bf16_f32 v162, v132, v133
    v_cvt_pk_bf16_f32 v163, v134, v135
    v_mfma_f32_32x32x16_bf16 v[80:95], a[8:11], v[168:171], 0
    global_load_dwordx4 a[64:67], v2, s[42:43] offset:-4096 sc1
    v_exp_f32 v136, v136
    v_exp_f32 v137, v137
    v_exp_f32 v138, v138
    v_exp_f32 v139, v139
    v_cvt_pk_bf16_f32 v164, v136, v137
    v_cvt_pk_bf16_f32 v165, v138, v139
    v_mfma_f32_32x32x16_bf16 v[80:95], a[12:15], v[172:175], v[80:95]
    s_andn2_b32 s73, 2047, s71
    v_exp_f32 v140, v140
    v_exp_f32 v141, v141
    v_exp_f32 v142, v142
    v_exp_f32 v143, v143
    v_cvt_pk_bf16_f32 v166, v140, v141
    v_cvt_pk_bf16_f32 v167, v142, v143
    v_mfma_f32_32x32x16_bf16 v[128:143], a[16:19], v[40:43], 0
    global_load_dwordx4 a[68:71], v2, s[42:43] offset:-3072 sc1
    v_exp_f32 v144, v144
    v_exp_f32 v145, v145
    v_exp_f32 v146, v146
    v_exp_f32 v147, v147
    v_cvt_pk_bf16_f32 v168, v144, v145
    v_cvt_pk_bf16_f32 v169, v146, v147
    v_mfma_f32_32x32x16_bf16 v[128:143], a[20:23], v[44:47], v[128:143]
    s_andn2_b32 s74, 2047, s72
    v_exp_f32 v148, v148
    v_exp_f32 v149, v149
    v_exp_f32 v150, v150
    v_exp_f32 v151, v151
    v_cvt_pk_bf16_f32 v170, v148, v149
    v_cvt_pk_bf16_f32 v171, v150, v151
    v_mfma_f32_32x32x16_bf16 v[96:111], a[8:11], v[160:163], 0
    global_load_dwordx4 a[72:75], v3, s[42:43] offset:-2048 sc1
    v_exp_f32 v152, v152
    v_exp_f32 v153, v153
    v_exp_f32 v154, v154
    v_exp_f32 v155, v155
    v_cvt_pk_bf16_f32 v172, v152, v153
    v_cvt_pk_bf16_f32 v173, v154, v155
    v_mfma_f32_32x32x16_bf16 v[96:111], a[12:15], v[164:167], v[96:111]
    s_mov_b32 vcc_lo, 0xaaaaaaaa
    v_exp_f32 v156, v156
    v_exp_f32 v157, v157
    v_exp_f32 v158, v158
    v_exp_f32 v159, v159
    v_cvt_pk_bf16_f32 v174, v156, v157
    v_cvt_pk_bf16_f32 v175, v158, v159
    v_mfma_f32_32x32x16_bf16 v[144:159], a[16:19], v[48:51], 0
    global_load_dwordx4 a[76:79], v3, s[42:43] offset:-1024 sc1
    v_exp_f32 v128, v128
    v_exp_f32 v129, v129
    v_exp_f32 v130, v130
    v_exp_f32 v131, v131
    v_cvt_pk_bf16_f32 v160, v128, v129
    v_cvt_pk_bf16_f32 v161, v130, v131
    v_mfma_f32_32x32x16_bf16 v[144:159], a[20:23], v[52:55], v[144:159]
    s_waitcnt vmcnt(8)
    v_exp_f32 v132, v132
    v_exp_f32 v133, v133
    v_exp_f32 v134, v134
    v_exp_f32 v135, v135
    v_cvt_pk_bf16_f32 v162, v132, v133
    v_cvt_pk_bf16_f32 v163, v134, v135
    v_mfma_f32_32x32x16_bf16 v[64:79], a[24:27], v[168:171], v[64:79]
    buffer_store_dwordx4 v[244:247], v2, s[36:39], s101 offen sc1
    v_exp_f32 v136, v136
    v_exp_f32 v137, v137
    v_exp_f32 v138, v138
    v_exp_f32 v139, v139
    v_cvt_pk_bf16_f32 v164, v136, v137
    v_cvt_pk_bf16_f32 v165, v138, v139
    v_mfma_f32_32x32x16_bf16 v[64:79], a[28:31], v[172:175], v[64:79]
    v_exp_f32 v140, v140
    v_exp_f32 v141, v141
    v_exp_f32 v142, v142
    v_exp_f32 v143, v143
    v_cvt_pk_bf16_f32 v166, v140, v141
    v_cvt_pk_bf16_f32 v167, v142, v143
    v_mfma_f32_32x32x16_bf16 v[128:143], a[32:35], v[32:35], 0
    s_add_u32 s101, s101, 16384
    v_exp_f32 v144, v144
    v_exp_f32 v145, v145
    v_exp_f32 v146, v146
    v_exp_f32 v147, v147
    v_cvt_pk_bf16_f32 v168, v144, v145
    v_cvt_pk_bf16_f32 v169, v146, v147
    v_mfma_f32_32x32x16_bf16 v[128:143], a[36:39], v[36:39], v[128:143]
    buffer_store_dwordx4 v[244:247], v2, s[36:39], s101 offen sc1
    v_exp_f32 v148, v148
    v_exp_f32 v149, v149
    v_exp_f32 v150, v150
    v_exp_f32 v151, v151
    v_cvt_pk_bf16_f32 v170, v148, v149
    v_cvt_pk_bf16_f32 v171, v150, v151
    v_mfma_f32_32x32x16_bf16 v[80:95], a[24:27], v[160:163], v[80:95]
    s_mov_b32 vcc_hi, vcc_lo
    v_exp_f32 v152, v152
    v_exp_f32 v153, v153
    v_exp_f32 v154, v154
    v_exp_f32 v155, v155
    v_cvt_pk_bf16_f32 v172, v152, v153
    v_cvt_pk_bf16_f32 v173, v154, v155
    v_mov_b32 v112, s73
    v_mov_b32 v113, s74
    v_cndmask_b32 v112, v112, v113, vcc
    v_mad_u32_u24 v241, v112, s14, v241
    v_lshlrev_b32 v242, 2, v112
    v_mfma_f32_32x32x16_bf16 v[80:95], a[28:31], v[164:167], v[80:95]
    buffer_store_dwordx4 v[244:247], v4, s[36:39], s87 offen sc1
    v_exp_f32 v156, v156
    v_exp_f32 v157, v157
    v_exp_f32 v158, v158
    v_exp_f32 v159, v159
    v_cvt_pk_bf16_f32 v174, v156, v157
    v_cvt_pk_bf16_f32 v175, v158, v159
    v_mfma_f32_32x32x16_bf16 v[144:159], a[32:35], v[40:43], 0
    s_mov_b64 exec, s[18:19]
    buffer_load_dwordx4 v[192:195], v241, s[28:31], s16 offen offset:0
    buffer_load_dwordx4 v[196:199], v241, s[28:31], s16 offen offset:64
    s_mov_b64 exec, -1
    v_exp_f32 v128, v128
    v_exp_f32 v129, v129
    v_exp_f32 v130, v130
    v_exp_f32 v131, v131
    v_cvt_pk_bf16_f32 v160, v128, v129
    v_cvt_pk_bf16_f32 v161, v130, v131
    v_mfma_f32_32x32x16_bf16 v[144:159], a[36:39], v[44:47], v[144:159]
    global_load_dwordx4 a[80:83], v2, s[42:43] offset:0 sc1
    v_exp_f32 v132, v132
    v_exp_f32 v133, v133
    v_exp_f32 v134, v134
    v_exp_f32 v135, v135
    v_cvt_pk_bf16_f32 v162, v132, v133
    v_cvt_pk_bf16_f32 v163, v134, v135
    v_mfma_f32_32x32x16_bf16 v[96:111], a[24:27], v[168:171], v[96:111]
    buffer_load_dword v242, v242, s[36:39], s98 offen sc1
    v_exp_f32 v136, v136
    v_exp_f32 v137, v137
    v_exp_f32 v138, v138
    v_exp_f32 v139, v139
    v_cvt_pk_bf16_f32 v164, v136, v137
    v_cvt_pk_bf16_f32 v165, v138, v139
    v_mfma_f32_32x32x16_bf16 v[96:111], a[28:31], v[172:175], v[96:111]
    global_load_dwordx4 a[84:87], v2, s[42:43] offset:1024 sc1
    v_exp_f32 v140, v140
    v_exp_f32 v141, v141
    v_exp_f32 v142, v142
    v_exp_f32 v143, v143
    v_cvt_pk_bf16_f32 v166, v140, v141
    v_cvt_pk_bf16_f32 v167, v142, v143
    v_mfma_f32_32x32x16_bf16 v[128:143], a[32:35], v[48:51], 0
    s_lshr_b32 s11, s73, 4
    v_exp_f32 v144, v144
    v_exp_f32 v145, v145
    v_exp_f32 v146, v146
    v_exp_f32 v147, v147
    v_cvt_pk_bf16_f32 v168, v144, v145
    v_cvt_pk_bf16_f32 v169, v146, v147
    v_mfma_f32_32x32x16_bf16 v[128:143], a[36:39], v[52:55], v[128:143]
    global_load_dwordx4 a[88:91], v3, s[42:43] offset:2048 sc1
    v_exp_f32 v148, v148
    v_exp_f32 v149, v149
    v_exp_f32 v150, v150
    v_exp_f32 v151, v151
    v_cvt_pk_bf16_f32 v170, v148, v149
    v_cvt_pk_bf16_f32 v171, v150, v151
    v_mfma_f32_32x32x16_bf16 v[64:79], a[40:43], v[160:163], v[64:79]
    s_and_b32 s11, s11, 0x79
    v_exp_f32 v152, v152
    v_exp_f32 v153, v153
    v_exp_f32 v154, v154
    v_exp_f32 v155, v155
    v_cvt_pk_bf16_f32 v172, v152, v153
    v_cvt_pk_bf16_f32 v173, v154, v155
    v_mfma_f32_32x32x16_bf16 v[64:79], a[44:47], v[164:167], v[64:79]
    s_waitcnt vmcnt(13)
    global_load_dwordx4 a[92:95], v3, s[42:43] offset:3072 sc1
    v_exp_f32 v156, v156
    v_exp_f32 v157, v157
    v_exp_f32 v158, v158
    v_exp_f32 v159, v159
    v_cvt_pk_bf16_f32 v174, v156, v157
    v_cvt_pk_bf16_f32 v175, v158, v159
    v_mfma_f32_32x32x16_bf16 v[144:159], a[48:51], v[32:35], 0
    s_add_u32 s42, s42, 8192
    s_addc_u32 s43, s43, 0
    v_exp_f32 v128, v128
    v_exp_f32 v129, v129
    v_exp_f32 v130, v130
    v_exp_f32 v131, v131
    v_cvt_pk_bf16_f32 v160, v128, v129
    v_cvt_pk_bf16_f32 v161, v130, v131
    v_mfma_f32_32x32x16_bf16 v[144:159], a[52:55], v[36:39], v[144:159]
    global_load_dwordx4 a[96:99], v2, s[42:43] offset:-4096 sc1
    v_exp_f32 v132, v132
    v_exp_f32 v133, v133
    v_exp_f32 v134, v134
    v_exp_f32 v135, v135
    v_cvt_pk_bf16_f32 v162, v132, v133
    v_cvt_pk_bf16_f32 v163, v134, v135
    v_mfma_f32_32x32x16_bf16 v[80:95], a[40:43], v[168:171], v[80:95]
    s_cmp_eq_u32 s11, s41
    s_cselect_b32 s69, 1, 0
    v_exp_f32 v136, v136
    v_exp_f32 v137, v137
    v_exp_f32 v138, v138
    v_exp_f32 v139, v139
    v_cvt_pk_bf16_f32 v164, v136, v137
    v_cvt_pk_bf16_f32 v165, v138, v139
    v_mfma_f32_32x32x16_bf16 v[80:95], a[44:47], v[172:175], v[80:95]
    global_load_dwordx4 a[100:103], v2, s[42:43] offset:-3072 sc1
    v_exp_f32 v140, v140
    v_exp_f32 v141, v141
    v_exp_f32 v142, v142
    v_exp_f32 v143, v143
    v_cvt_pk_bf16_f32 v166, v140, v141
    v_cvt_pk_bf16_f32 v167, v142, v143
    v_mfma_f32_32x32x16_bf16 v[128:143], a[48:51], v[40:43], 0
    s_lshr_b32 s11, s74, 4
    v_exp_f32 v144, v144
    v_exp_f32 v145, v145
    v_exp_f32 v146, v146
    v_exp_f32 v147, v147
    v_cvt_pk_bf16_f32 v168, v144, v145
    v_cvt_pk_bf16_f32 v169, v146, v147
    v_mfma_f32_32x32x16_bf16 v[128:143], a[52:55], v[44:47], v[128:143]
    global_load_dwordx4 a[104:107], v3, s[42:43] offset:-2048 sc1
    v_exp_f32 v148, v148
    v_exp_f32 v149, v149
    v_exp_f32 v150, v150
    v_exp_f32 v151, v151
    v_cvt_pk_bf16_f32 v170, v148, v149
    v_cvt_pk_bf16_f32 v171, v150, v151
    v_mfma_f32_32x32x16_bf16 v[96:111], a[40:43], v[160:163], v[96:111]
    s_and_b32 s11, s11, 0x79
    v_exp_f32 v152, v152
    v_exp_f32 v153, v153
    v_exp_f32 v154, v154
    v_exp_f32 v155, v155
    v_cvt_pk_bf16_f32 v172, v152, v153
    v_cvt_pk_bf16_f32 v173, v154, v155
    v_mfma_f32_32x32x16_bf16 v[96:111], a[44:47], v[164:167], v[96:111]
    global_load_dwordx4 a[108:111], v3, s[42:43] offset:-1024 sc1
    v_exp_f32 v156, v156
    v_exp_f32 v157, v157
    v_exp_f32 v158, v158
    v_exp_f32 v159, v159
    v_cvt_pk_bf16_f32 v174, v156, v157
    v_cvt_pk_bf16_f32 v175, v158, v159
    v_mfma_f32_32x32x16_bf16 v[144:159], a[48:51], v[48:51], 0
    s_cmp_eq_u32 s11, s41
    s_cselect_b32 s11, 2, 0
    v_exp_f32 v128, v128
    v_exp_f32 v129, v129
    v_exp_f32 v130, v130
    v_exp_f32 v131, v131
    v_cvt_pk_bf16_f32 v160, v128, v129
    v_cvt_pk_bf16_f32 v161, v130, v131
    v_mfma_f32_32x32x16_bf16 v[144:159], a[52:55], v[52:55], v[144:159]
    global_load_dwordx4 a[112:115], v2, s[42:43] offset:0 sc1
    v_exp_f32 v132, v132
    v_exp_f32 v133, v133
    v_exp_f32 v134, v134
    v_exp_f32 v135, v135
    v_cvt_pk_bf16_f32 v162, v132, v133
    v_cvt_pk_bf16_f32 v163, v134, v135
    v_mfma_f32_32x32x16_bf16 v[64:79], a[56:59], v[168:171], v[64:79]
    s_or_b32 s69, s69, s11
    v_exp_f32 v136, v136
    v_exp_f32 v137, v137
    v_exp_f32 v138, v138
    v_exp_f32 v139, v139
    v_cvt_pk_bf16_f32 v164, v136, v137
    v_cvt_pk_bf16_f32 v165, v138, v139
    v_mfma_f32_32x32x16_bf16 v[64:79], a[60:63], v[172:175], v[64:79]
    s_waitcnt vmcnt(15)
    global_load_dwordx4 a[116:119], v2, s[42:43] offset:1024 sc1
    v_exp_f32 v140, v140
    v_exp_f32 v141, v141
    v_exp_f32 v142, v142
    v_exp_f32 v143, v143
    v_cvt_pk_bf16_f32 v166, v140, v141
    v_cvt_pk_bf16_f32 v167, v142, v143
    v_mfma_f32_32x32x16_bf16 v[128:143], a[64:67], v[32:35], 0
    v_exp_f32 v144, v144
    v_exp_f32 v145, v145
    v_exp_f32 v146, v146
    v_exp_f32 v147, v147
    v_cvt_pk_bf16_f32 v168, v144, v145
    v_cvt_pk_bf16_f32 v169, v146, v147
    v_mfma_f32_32x32x16_bf16 v[128:143], a[68:71], v[36:39], v[128:143]
    global_load_dwordx4 a[120:123], v3, s[42:43] offset:2048 sc1
    v_exp_f32 v148, v148
    v_exp_f32 v149, v149
    v_exp_f32 v150, v150
    v_exp_f32 v151, v151
    v_cvt_pk_bf16_f32 v170, v148, v149
    v_cvt_pk_bf16_f32 v171, v150, v151
    v_mfma_f32_32x32x16_bf16 v[80:95], a[56:59], v[160:163], v[80:95]
    v_exp_f32 v152, v152
    v_exp_f32 v153, v153
    v_exp_f32 v154, v154
    v_exp_f32 v155, v155
    v_cvt_pk_bf16_f32 v172, v152, v153
    v_cvt_pk_bf16_f32 v173, v154, v155
    v_mfma_f32_32x32x16_bf16 v[80:95], a[60:63], v[164:167], v[80:95]
    global_load_dwordx4 a[124:127], v3, s[42:43] offset:3072 sc1
    v_exp_f32 v156, v156
    v_exp_f32 v157, v157
    v_exp_f32 v158, v158
    v_exp_f32 v159, v159
    v_cvt_pk_bf16_f32 v174, v156, v157
    v_cvt_pk_bf16_f32 v175, v158, v159
    v_mfma_f32_32x32x16_bf16 v[144:159], a[64:67], v[40:43], 0
    s_add_u32 s42, s42, 8192
    s_addc_u32 s43, s43, 0
    v_exp_f32 v128, v128
    v_exp_f32 v129, v129
    v_exp_f32 v130, v130
    v_exp_f32 v131, v131
    v_cvt_pk_bf16_f32 v160, v128, v129
    v_cvt_pk_bf16_f32 v161, v130, v131
    v_mfma_f32_32x32x16_bf16 v[144:159], a[68:71], v[44:47], v[144:159]
    global_load_dwordx4 a[128:131], v2, s[42:43] offset:-4096 sc1
    v_exp_f32 v132, v132
    v_exp_f32 v133, v133
    v_exp_f32 v134, v134
    v_exp_f32 v135, v135
    v_cvt_pk_bf16_f32 v162, v132, v133
    v_cvt_pk_bf16_f32 v163, v134, v135
    v_mfma_f32_32x32x16_bf16 v[96:111], a[56:59], v[168:171], v[96:111]
    v_exp_f32 v136, v136
    v_exp_f32 v137, v137
    v_exp_f32 v138, v138
    v_exp_f32 v139, v139
    v_cvt_pk_bf16_f32 v164, v136, v137
    v_cvt_pk_bf16_f32 v165, v138, v139
    v_mfma_f32_32x32x16_bf16 v[96:111], a[60:63], v[172:175], v[96:111]
    global_load_dwordx4 a[132:135], v2, s[42:43] offset:-3072 sc1
    v_exp_f32 v140, v140
    v_exp_f32 v141, v141
    v_exp_f32 v142, v142
    v_exp_f32 v143, v143
    v_cvt_pk_bf16_f32 v166, v140, v141
    v_cvt_pk_bf16_f32 v167, v142, v143
    v_mfma_f32_32x32x16_bf16 v[128:143], a[64:67], v[48:51], 0
    s_waitcnt vmcnt(17)
    buffer_store_dword v244, v29, s[36:39], s96 offen sc1
    v_exp_f32 v144, v144
    v_exp_f32 v145, v145
    v_exp_f32 v146, v146
    v_exp_f32 v147, v147
    v_cvt_pk_bf16_f32 v168, v144, v145
    v_cvt_pk_bf16_f32 v169, v146, v147
    v_mfma_f32_32x32x16_bf16 v[128:143], a[68:71], v[52:55], v[128:143]
    global_load_dwordx4 a[136:139], v3, s[42:43] offset:-2048 sc1
    v_exp_f32 v148, v148
    v_exp_f32 v149, v149
    v_exp_f32 v150, v150
    v_exp_f32 v151, v151
    v_cvt_pk_bf16_f32 v170, v148, v149
    v_cvt_pk_bf16_f32 v171, v150, v151
    v_mfma_f32_32x32x16_bf16 v[64:79], a[72:75], v[160:163], v[64:79]
    v_exp_f32 v152, v152
    v_exp_f32 v153, v153
    v_exp_f32 v154, v154
    v_exp_f32 v155, v155
    v_cvt_pk_bf16_f32 v172, v152, v153
    v_cvt_pk_bf16_f32 v173, v154, v155
    v_mfma_f32_32x32x16_bf16 v[64:79], a[76:79], v[164:167], v[64:79]
    s_waitcnt vmcnt(12)
    global_load_dwordx4 a[140:143], v3, s[42:43] offset:-1024 sc1
    v_exp_f32 v156, v156
    v_exp_f32 v157, v157
    v_exp_f32 v158, v158
    v_exp_f32 v159, v159
    v_cvt_pk_bf16_f32 v174, v156, v157
    v_cvt_pk_bf16_f32 v175, v158, v159
    v_mfma_f32_32x32x16_bf16 v[144:159], a[80:83], v[32:35], 0
    v_exp_f32 v128, v128
    v_exp_f32 v129, v129
    v_exp_f32 v130, v130
    v_exp_f32 v131, v131
    v_cvt_pk_bf16_f32 v160, v128, v129
    v_cvt_pk_bf16_f32 v161, v130, v131
    v_mfma_f32_32x32x16_bf16 v[144:159], a[84:87], v[36:39], v[144:159]
    global_load_dwordx4 a[144:147], v2, s[42:43] offset:0 sc1
    v_exp_f32 v132, v132
    v_exp_f32 v133, v133
    v_exp_f32 v134, v134
    v_exp_f32 v135, v135
    v_cvt_pk_bf16_f32 v162, v132, v133
    v_cvt_pk_bf16_f32 v163, v134, v135
    v_mfma_f32_32x32x16_bf16 v[80:95], a[72:75], v[168:171], v[80:95]
    v_exp_f32 v136, v136
    v_exp_f32 v137, v137
    v_exp_f32 v138, v138
    v_exp_f32 v139, v139
    v_cvt_pk_bf16_f32 v164, v136, v137
    v_cvt_pk_bf16_f32 v165, v138, v139
    v_mfma_f32_32x32x16_bf16 v[80:95], a[76:79], v[172:175], v[80:95]
    global_load_dwordx4 a[148:151], v2, s[42:43] offset:1024 sc1
    v_exp_f32 v140, v140
    v_exp_f32 v141, v141
    v_exp_f32 v142, v142
    v_exp_f32 v143, v143
    v_cvt_pk_bf16_f32 v166, v140, v141
    v_cvt_pk_bf16_f32 v167, v142, v143
    v_mfma_f32_32x32x16_bf16 v[128:143], a[80:83], v[40:43], 0
    v_exp_f32 v144, v144
    v_exp_f32 v145, v145
    v_exp_f32 v146, v146
    v_exp_f32 v147, v147
    v_cvt_pk_bf16_f32 v168, v144, v145
    v_cvt_pk_bf16_f32 v169, v146, v147
    v_mfma_f32_32x32x16_bf16 v[128:143], a[84:87], v[44:47], v[128:143]
L_tch4:
    s_cbranch_execz L_tch8
    global_load_dwordx4 a[152:155], v3, s[42:43] offset:2048 sc1
    v_exp_f32 v148, v148
    v_exp_f32 v149, v149
    v_exp_f32 v150, v150
    v_exp_f32 v151, v151
    v_cvt_pk_bf16_f32 v170, v148, v149
    v_cvt_pk_bf16_f32 v171, v150, v151
    v_mfma_f32_32x32x16_bf16 v[96:111], a[72:75], v[160:163], v[96:111]
    v_exp_f32 v152, v152
    v_exp_f32 v153, v153
    v_exp_f32 v154, v154
    v_exp_f32 v155, v155
    v_cvt_pk_bf16_f32 v172, v152, v153
    v_cvt_pk_bf16_f32 v173, v154, v155
    v_mfma_f32_32x32x16_bf16 v[96:111], a[76:79], v[164:167], v[96:111]
    global_load_dwordx4 a[156:159], v3, s[42:43] offset:3072 sc1
    v_exp_f32 v156, v156
    v_exp_f32 v157, v157
    v_exp_f32 v158, v158
    v_exp_f32 v159, v159
    v_cvt_pk_bf16_f32 v174, v156, v157
    v_cvt_pk_bf16_f32 v175, v158, v159
    v_mfma_f32_32x32x16_bf16 v[144:159], a[80:83], v[48:51], 0
    s_add_u32 s42, s42, 8192
    s_addc_u32 s43, s43, 0
    v_exp_f32 v128, v128
    v_exp_f32 v129, v129
    v_exp_f32 v130, v130
    v_exp_f32 v131, v131
    v_cvt_pk_bf16_f32 v160, v128, v129
    v_cvt_pk_bf16_f32 v161, v130, v131
    v_mfma_f32_32x32x16_bf16 v[144:159], a[84:87], v[52:55], v[144:159]
    global_load_dwordx4 a[160:163], v2, s[42:43] offset:-4096 sc1
    v_exp_f32 v132, v132
    v_exp_f32 v133, v133
    v_exp_f32 v134, v134
    v_exp_f32 v135, v135
    v_cvt_pk_bf16_f32 v162, v132, v133
    v_cvt_pk_bf16_f32 v163, v134, v135
    v_mfma_f32_32x32x16_bf16 v[64:79], a[88:91], v[168:171], v[64:79]
    v_exp_f32 v136, v136
    v_exp_f32 v137, v137
    v_exp_f32 v138, v138
    v_exp_f32 v139, v139
    v_cvt_pk_bf16_f32 v164, v136, v137
    v_cvt_pk_bf16_f32 v165, v138, v139
    v_mfma_f32_32x32x16_bf16 v[64:79], a[92:95], v[172:175], v[64:79]
    s_waitcnt vmcnt(14)
    global_load_dwordx4 a[164:167], v2, s[42:43] offset:-3072 sc1
    v_exp_f32 v140, v140
    v_exp_f32 v141, v141
    v_exp_f32 v142, v142
    v_exp_f32 v143, v143
    v_cvt_pk_bf16_f32 v166, v140, v141
    v_cvt_pk_bf16_f32 v167, v142, v143
    v_mfma_f32_32x32x16_bf16 v[128:143], a[96:99], v[32:35], 0
    v_exp_f32 v144, v144
    v_exp_f32 v145, v145
    v_exp_f32 v146, v146
    v_exp_f32 v147, v147
    v_cvt_pk_bf16_f32 v168, v144, v145
    v_cvt_pk_bf16_f32 v169, v146, v147
    v_mfma_f32_32x32x16_bf16 v[128:143], a[100:103], v[36:39], v[128:143]
    global_load_dwordx4 a[168:171], v3, s[42:43] offset:-2048 sc1
    v_exp_f32 v148, v148
    v_exp_f32 v149, v149
    v_exp_f32 v150, v150
    v_exp_f32 v151, v151
    v_cvt_pk_bf16_f32 v170, v148, v149
    v_cvt_pk_bf16_f32 v171, v150, v151
    v_mfma_f32_32x32x16_bf16 v[80:95], a[88:91], v[160:163], v[80:95]
    v_exp_f32 v152, v152
    v_exp_f32 v153, v153
    v_exp_f32 v154, v154
    v_exp_f32 v155, v155
    v_cvt_pk_bf16_f32 v172, v152, v153
    v_cvt_pk_bf16_f32 v173, v154, v155
    v_mfma_f32_32x32x16_bf16 v[80:95], a[92:95], v[164:167], v[80:95]
    global_load_dwordx4 a[172:175], v3, s[42:43] offset:-1024 sc1
    v_exp_f32 v156, v156
    v_exp_f32 v157, v157
    v_exp_f32 v158, v158
    v_exp_f32 v159, v159
    v_cvt_pk_bf16_f32 v174, v156, v157
    v_cvt_pk_bf16_f32 v175, v158, v159
    v_mfma_f32_32x32x16_bf16 v[144:159], a[96:99], v[40:43], 0
    v_exp_f32 v128, v128
    v_exp_f32 v129, v129
    v_exp_f32 v130, v130
    v_exp_f32 v131, v131
    v_cvt_pk_bf16_f32 v160, v128, v129
    v_cvt_pk_bf16_f32 v161, v130, v131
    v_mfma_f32_32x32x16_bf16 v[144:159], a[100:103], v[44:47], v[144:159]
    v_exp_f32 v132, v132
    v_exp_f32 v133, v133
    v_exp_f32 v134, v134
    v_exp_f32 v135, v135
    v_cvt_pk_bf16_f32 v162, v132, v133
    v_cvt_pk_bf16_f32 v163, v134, v135
    v_mfma_f32_32x32x16_bf16 v[96:111], a[88:91], v[168:171], v[96:111]
    s_add_u32 m0, s17, 2048
    v_exp_f32 v136, v136
    v_exp_f32 v137, v137
    v_exp_f32 v138, v138
    v_exp_f32 v139, v139
    v_cvt_pk_bf16_f32 v164, v136, v137
    v_cvt_pk_bf16_f32 v165, v138, v139
    v_mfma_f32_32x32x16_bf16 v[96:111], a[92:95], v[172:175], v[96:111]
    buffer_load_dwordx4 v5, s[56:59], s89 offen nt lds
    v_exp_f32 v140, v140
    v_exp_f32 v141, v141
    v_exp_f32 v142, v142
    v_exp_f32 v143, v143
    v_cvt_pk_bf16_f32 v166, v140, v141
    v_cvt_pk_bf16_f32 v167, v142, v143
    v_mfma_f32_32x32x16_bf16 v[128:143], a[96:99], v[48:51], 0
    v_exp_f32 v144, v144
    v_exp_f32 v145, v145
    v_exp_f32 v146, v146
    v_exp_f32 v147, v147
    v_cvt_pk_bf16_f32 v168, v144, v145
    v_cvt_pk_bf16_f32 v169, v146, v147
    v_mfma_f32_32x32x16_bf16 v[128:143], a[100:103], v[52:55], v[128:143]
    buffer_load_dwordx4 v5, s[56:59], s90 offen offset:1024 nt lds
    v_exp_f32 v148, v148
    v_exp_f32 v149, v149
    v_exp_f32 v150, v150
    v_exp_f32 v151, v151
    v_cvt_pk_bf16_f32 v170, v148, v149
    v_cvt_pk_bf16_f32 v171, v150, v151
    v_mfma_f32_32x32x16_bf16 v[64:79], a[104:107], v[160:163], v[64:79]
    s_add_u32 m0, s17, 4096
    v_exp_f32 v152, v152
    v_exp_f32 v153, v153
    v_exp_f32 v154, v154
    v_exp_f32 v155, v155
    v_cvt_pk_bf16_f32 v172, v152, v153
    v_cvt_pk_bf16_f32 v173, v154, v155
    v_mfma_f32_32x32x16_bf16 v[64:79], a[108:111], v[164:167], v[64:79]
    s_waitcnt vmcnt(15)
    buffer_load_dwordx4 v5, s[60:63], s89 offen nt lds
    v_exp_f32 v156, v156
    v_exp_f32 v157, v157
    v_exp_f32 v158, v158
    v_exp_f32 v159, v159
    v_cvt_pk_bf16_f32 v174, v156, v157
    v_cvt_pk_bf16_f32 v175, v158, v159
    v_mfma_f32_32x32x16_bf16 v[144:159], a[112:115], v[32:35], 0
    v_exp_f32 v128, v128
    v_exp_f32 v129, v129
    v_exp_f32 v130, v130
    v_exp_f32 v131, v131
    v_cvt_pk_bf16_f32 v160, v128, v129
    v_cvt_pk_bf16_f32 v161, v130, v131
    v_mfma_f32_32x32x16_bf16 v[144:159], a[116:119], v[36:39], v[144:159]
    buffer_load_dwordx4 v5, s[60:63], s90 offen offset:1024 nt lds
    v_exp_f32 v132, v132
    v_exp_f32 v133, v133
    v_exp_f32 v134, v134
    v_exp_f32 v135, v135
    v_cvt_pk_bf16_f32 v162, v132, v133
    v_cvt_pk_bf16_f32 v163, v134, v135
    v_mfma_f32_32x32x16_bf16 v[80:95], a[104:107], v[168:171], v[80:95]
    s_add_u32 m0, s17, 6144
    v_exp_f32 v136, v136
    v_exp_f32 v137, v137
    v_exp_f32 v138, v138
    v_exp_f32 v139, v139
    v_cvt_pk_bf16_f32 v164, v136, v137
    v_cvt_pk_bf16_f32 v165, v138, v139
    v_mfma_f32_32x32x16_bf16 v[80:95], a[108:111], v[172:175], v[80:95]
    buffer_load_dwordx4 v6, s[64:67], s91 offen nt lds
    v_exp_f32 v140, v140
    v_exp_f32 v141, v141
    v_exp_f32 v142, v142
    v_exp_f32 v143, v143
    v_cvt_pk_bf16_f32 v166, v140, v141
    v_cvt_pk_bf16_f32 v167, v142, v143
    v_mfma_f32_32x32x16_bf16 v[128:143], a[112:115], v[40:43], 0
    v_exp_f32 v144, v144
    v_exp_f32 v145, v145
    v_exp_f32 v146, v146
    v_exp_f32 v147, v147
    v_cvt_pk_bf16_f32 v168, v144, v145
    v_cvt_pk_bf16_f32 v169, v146, v147
    v_mfma_f32_32x32x16_bf16 v[128:143], a[116:119], v[44:47], v[128:143]
    buffer_load_dwordx4 v6, s[64:67], s92 offen offset:1024 nt lds
    v_exp_f32 v148, v148
    v_exp_f32 v149, v149
    v_exp_f32 v150, v150
    v_exp_f32 v151, v151
    v_cvt_pk_bf16_f32 v170, v148, v149
    v_cvt_pk_bf16_f32 v171, v150, v151
    v_mfma_f32_32x32x16_bf16 v[96:111], a[104:107], v[160:163], v[96:111]
    buffer_load_dword v7, v7, s[52:55], s84 offen
    v_exp_f32 v152, v152
    v_exp_f32 v153, v153
    v_exp_f32 v154, v154
    v_exp_f32 v155, v155
    v_cvt_pk_bf16_f32 v172, v152, v153
    v_cvt_pk_bf16_f32 v173, v154, v155
    v_mfma_f32_32x32x16_bf16 v[96:111], a[108:111], v[164:167], v[96:111]
    s_mov_b32 s50, 1835008
    v_exp_f32 v156, v156
    v_exp_f32 v157, v157
    v_exp_f32 v158, v158
    v_exp_f32 v159, v159
    v_cvt_pk_bf16_f32 v174, v156, v157
    v_cvt_pk_bf16_f32 v175, v158, v159
    v_mfma_f32_32x32x16_bf16 v[144:159], a[112:115], v[48:51], 0
    s_mov_b32 s51, 0x20000
    v_exp_f32 v128, v128
    v_exp_f32 v129, v129
    v_exp_f32 v130, v130
    v_exp_f32 v131, v131
    v_cvt_pk_bf16_f32 v160, v128, v129
    v_cvt_pk_bf16_f32 v161, v130, v131
    v_mfma_f32_32x32x16_bf16 v[144:159], a[116:119], v[52:55], v[144:159]
    s_mul_i32 s94, s3, 14336
    v_exp_f32 v132, v132
    v_exp_f32 v133, v133
    v_exp_f32 v134, v134
    v_exp_f32 v135, v135
    v_cvt_pk_bf16_f32 v162, v132, v133
    v_cvt_pk_bf16_f32 v163, v134, v135
    v_mfma_f32_32x32x16_bf16 v[64:79], a[120:123], v[168:171], v[64:79]
    s_mov_b32 s80, 0x28000000
    v_exp_f32 v136, v136
    v_exp_f32 v137, v137
    v_exp_f32 v138, v138
    v_exp_f32 v139, v139
    v_cvt_pk_bf16_f32 v164, v136, v137
    v_cvt_pk_bf16_f32 v165, v138, v139
    v_mfma_f32_32x32x16_bf16 v[64:79], a[124:127], v[172:175], v[64:79]
    s_waitcnt vmcnt(15)
    v_exp_f32 v140, v140
    v_exp_f32 v141, v141
    v_exp_f32 v142, v142
    v_exp_f32 v143, v143
    v_cvt_pk_bf16_f32 v166, v140, v141
    v_cvt_pk_bf16_f32 v167, v142, v143
    v_mfma_f32_32x32x16_bf16 v[128:143], a[128:131], v[32:35], 0
    s_add_u32 s23, s85, 28672
    v_exp_f32 v144, v144
    v_exp_f32 v145, v145
    v_exp_f32 v146, v146
    v_exp_f32 v147, v147
    v_cvt_pk_bf16_f32 v168, v144, v145
    v_cvt_pk_bf16_f32 v169, v146, v147
    v_mfma_f32_32x32x16_bf16 v[128:143], a[132:135], v[36:39], v[128:143]
    s_add_u32 s24, s85, 57344
    v_exp_f32 v148, v148
    v_exp_f32 v149, v149
    v_exp_f32 v150, v150
    v_exp_f32 v151, v151
    v_cvt_pk_bf16_f32 v170, v148, v149
    v_cvt_pk_bf16_f32 v171, v150, v151
    v_mfma_f32_32x32x16_bf16 v[80:95], a[120:123], v[160:163], v[80:95]
    s_add_u32 s25, s85, 86016
    v_exp_f32 v152, v152
    v_exp_f32 v153, v153
    v_exp_f32 v154, v154
    v_exp_f32 v155, v155
    v_cvt_pk_bf16_f32 v172, v152, v153
    v_cvt_pk_bf16_f32 v173, v154, v155
    v_mfma_f32_32x32x16_bf16 v[80:95], a[124:127], v[164:167], v[80:95]
    s_add_u32 s101, s78, 65536
    v_exp_f32 v156, v156
    v_exp_f32 v157, v157
    v_exp_f32 v158, v158
    v_exp_f32 v159, v159
    v_cvt_pk_bf16_f32 v174, v156, v157
    v_cvt_pk_bf16_f32 v175, v158, v159
    v_mfma_f32_32x32x16_bf16 v[144:159], a[128:131], v[40:43], 0
    global_load_dwordx4 v[8:11], v2, s[26:27] offset:-2048
    v_exp_f32 v128, v128
    v_exp_f32 v129, v129
    v_exp_f32 v130, v130
    v_exp_f32 v131, v131
    v_cvt_pk_bf16_f32 v160, v128, v129
    v_cvt_pk_bf16_f32 v161, v130, v131
    v_mfma_f32_32x32x16_bf16 v[144:159], a[132:135], v[44:47], v[144:159]
    s_lshl2_add_u32 s12, s41, s3
    v_exp_f32 v132, v132
    v_exp_f32 v133, v133
    v_exp_f32 v134, v134
    v_exp_f32 v135, v135
    v_cvt_pk_bf16_f32 v162, v132, v133
    v_cvt_pk_bf16_f32 v163, v134, v135
    v_mfma_f32_32x32x16_bf16 v[96:111], a[120:123], v[168:171], v[96:111]
    global_load_dwordx4 v[12:15], v2, s[26:27] offset:-1024
    v_exp_f32 v136, v136
    v_exp_f32 v137, v137
    v_exp_f32 v138, v138
    v_exp_f32 v139, v139
    v_cvt_pk_bf16_f32 v164, v136, v137
    v_cvt_pk_bf16_f32 v165, v138, v139
    v_mfma_f32_32x32x16_bf16 v[96:111], a[124:127], v[172:175], v[96:111]
    s_lshl_b32 s12, s12, 12
    v_exp_f32 v140, v140
    v_exp_f32 v141, v141
    v_exp_f32 v142, v142
    v_exp_f32 v143, v143
    v_cvt_pk_bf16_f32 v166, v140, v141
    v_cvt_pk_bf16_f32 v167, v142, v143
    v_mfma_f32_32x32x16_bf16 v[128:143], a[128:131], v[48:51], 0
    global_load_dwordx4 v[16:19], v2, s[26:27] offset:0
    v_exp_f32 v144, v144
    v_exp_f32 v145, v145
    v_exp_f32 v146, v146
    v_exp_f32 v147, v147
    v_cvt_pk_bf16_f32 v168, v144, v145
    v_cvt_pk_bf16_f32 v169, v146, v147
    v_mfma_f32_32x32x16_bf16 v[128:143], a[132:135], v[52:55], v[128:143]
    s_add_u32 s79, s12, 9437184
    v_exp_f32 v148, v148
    v_exp_f32 v149, v149
    v_exp_f32 v150, v150
    v_exp_f32 v151, v151
    v_cvt_pk_bf16_f32 v170, v148, v149
    v_cvt_pk_bf16_f32 v171, v150, v151
    v_mfma_f32_32x32x16_bf16 v[64:79], a[136:139], v[160:163], v[64:79]
    global_load_dwordx4 v[20:23], v2, s[26:27] offset:1024
    v_exp_f32 v152, v152
    v_exp_f32 v153, v153
    v_exp_f32 v154, v154
    v_exp_f32 v155, v155
    v_cvt_pk_bf16_f32 v172, v152, v153
    v_cvt_pk_bf16_f32 v173, v154, v155
    v_mfma_f32_32x32x16_bf16 v[64:79], a[140:143], v[164:167], v[64:79]
    s_waitcnt vmcnt(15)
    v_exp_f32 v156, v156
    v_exp_f32 v157, v157
    v_exp_f32 v158, v158
    v_exp_f32 v159, v159
    v_cvt_pk_bf16_f32 v174, v156, v157
    v_cvt_pk_bf16_f32 v175, v158, v159
    v_mfma_f32_32x32x16_bf16 v[144:159], a[144:147], v[32:35], 0
    global_load_dwordx4 v[24:27], v2, s[26:27] offset:2048
    v_exp_f32 v128, v128
    v_exp_f32 v129, v129
    v_exp_f32 v130, v130
    v_exp_f32 v131, v131
    v_cvt_pk_bf16_f32 v160, v128, v129
    v_cvt_pk_bf16_f32 v161, v130, v131
    v_mfma_f32_32x32x16_bf16 v[144:159], a[148:151], v[36:39], v[144:159]
    s_cmp_lt_u32 s5, 28
    s_cselect_b32 s79, s79, 1073741824
    s_cselect_b32 s69, s69, 4
    v_exp_f32 v132, v132
    v_exp_f32 v133, v133
    v_exp_f32 v134, v134
    v_exp_f32 v135, v135
    v_cvt_pk_bf16_f32 v162, v132, v133
    v_cvt_pk_bf16_f32 v163, v134, v135
    v_mfma_f32_32x32x16_bf16 v[80:95], a[136:139], v[168:171], v[80:95]
    v_exp_f32 v136, v136
    v_exp_f32 v137, v137
    v_exp_f32 v138, v138
    v_exp_f32 v139, v139
    v_cvt_pk_bf16_f32 v164, v136, v137
    v_cvt_pk_bf16_f32 v165, v138, v139
    v_mfma_f32_32x32x16_bf16 v[80:95], a[140:143], v[172:175], v[80:95]
    v_exp_f32 v140, v140
    v_exp_f32 v141, v141
    v_exp_f32 v142, v142
    v_exp_f32 v143, v143
    v_cvt_pk_bf16_f32 v166, v140, v141
    v_cvt_pk_bf16_f32 v167, v142, v143
    v_mfma_f32_32x32x16_bf16 v[128:143], a[144:147], v[40:43], 0
    global_load_dwordx4 a[176:179], v2, s[42:43] offset:0 sc1
    v_exp_f32 v144, v144
    v_exp_f32 v145, v145
    v_exp_f32 v146, v146
    v_exp_f32 v147, v147
    v_cvt_pk_bf16_f32 v168, v144, v145
    v_cvt_pk_bf16_f32 v169, v146, v147
    v_mfma_f32_32x32x16_bf16 v[128:143], a[148:151], v[44:47], v[128:143]
    v_exp_f32 v148, v148
    v_exp_f32 v149, v149
    v_exp_f32 v150, v150
    v_exp_f32 v151, v151
    v_cvt_pk_bf16_f32 v170, v148, v149
    v_cvt_pk_bf16_f32 v171, v150, v151
    v_mfma_f32_32x32x16_bf16 v[96:111], a[136:139], v[160:163], v[96:111]
    global_load_dwordx4 a[180:183], v2, s[42:43] offset:1024 sc1
    v_exp_f32 v152, v152
    v_exp_f32 v153, v153
    v_exp_f32 v154, v154
    v_exp_f32 v155, v155
    v_cvt_pk_bf16_f32 v172, v152, v153
    v_cvt_pk_bf16_f32 v173, v154, v155
    v_mfma_f32_32x32x16_bf16 v[96:111], a[140:143], v[164:167], v[96:111]
    v_exp_f32 v156, v156
    v_exp_f32 v157, v157
    v_exp_f32 v158, v158
    v_exp_f32 v159, v159
    v_cvt_pk_bf16_f32 v174, v156, v157
    v_cvt_pk_bf16_f32 v175, v158, v159
    v_mfma_f32_32x32x16_bf16 v[144:159], a[144:147], v[48:51], 0
    global_load_dwordx4 a[184:187], v3, s[42:43] offset:2048 sc1
    v_exp_f32 v128, v128
    v_exp_f32 v129, v129
    v_exp_f32 v130, v130
    v_exp_f32 v131, v131
    v_cvt_pk_bf16_f32 v160, v128, v129
    v_cvt_pk_bf16_f32 v161, v130, v131
    v_mfma_f32_32x32x16_bf16 v[144:159], a[148:151], v[52:55], v[144:159]
    v_exp_f32 v132, v132
    v_exp_f32 v133, v133
    v_exp_f32 v134, v134
    v_exp_f32 v135, v135
    v_cvt_pk_bf16_f32 v162, v132, v133
    v_cvt_pk_bf16_f32 v163, v134, v135
    v_mfma_f32_32x32x16_bf16 v[64:79], a[152:155], v[168:171], v[64:79]
    global_load_dwordx4 a[188:191], v3, s[42:43] offset:3072 sc1
    v_exp_f32 v136, v136
    v_exp_f32 v137, v137
    v_exp_f32 v138, v138
    v_exp_f32 v139, v139
    v_cvt_pk_bf16_f32 v164, v136, v137
    v_cvt_pk_bf16_f32 v165, v138, v139
    v_mfma_f32_32x32x16_bf16 v[64:79], a[156:159], v[172:175], v[64:79]
    s_waitcnt vmcnt(16)
    v_exp_f32 v140, v140
    v_exp_f32 v141, v141
    v_exp_f32 v142, v142
    v_exp_f32 v143, v143
    v_cvt_pk_bf16_f32 v166, v140, v141
    v_cvt_pk_bf16_f32 v167, v142, v143
    v_mfma_f32_32x32x16_bf16 v[128:143], a[160:163], v[32:35], 0
    s_add_u32 s42, s42, 8192
    s_addc_u32 s43, s43, 0
    v_exp_f32 v144, v144
    v_exp_f32 v145, v145
    v_exp_f32 v146, v146
    v_exp_f32 v147, v147
    v_cvt_pk_bf16_f32 v168, v144, v145
    v_cvt_pk_bf16_f32 v169, v146, v147
    v_mfma_f32_32x32x16_bf16 v[128:143], a[164:167], v[36:39], v[128:143]
    global_load_dwordx4 a[192:195], v2, s[42:43] offset:-4096 sc1
    v_exp_f32 v148, v148
    v_exp_f32 v149, v149
    v_exp_f32 v150, v150
    v_exp_f32 v151, v151
    v_cvt_pk_bf16_f32 v170, v148, v149
    v_cvt_pk_bf16_f32 v171, v150, v151
    v_mfma_f32_32x32x16_bf16 v[80:95], a[152:155], v[160:163], v[80:95]
    v_exp_f32 v152, v152
    v_exp_f32 v153, v153
    v_exp_f32 v154, v154
    v_exp_f32 v155, v155
    v_cvt_pk_bf16_f32 v172, v152, v153
    v_cvt_pk_bf16_f32 v173, v154, v155
    v_mfma_f32_32x32x16_bf16 v[80:95], a[156:159], v[164:167], v[80:95]
    global_load_dwordx4 a[196:199], v2, s[42:43] offset:-3072 sc1
    v_exp_f32 v156, v156
    v_exp_f32 v157, v157
    v_exp_f32 v158, v158
    v_exp_f32 v159, v159
    v_cvt_pk_bf16_f32 v174, v156, v157
    v_cvt_pk_bf16_f32 v175, v158, v159
    v_mfma_f32_32x32x16_bf16 v[144:159], a[160:163], v[40:43], 0
    v_exp_f32 v128, v128
    v_exp_f32 v129, v129
    v_exp_f32 v130, v130
    v_exp_f32 v131, v131
    v_cvt_pk_bf16_f32 v160, v128, v129
    v_cvt_pk_bf16_f32 v161, v130, v131
    v_mfma_f32_32x32x16_bf16 v[144:159], a[164:167], v[44:47], v[144:159]
    global_load_dwordx4 a[200:203], v3, s[42:43] offset:-2048 sc1
    v_exp_f32 v132, v132
    v_exp_f32 v133, v133
    v_exp_f32 v134, v134
    v_exp_f32 v135, v135
    v_cvt_pk_bf16_f32 v162, v132, v133
    v_cvt_pk_bf16_f32 v163, v134, v135
    v_mfma_f32_32x32x16_bf16 v[96:111], a[152:155], v[168:171], v[96:111]
    v_exp_f32 v136, v136
    v_exp_f32 v137, v137
    v_exp_f32 v138, v138
    v_exp_f32 v139, v139
    v_cvt_pk_bf16_f32 v164, v136, v137
    v_cvt_pk_bf16_f32 v165, v138, v139
    v_mfma_f32_32x32x16_bf16 v[96:111], a[156:159], v[172:175], v[96:111]
    global_load_dwordx4 a[204:207], v3, s[42:43] offset:-1024 sc1
    v_exp_f32 v140, v140
    v_exp_f32 v141, v141
    v_exp_f32 v142, v142
    v_exp_f32 v143, v143
    v_cvt_pk_bf16_f32 v166, v140, v141
    v_cvt_pk_bf16_f32 v167, v142, v143
    v_mfma_f32_32x32x16_bf16 v[128:143], a[160:163], v[48:51], 0
    v_exp_f32 v144, v144
    v_exp_f32 v145, v145
    v_exp_f32 v146, v146
    v_exp_f32 v147, v147
    v_cvt_pk_bf16_f32 v168, v144, v145
    v_cvt_pk_bf16_f32 v169, v146, v147
    v_mfma_f32_32x32x16_bf16 v[128:143], a[164:167], v[52:55], v[128:143]
    global_load_dwordx4 a[208:211], v2, s[42:43] offset:0 sc1
    v_exp_f32 v148, v148
    v_exp_f32 v149, v149
    v_exp_f32 v150, v150
    v_exp_f32 v151, v151
    v_cvt_pk_bf16_f32 v170, v148, v149
    v_cvt_pk_bf16_f32 v171, v150, v151
    v_mfma_f32_32x32x16_bf16 v[64:79], a[168:171], v[160:163], v[64:79]
    s_waitcnt vmcnt(9)
    v_exp_f32 v152, v152
    v_exp_f32 v153, v153
    v_exp_f32 v154, v154
    v_exp_f32 v155, v155
    v_cvt_pk_bf16_f32 v172, v152, v153
    v_cvt_pk_bf16_f32 v173, v154, v155
    v_mfma_f32_32x32x16_bf16 v[64:79], a[172:175], v[164:167], v[64:79]
    s_waitcnt vmcnt(5)
    global_load_dwordx4 a[212:215], v2, s[42:43] offset:1024 sc1
    v_exp_f32 v156, v156
    v_exp_f32 v157, v157
    v_exp_f32 v158, v158
    v_exp_f32 v159, v159
    v_cvt_pk_bf16_f32 v174, v156, v157
    v_cvt_pk_bf16_f32 v175, v158, v159
    v_mfma_f32_32x32x16_bf16 v[144:159], a[176:179], v[32:35], 0
    s_barrier
    ds_read_b64_tr_b16 v[176:177], v8 offset:2048
    ds_read_b64_tr_b16 v[178:179], v8 offset:2560
    v_exp_f32 v128, v128
    v_exp_f32 v129, v129
    v_exp_f32 v130, v130
    v_exp_f32 v131, v131
    v_cvt_pk_bf16_f32 v160, v128, v129
    v_cvt_pk_bf16_f32 v161, v130, v131
    v_mfma_f32_32x32x16_bf16 v[144:159], a[180:183], v[36:39], v[144:159]
    global_load_dwordx4 a[216:219], v3, s[42:43] offset:2048 sc1
    v_exp_f32 v132, v132
    v_exp_f32 v133, v133
    v_exp_f32 v134, v134
    v_exp_f32 v135, v135
    v_cvt_pk_bf16_f32 v162, v132, v133
    v_cvt_pk_bf16_f32 v163, v134, v135
    v_mfma_f32_32x32x16_bf16 v[80:95], a[168:171], v[168:171], v[80:95]
    ds_read_b64_tr_b16 v[184:185], v8 offset:4096
    ds_read_b64_tr_b16 v[186:187], v8 offset:4608
    v_exp_f32 v136, v136
    v_exp_f32 v137, v137
    v_exp_f32 v138, v138
    v_exp_f32 v139, v139
    v_cvt_pk_bf16_f32 v164, v136, v137
    v_cvt_pk_bf16_f32 v165, v138, v139
    v_mfma_f32_32x32x16_bf16 v[80:95], a[172:175], v[172:175], v[80:95]
    global_load_dwordx4 a[220:223], v3, s[42:43] offset:3072 sc1
    v_exp_f32 v140, v140
    v_exp_f32 v141, v141
    v_exp_f32 v142, v142
    v_exp_f32 v143, v143
    v_cvt_pk_bf16_f32 v166, v140, v141
    v_cvt_pk_bf16_f32 v167, v142, v143
    v_mfma_f32_32x32x16_bf16 v[128:143], a[176:179], v[40:43], 0
    s_add_u32 s42, s42, 8192
    s_addc_u32 s43, s43, 0
    ds_read_b64_tr_b16 v[180:181], v8 offset:51200
    ds_read_b64_tr_b16 v[182:183], v8 offset:51712
    v_exp_f32 v144, v144
    v_exp_f32 v145, v145
    v_exp_f32 v146, v146
    v_exp_f32 v147, v147
    v_cvt_pk_bf16_f32 v168, v144, v145
    v_cvt_pk_bf16_f32 v169, v146, v147
    v_mfma_f32_32x32x16_bf16 v[128:143], a[180:183], v[44:47], v[128:143]
    global_load_dwordx4 a[224:227], v2, s[42:43] offset:-4096 sc1
    v_exp_f32 v148, v148
    v_exp_f32 v149, v149
    v_exp_f32 v150, v150
    v_exp_f32 v151, v151
    v_cvt_pk_bf16_f32 v170, v148, v149
    v_cvt_pk_bf16_f32 v171, v150, v151
    v_mfma_f32_32x32x16_bf16 v[96:111], a[168:171], v[160:163], v[96:111]
    ds_read_b64_tr_b16 v[188:189], v8 offset:53248
    ds_read_b64_tr_b16 v[190:191], v8 offset:53760
    v_exp_f32 v152, v152
    v_exp_f32 v153, v153
    v_exp_f32 v154, v154
    v_exp_f32 v155, v155
    v_cvt_pk_bf16_f32 v172, v152, v153
    v_cvt_pk_bf16_f32 v173, v154, v155
    v_mfma_f32_32x32x16_bf16 v[96:111], a[172:175], v[164:167], v[96:111]
    global_load_dwordx4 a[228:231], v2, s[42:43] offset:-3072 sc1
    v_exp_f32 v156, v156
    v_exp_f32 v157, v157
    v_exp_f32 v158, v158
    v_exp_f32 v159, v159
    v_cvt_pk_bf16_f32 v174, v156, v157
    v_cvt_pk_bf16_f32 v175, v158, v159
    v_mfma_f32_32x32x16_bf16 v[144:159], a[176:179], v[48:51], 0
    s_waitcnt lgkmcnt(0)
    buffer_load_dword v243, v31, s[36:39], s97 offen sc1
    v_exp_f32 v128, v128
    v_exp_f32 v129, v129
    v_exp_f32 v130, v130
    v_mfma_f32_16x16x32_bf16 v[200:203], v[176:179], v[192:195], 0
    ds_read_b64_tr_b16 v[248:249], v8 offset:6144
    v_exp_f32 v131, v131
    v_cvt_pk_bf16_f32 v160, v128, v129
    v_cvt_pk_bf16_f32 v161, v130, v131
    v_lshlrev_b32 v240, 16, v242
    v_and_b32 v241, s81, v242
    v_readlane_b32 s9, v242, 0
    v_rcp_f32 v241, v241
    v_readlane_b32 s15, v242, 1
    v_xor_b32 v240, 0x80000000, v240
    v_mfma_f32_32x32x16_bf16 v[144:159], a[180:183], v[52:55], v[144:159]
    global_load_dwordx4 a[232:235], v3, s[42:43] offset:-2048 sc1
    v_exp_f32 v132, v132
    v_exp_f32 v133, v133
    v_exp_f32 v134, v134
    v_mfma_f32_16x16x32_bf16 v[204:207], v[184:187], v[192:195], 0
    ds_read_b64_tr_b16 v[250:251], v8 offset:6656
    v_exp_f32 v135, v135
    v_cvt_pk_bf16_f32 v162, v132, v133
    v_cvt_pk_bf16_f32 v163, v134, v135
    v_mfma_f32_32x32x16_bf16 v[64:79], a[184:187], v[168:171], v[64:79]
    v_exp_f32 v136, v136
    v_exp_f32 v137, v137
    v_exp_f32 v138, v138
    v_mfma_f32_16x16x32_bf16 v[200:203], v[180:183], v[196:199], v[200:203]
    ds_read_b64_tr_b16 v[252:253], v8 offset:55296
    v_exp_f32 v139, v139
    v_cvt_pk_bf16_f32 v164, v136, v137
    v_cvt_pk_bf16_f32 v165, v138, v139
    v_mfma_f32_32x32x16_bf16 v[64:79], a[188:191], v[172:175], v[64:79]
    s_waitcnt vmcnt(8)
    global_load_dwordx4 a[236:239], v3, s[42:43] offset:-1024 sc1
    v_exp_f32 v140, v140
    v_exp_f32 v141, v141
    v_exp_f32 v142, v142
    v_mfma_f32_16x16x32_bf16 v[204:207], v[188:191], v[196:199], v[204:207]
    ds_read_b64_tr_b16 v[254:255], v8 offset:55808
    v_exp_f32 v143, v143
    v_cvt_pk_bf16_f32 v166, v140, v141
    v_cvt_pk_bf16_f32 v167, v142, v143
    v_mfma_f32_32x32x16_bf16 v[128:143], a[192:195], v[32:35], 0
    v_exp_f32 v144, v144
    v_exp_f32 v145, v145
    v_exp_f32 v146, v146
    v_exp_f32 v147, v147
    v_cvt_pk_bf16_f32 v168, v144, v145
    v_cvt_pk_bf16_f32 v169, v146, v147
    v_fmac_f32_dpp v200, v200, v240 quad_perm:[2,2,2,2] row_mask:0xf bank_mask:0xf
    v_fmac_f32_dpp v201, v201, v240 quad_perm:[2,2,2,2] row_mask:0xf bank_mask:0xf
    v_fmac_f32_dpp v202, v202, v240 quad_perm:[2,2,2,2] row_mask:0xf bank_mask:0xf
    v_fmac_f32_dpp v203, v203, v240 quad_perm:[2,2,2,2] row_mask:0xf bank_mask:0xf
    v_fmac_f32_dpp v204, v204, v240 quad_perm:[2,2,2,2] row_mask:0xf bank_mask:0xf
    v_fmac_f32_dpp v205, v205, v240 quad_perm:[2,2,2,2] row_mask:0xf bank_mask:0xf
    v_fmac_f32_dpp v206, v206, v240 quad_perm:[2,2,2,2] row_mask:0xf bank_mask:0xf
    v_fmac_f32_dpp v207, v207, v240 quad_perm:[2,2,2,2] row_mask:0xf bank_mask:0xf
    v_mfma_f32_32x32x16_bf16 v[128:143], a[196:199], v[36:39], v[128:143]
    global_load_dwordx4 a[240:243], v2, s[42:43] offset:0 sc1
    v_exp_f32 v148, v148
    v_exp_f32 v149, v149
    v_exp_f32 v150, v150
    v_exp_f32 v151, v151
    v_cvt_pk_bf16_f32 v170, v148, v149
    v_cvt_pk_bf16_f32 v171, v150, v151
    v_mfma_f32_32x32x16_bf16 v[80:95], a[184:187], v[160:163], v[80:95]
    buffer_store_dwordx4 v[200:203], v9, s[36:39], s87 offen sc1
    v_exp_f32 v152, v152
    v_exp_f32 v153, v153
    v_exp_f32 v154, v154
    v_exp_f32 v155, v155
    v_cvt_pk_bf16_f32 v172, v152, v153
    v_cvt_pk_bf16_f32 v173, v154, v155
    v_mfma_f32_32x32x16_bf16 v[80:95], a[188:191], v[164:167], v[80:95]
    global_load_dwordx4 a[244:247], v2, s[42:43] offset:1024 sc1
    v_exp_f32 v156, v156
    v_exp_f32 v157, v157
    v_exp_f32 v158, v158
    v_exp_f32 v159, v159
    v_cvt_pk_bf16_f32 v174, v156, v157
    v_cvt_pk_bf16_f32 v175, v158, v159
    v_mfma_f32_32x32x16_bf16 v[144:159], a[192:195], v[40:43], 0
    buffer_store_dwordx4 v[204:207], v9, s[36:39], s87 offen offset:128 sc1
    v_exp_f32 v128, v128
    v_exp_f32 v129, v129
    v_exp_f32 v130, v130
    v_exp_f32 v131, v131
    v_cvt_pk_bf16_f32 v160, v128, v129
    v_cvt_pk_bf16_f32 v161, v130, v131
    v_mfma_f32_32x32x16_bf16 v[144:159], a[196:199], v[44:47], v[144:159]
L_tch5:
    s_cbranch_execz L_tch_ret
    global_load_dwordx4 a[248:251], v3, s[42:43] offset:2048 sc1
    v_exp_f32 v132, v132
    v_exp_f32 v133, v133
    v_exp_f32 v134, v134
    v_exp_f32 v135, v135
    v_cvt_pk_bf16_f32 v162, v132, v133
    v_cvt_pk_bf16_f32 v163, v134, v135
    v_mfma_f32_32x32x16_bf16 v[96:111], a[184:187], v[168:171], v[96:111]
    v_exp_f32 v136, v136
    v_exp_f32 v137, v137
    v_exp_f32 v138, v138
    v_exp_f32 v139, v139
    v_cvt_pk_bf16_f32 v164, v136, v137
    v_cvt_pk_bf16_f32 v165, v138, v139
    v_mfma_f32_32x32x16_bf16 v[96:111], a[188:191], v[172:175], v[96:111]
    global_load_dwordx4 a[252:255], v3, s[42:43] offset:3072 sc1
    v_exp_f32 v140, v140
    v_exp_f32 v141, v141
    v_exp_f32 v142, v142
    v_exp_f32 v143, v143
    v_cvt_pk_bf16_f32 v166, v140, v141
    v_cvt_pk_bf16_f32 v167, v142, v143
    v_mfma_f32_32x32x16_bf16 v[128:143], a[192:195], v[48:51], 0
    s_add_u32 s52, s52, s93
    s_addc_u32 s53, s53, 0
    v_exp_f32 v144, v144
    v_exp_f32 v145, v145
    v_exp_f32 v146, v146
    v_exp_f32 v147, v147
    v_cvt_pk_bf16_f32 v168, v144, v145
    v_cvt_pk_bf16_f32 v169, v146, v147
    v_mfma_f32_32x32x16_bf16 v[128:143], a[196:199], v[52:55], v[128:143]
    s_add_u32 m0, s94, 0
    v_exp_f32 v148, v148
    v_exp_f32 v149, v149
    v_exp_f32 v150, v150
    v_exp_f32 v151, v151
    v_cvt_pk_bf16_f32 v170, v148, v149
    v_cvt_pk_bf16_f32 v171, v150, v151
    v_mfma_f32_32x32x16_bf16 v[64:79], a[200:203], v[160:163], v[64:79]
    buffer_load_dwordx4 v12, s[52:55], 0 offen offset:0 lds
    v_exp_f32 v152, v152
    v_exp_f32 v153, v153
    v_exp_f32 v154, v154
    v_exp_f32 v155, v155
    v_cvt_pk_bf16_f32 v172, v152, v153
    v_cvt_pk_bf16_f32 v173, v154, v155
    v_mfma_f32_32x32x16_bf16 v[64:79], a[204:207], v[164:167], v[64:79]
    s_waitcnt vmcnt(12)
    v_exp_f32 v156, v156
    v_exp_f32 v157, v157
    v_exp_f32 v158, v158
    v_exp_f32 v159, v159
    v_cvt_pk_bf16_f32 v174, v156, v157
    v_cvt_pk_bf16_f32 v175, v158, v159
    v_mfma_f32_32x32x16_bf16 v[144:159], a[208:211], v[32:35], 0
    buffer_load_dwordx4 v13, s[52:55], 0 offen offset:1024 lds
    v_exp_f32 v128, v128
    v_exp_f32 v129, v129
    v_exp_f32 v130, v130
    v_exp_f32 v131, v131
    v_cvt_pk_bf16_f32 v160, v128, v129
    v_cvt_pk_bf16_f32 v161, v130, v131
    v_mfma_f32_32x32x16_bf16 v[144:159], a[212:215], v[36:39], v[144:159]
    s_waitcnt vmcnt(10)
    v_exp_f32 v132, v132
    v_exp_f32 v133, v133
    v_exp_f32 v134, v134
    v_exp_f32 v135, v135
    v_cvt_pk_bf16_f32 v162, v132, v133
    v_cvt_pk_bf16_f32 v163, v134, v135
    v_cmp_ge_u32 vcc, s86, v243
    v_mfma_f32_32x32x16_bf16 v[80:95], a[200:203], v[168:171], v[80:95]
    s_cbranch_vccnz L_crt
L_cok:
    buffer_load_dwordx4 v14, s[52:55], 0 offen offset:2048 lds
    v_exp_f32 v136, v136
    v_exp_f32 v137, v137
    v_exp_f32 v138, v138
    v_exp_f32 v139, v139
    v_cvt_pk_bf16_f32 v164, v136, v137
    v_cvt_pk_bf16_f32 v165, v138, v139
    v_mfma_f32_32x32x16_bf16 v[80:95], a[204:207], v[172:175], v[80:95]
    v_exp_f32 v140, v140
    v_exp_f32 v141, v141
    v_exp_f32 v142, v142
    v_exp_f32 v143, v143
    v_cvt_pk_bf16_f32 v166, v140, v141
    v_cvt_pk_bf16_f32 v167, v142, v143
    v_mfma_f32_32x32x16_bf16 v[128:143], a[208:211], v[40:43], 0
    buffer_load_dwordx4 v15, s[52:55], 0 offen offset:3072 lds
    v_exp_f32 v144, v144
    v_exp_f32 v145, v145
    v_exp_f32 v146, v146
    v_exp_f32 v147, v147
    v_cvt_pk_bf16_f32 v168, v144, v145
    v_cvt_pk_bf16_f32 v169, v146, v147
    v_mfma_f32_32x32x16_bf16 v[128:143], a[212:215], v[44:47], v[128:143]
    s_add_u32 s52, s52, 28672
    s_addc_u32 s53, s53, 0
    v_exp_f32 v148, v148
    v_exp_f32 v149, v149
    v_exp_f32 v150, v150
    v_exp_f32 v151, v151
    v_cvt_pk_bf16_f32 v170, v148, v149
    v_cvt_pk_bf16_f32 v171, v150, v151
    v_mfma_f32_32x32x16_bf16 v[96:111], a[200:203], v[160:163], v[96:111]
    s_add_u32 m0, s94, 4096
    v_exp_f32 v152, v152
    v_exp_f32 v153, v153
    v_exp_f32 v154, v154
    v_exp_f32 v155, v155
    v_cvt_pk_bf16_f32 v172, v152, v153
    v_cvt_pk_bf16_f32 v173, v154, v155
    v_mfma_f32_32x32x16_bf16 v[96:111], a[204:207], v[164:167], v[96:111]
    buffer_load_dwordx4 v12, s[52:55], 0 offen offset:0 lds
    v_exp_f32 v156, v156
    v_exp_f32 v157, v157
    v_exp_f32 v158, v158
    v_exp_f32 v159, v159
    v_cvt_pk_bf16_f32 v174, v156, v157
    v_cvt_pk_bf16_f32 v175, v158, v159
    v_mfma_f32_32x32x16_bf16 v[144:159], a[208:211], v[48:51], 0
    v_exp_f32 v128, v128
    v_exp_f32 v129, v129
    v_exp_f32 v130, v130
    v_exp_f32 v131, v131
    v_cvt_pk_bf16_f32 v160, v128, v129
    v_cvt_pk_bf16_f32 v161, v130, v131
    v_mfma_f32_32x32x16_bf16 v[144:159], a[212:215], v[52:55], v[144:159]
    buffer_load_dwordx4 v13, s[52:55], 0 offen offset:1024 lds
    v_exp_f32 v132, v132
    v_exp_f32 v133, v133
    v_exp_f32 v134, v134
    v_exp_f32 v135, v135
    v_cvt_pk_bf16_f32 v162, v132, v133
    v_cvt_pk_bf16_f32 v163, v134, v135
    v_mfma_f32_32x32x16_bf16 v[64:79], a[216:219], v[168:171], v[64:79]
    v_exp_f32 v136, v136
    v_exp_f32 v137, v137
    v_exp_f32 v138, v138
    v_exp_f32 v139, v139
    v_cvt_pk_bf16_f32 v164, v136, v137
    v_cvt_pk_bf16_f32 v165, v138, v139
    v_mfma_f32_32x32x16_bf16 v[64:79], a[220:223], v[172:175], v[64:79]
    s_waitcnt vmcnt(12)
    buffer_load_dwordx4 v14, s[52:55], 0 offen offset:2048 lds
    v_exp_f32 v140, v140
    v_exp_f32 v141, v141
    v_exp_f32 v142, v142
    v_exp_f32 v143, v143
    v_cvt_pk_bf16_f32 v166, v140, v141
    v_cvt_pk_bf16_f32 v167, v142, v143
    v_mfma_f32_32x32x16_bf16 v[128:143], a[224:227], v[32:35], 0
    v_exp_f32 v144, v144
    v_exp_f32 v145, v145
    v_exp_f32 v146, v146
    v_exp_f32 v147, v147
    v_cvt_pk_bf16_f32 v168, v144, v145
    v_cvt_pk_bf16_f32 v169, v146, v147
    v_mfma_f32_32x32x16_bf16 v[128:143], a[228:231], v[36:39], v[128:143]
    buffer_load_dwordx4 v15, s[52:55], 0 offen offset:3072 lds
    v_exp_f32 v148, v148
    v_exp_f32 v149, v149
    v_exp_f32 v150, v150
    v_exp_f32 v151, v151
    v_cvt_pk_bf16_f32 v170, v148, v149
    v_cvt_pk_bf16_f32 v171, v150, v151
    v_mfma_f32_32x32x16_bf16 v[80:95], a[216:219], v[160:163], v[80:95]
    s_add_u32 s52, s52, 28672
    s_addc_u32 s53, s53, 0
    v_exp_f32 v152, v152
    v_exp_f32 v153, v153
    v_exp_f32 v154, v154
    v_exp_f32 v155, v155
    v_cvt_pk_bf16_f32 v172, v152, v153
    v_cvt_pk_bf16_f32 v173, v154, v155
    v_mfma_f32_32x32x16_bf16 v[80:95], a[220:223], v[164:167], v[80:95]
    s_add_u32 m0, s94, 8192
    v_exp_f32 v156, v156
    v_exp_f32 v157, v157
    v_exp_f32 v158, v158
    v_exp_f32 v159, v159
    v_cvt_pk_bf16_f32 v174, v156, v157
    v_cvt_pk_bf16_f32 v175, v158, v159
    v_mfma_f32_32x32x16_bf16 v[144:159], a[224:227], v[40:43], 0
    buffer_load_dwordx4 v[176:179], v10, s[36:39], s95 offen offset:0 sc1
    v_exp_f32 v128, v128
    v_exp_f32 v129, v129
    v_exp_f32 v130, v130
    v_exp_f32 v131, v131
    v_cvt_pk_bf16_f32 v160, v128, v129
    v_cvt_pk_bf16_f32 v161, v130, v131
    v_mfma_f32_32x32x16_bf16 v[144:159], a[228:231], v[44:47], v[144:159]
    v_exp_f32 v132, v132
    v_exp_f32 v133, v133
    v_exp_f32 v134, v134
    v_exp_f32 v135, v135
    v_cvt_pk_bf16_f32 v162, v132, v133
    v_cvt_pk_bf16_f32 v163, v134, v135
    v_mfma_f32_32x32x16_bf16 v[96:111], a[216:219], v[168:171], v[96:111]
    buffer_load_dwordx4 v[180:183], v10, s[36:39], s95 offen offset:128 sc1
    v_exp_f32 v136, v136
    v_exp_f32 v137, v137
    v_exp_f32 v138, v138
    v_exp_f32 v139, v139
    v_cvt_pk_bf16_f32 v164, v136, v137
    v_cvt_pk_bf16_f32 v165, v138, v139
    v_mfma_f32_32x32x16_bf16 v[96:111], a[220:223], v[172:175], v[96:111]
    v_exp_f32 v140, v140
    v_exp_f32 v141, v141
    v_exp_f32 v142, v142
    v_exp_f32 v143, v143
    v_cvt_pk_bf16_f32 v166, v140, v141
    v_cvt_pk_bf16_f32 v167, v142, v143
    v_mfma_f32_32x32x16_bf16 v[128:143], a[224:227], v[48:51], 0
    buffer_load_dwordx4 v12, s[52:55], 0 offen offset:0 lds
    v_exp_f32 v144, v144
    v_exp_f32 v145, v145
    v_exp_f32 v146, v146
    v_exp_f32 v147, v147
    v_cvt_pk_bf16_f32 v168, v144, v145
    v_cvt_pk_bf16_f32 v169, v146, v147
    v_mfma_f32_32x32x16_bf16 v[128:143], a[228:231], v[52:55], v[128:143]
    v_exp_f32 v148, v148
    v_exp_f32 v149, v149
    v_exp_f32 v150, v150
    v_exp_f32 v151, v151
    v_cvt_pk_bf16_f32 v170, v148, v149
    v_cvt_pk_bf16_f32 v171, v150, v151
    v_mfma_f32_32x32x16_bf16 v[64:79], a[232:235], v[160:163], v[64:79]
    buffer_load_dwordx4 v13, s[52:55], 0 offen offset:1024 lds
    v_exp_f32 v152, v152
    v_exp_f32 v153, v153
    v_exp_f32 v154, v154
    v_exp_f32 v155, v155
    v_cvt_pk_bf16_f32 v172, v152, v153
    v_cvt_pk_bf16_f32 v173, v154, v155
    v_mfma_f32_32x32x16_bf16 v[64:79], a[236:239], v[164:167], v[64:79]
    s_waitcnt vmcnt(12)
    v_exp_f32 v156, v156
    v_exp_f32 v157, v157
    v_exp_f32 v158, v158
    v_exp_f32 v159, v159
    v_cvt_pk_bf16_f32 v174, v156, v157
    v_cvt_pk_bf16_f32 v175, v158, v159
    v_mfma_f32_32x32x16_bf16 v[144:159], a[240:243], v[32:35], 0
    buffer_load_dwordx4 v14, s[52:55], 0 offen offset:2048 lds
    v_exp_f32 v128, v128
    v_exp_f32 v129, v129
    v_exp_f32 v130, v130
    v_exp_f32 v131, v131
    v_cvt_pk_bf16_f32 v160, v128, v129
    v_cvt_pk_bf16_f32 v161, v130, v131
    v_mfma_f32_32x32x16_bf16 v[144:159], a[244:247], v[36:39], v[144:159]
    v_exp_f32 v132, v132
    v_exp_f32 v133, v133
    v_exp_f32 v134, v134
    v_exp_f32 v135, v135
    v_cvt_pk_bf16_f32 v162, v132, v133
    v_cvt_pk_bf16_f32 v163, v134, v135
    v_mfma_f32_32x32x16_bf16 v[80:95], a[232:235], v[168:171], v[80:95]
    buffer_load_dwordx4 v15, s[52:55], 0 offen offset:3072 lds
    v_exp_f32 v136, v136
    v_exp_f32 v137, v137
    v_exp_f32 v138, v138
    v_exp_f32 v139, v139
    v_cvt_pk_bf16_f32 v164, v136, v137
    v_cvt_pk_bf16_f32 v165, v138, v139
    v_mfma_f32_32x32x16_bf16 v[80:95], a[236:239], v[172:175], v[80:95]
    s_add_u32 s52, s52, 28672
    s_addc_u32 s53, s53, 0
    v_exp_f32 v140, v140
    v_exp_f32 v141, v141
    v_exp_f32 v142, v142
    v_exp_f32 v143, v143
    v_cvt_pk_bf16_f32 v166, v140, v141
    v_cvt_pk_bf16_f32 v167, v142, v143
    v_mfma_f32_32x32x16_bf16 v[128:143], a[240:243], v[40:43], 0
    s_add_u32 m0, s94, 12288
    v_exp_f32 v144, v144
    v_exp_f32 v145, v145
    v_exp_f32 v146, v146
    v_exp_f32 v147, v147
    v_cvt_pk_bf16_f32 v168, v144, v145
    v_cvt_pk_bf16_f32 v169, v146, v147
    v_mfma_f32_32x32x16_bf16 v[128:143], a[244:247], v[44:47], v[128:143]
    buffer_load_dwordx4 v12, s[52:55], 0 offen offset:0 lds
    v_exp_f32 v148, v148
    v_exp_f32 v149, v149
    v_exp_f32 v150, v150
    v_exp_f32 v151, v151
    v_cvt_pk_bf16_f32 v170, v148, v149
    v_cvt_pk_bf16_f32 v171, v150, v151
    v_mfma_f32_32x32x16_bf16 v[96:111], a[232:235], v[160:163], v[96:111]
    v_exp_f32 v152, v152
    v_exp_f32 v153, v153
    v_exp_f32 v154, v154
    v_exp_f32 v155, v155
    v_cvt_pk_bf16_f32 v172, v152, v153
    v_cvt_pk_bf16_f32 v173, v154, v155
    v_mfma_f32_32x32x16_bf16 v[96:111], a[236:239], v[164:167], v[96:111]
    buffer_load_dwordx4 v13, s[52:55], 0 offen offset:1024 lds
    v_exp_f32 v156, v156
    v_exp_f32 v157, v157
    v_exp_f32 v158, v158
    v_exp_f32 v159, v159
    v_cvt_pk_bf16_f32 v174, v156, v157
    v_cvt_pk_bf16_f32 v175, v158, v159
    v_mfma_f32_32x32x16_bf16 v[144:159], a[240:243], v[48:51], 0
    s_waitcnt vmcnt(6)
    v_exp_f32 v128, v128
    v_exp_f32 v129, v129
    v_exp_f32 v130, v130
    v_exp_f32 v131, v131
    v_cvt_pk_bf16_f32 v160, v128, v129
    v_cvt_pk_bf16_f32 v161, v130, v131
    v_permlane32_swap_b32 v176, v178
    v_permlane32_swap_b32 v177, v179
    v_permlane32_swap_b32 v180, v182
    v_permlane32_swap_b32 v181, v183
    v_add_f32 v176, v176, v178
    v_add_f32 v177, v177, v179
    v_add_f32 v180, v180, v182
    v_add_f32 v181, v181, v183
    v_permlane16_swap_b32 v176, v177
    v_add_f32 v176, v176, v177
    v_permlane16_swap_b32 v180, v181
    v_add_f32 v180, v180, v181
    v_cmp_u_f32 vcc, v176, v180
    v_mfma_f32_32x32x16_bf16 v[144:159], a[244:247], v[52:55], v[144:159]
    s_cbranch_vccnz L_zrt
L_zok:
    v_exp_f32 v132, v132
    v_exp_f32 v133, v133
    v_exp_f32 v134, v134
    v_exp_f32 v135, v135
    v_cvt_pk_bf16_f32 v162, v132, v133
    v_cvt_pk_bf16_f32 v163, v134, v135
    v_add_f32_dpp v176, v176, v176 row_ror:8 row_mask:0xf bank_mask:0xf
    v_add_f32_dpp v180, v180, v180 row_ror:8 row_mask:0xf bank_mask:0xf
    v_mul_f32 v176, v176, v241
    v_mul_f32 v180, v180, v241
    v_mul_f32 v177, 0xbfb8aa3b, v176
    v_exp_f32 v177, v177
    v_mul_f32 v176, v176, v180
    v_add_f32 v177, 1.0, v177
    v_rcp_f32 v177, v177
    v_mfma_f32_32x32x16_bf16 v[64:79], a[248:251], v[168:171], v[64:79]
    v_exp_f32 v136, v136
    v_exp_f32 v137, v137
    v_exp_f32 v138, v138
    v_exp_f32 v139, v139
    v_cvt_pk_bf16_f32 v164, v136, v137
    v_cvt_pk_bf16_f32 v165, v138, v139
    v_mul_f32 v176, v176, v177
    v_cvt_pk_bf16_f32 v176, v176, v176
    v_mfma_f32_32x32x16_bf16 v[64:79], a[252:255], v[172:175], v[64:79]
    ds_write_b16 v11, v176
    v_exp_f32 v140, v140
    v_exp_f32 v141, v141
    v_exp_f32 v142, v142
    v_exp_f32 v143, v143
    v_cvt_pk_bf16_f32 v166, v140, v141
    v_cvt_pk_bf16_f32 v167, v142, v143
    v_mfma_f32_32x32x16_bf16 v[128:143], a[0:3], v[56:59], 0
    v_exp_f32 v144, v144
    v_exp_f32 v145, v145
    v_exp_f32 v146, v146
    v_exp_f32 v147, v147
    v_cvt_pk_bf16_f32 v168, v144, v145
    v_cvt_pk_bf16_f32 v169, v146, v147
    v_mfma_f32_32x32x16_bf16 v[128:143], a[4:7], v[60:63], v[128:143]
    s_waitcnt lgkmcnt(0)
    v_exp_f32 v148, v148
    v_exp_f32 v149, v149
    v_exp_f32 v150, v150
    v_exp_f32 v151, v151
    v_cvt_pk_bf16_f32 v170, v148, v149
    v_cvt_pk_bf16_f32 v171, v150, v151
    v_mfma_f32_32x32x16_bf16 v[80:95], a[248:251], v[160:163], v[80:95]
    s_barrier
    ds_write_b128 v28, v[68:71] offset:10240
    ds_read_b128 v[192:195], v16 offset:0
    v_exp_f32 v152, v152
    v_exp_f32 v153, v153
    v_exp_f32 v154, v154
    v_exp_f32 v155, v155
    v_cvt_pk_bf16_f32 v172, v152, v153
    v_cvt_pk_bf16_f32 v173, v154, v155
    v_mfma_f32_32x32x16_bf16 v[80:95], a[252:255], v[164:167], v[80:95]
    ds_write_b128 v28, v[72:75] offset:11264
    ds_read_b128 v[196:199], v16 offset:64
    v_exp_f32 v156, v156
    v_exp_f32 v157, v157
    v_exp_f32 v158, v158
    v_exp_f32 v159, v159
    v_cvt_pk_bf16_f32 v174, v156, v157
    v_cvt_pk_bf16_f32 v175, v158, v159
    v_mfma_f32_32x32x16_bf16 v[144:159], a[16:19], v[56:59], 0
    ds_write_b128 v28, v[76:79] offset:12288
    v_exp_f32 v128, v128
    v_exp_f32 v129, v129
    v_exp_f32 v130, v130
    v_exp_f32 v131, v131
    v_cvt_pk_bf16_f32 v160, v128, v129
    v_cvt_pk_bf16_f32 v161, v130, v131
    v_mfma_f32_32x32x16_bf16 v[144:159], a[20:23], v[60:63], v[144:159]
    s_waitcnt lgkmcnt(1)
    global_load_dwordx4 v[48:51], v2, s[26:27] offset:3072
    v_exp_f32 v132, v132
    v_exp_f32 v133, v133
    v_exp_f32 v134, v134
    v_exp_f32 v135, v135
    v_cvt_pk_bf16_f32 v162, v132, v133
    v_cvt_pk_bf16_f32 v163, v134, v135
    v_mfma_f32_32x32x16_bf16 v[96:111], a[248:251], v[168:171], v[96:111]
    ds_write_b128 v28, v[84:87] offset:14336
    v_exp_f32 v136, v136
    v_exp_f32 v137, v137
    v_exp_f32 v138, v138
    v_mfma_f32_16x16x32_bf16 v[200:203], v[248:251], v[192:195], 0
    v_exp_f32 v139, v139
    v_cvt_pk_bf16_f32 v164, v136, v137
    v_cvt_pk_bf16_f32 v165, v138, v139
    v_mfma_f32_32x32x16_bf16 v[96:111], a[252:255], v[172:175], v[96:111]
    ds_write_b128 v28, v[88:91] offset:15360
    v_exp_f32 v140, v140
    v_exp_f32 v141, v141
    v_exp_f32 v142, v142
    v_mfma_f32_16x16x32_bf16 v[200:203], v[252:255], v[196:199], v[200:203]
    v_exp_f32 v143, v143
    v_cvt_pk_bf16_f32 v166, v140, v141
    v_cvt_pk_bf16_f32 v167, v142, v143
    v_mfma_f32_32x32x16_bf16 v[128:143], a[32:35], v[56:59], 0
    ds_write_b128 v28, v[92:95] offset:16384
    v_exp_f32 v144, v144
    v_exp_f32 v145, v145
    v_exp_f32 v146, v146
    v_exp_f32 v147, v147
    v_cvt_pk_bf16_f32 v168, v144, v145
    v_cvt_pk_bf16_f32 v169, v146, v147
    v_mfma_f32_32x32x16_bf16 v[128:143], a[36:39], v[60:63], v[128:143]
    buffer_store_dwordx4 v[200:203], v17, s[36:39], s87 offen sc1
    v_exp_f32 v148, v148
    v_exp_f32 v149, v149
    v_exp_f32 v150, v150
    v_exp_f32 v151, v151
    v_cvt_pk_bf16_f32 v170, v148, v149
    v_cvt_pk_bf16_f32 v171, v150, v151
    v_mfma_f32_32x32x16_bf16 v[112:127], a[8:11], v[160:163], 0
    ds_write_b128 v28, v[100:103] offset:18432
    v_exp_f32 v152, v152
    v_exp_f32 v153, v153
    v_exp_f32 v154, v154
    v_exp_f32 v155, v155
    v_cvt_pk_bf16_f32 v172, v152, v153
    v_cvt_pk_bf16_f32 v173, v154, v155
    v_mfma_f32_32x32x16_bf16 v[112:127], a[12:15], v[164:167], v[112:127]
    ds_write_b128 v28, v[104:107] offset:19456
    v_exp_f32 v156, v156
    v_exp_f32 v157, v157
    v_exp_f32 v158, v158
    v_exp_f32 v159, v159
    v_cvt_pk_bf16_f32 v174, v156, v157
    v_cvt_pk_bf16_f32 v175, v158, v159
    v_mfma_f32_32x32x16_bf16 v[144:159], a[48:51], v[56:59], 0
    ds_write_b128 v28, v[108:111] offset:20480
    v_exp_f32 v128, v128
    v_exp_f32 v129, v129
    v_exp_f32 v130, v130
    v_exp_f32 v131, v131
    v_cvt_pk_bf16_f32 v160, v128, v129
    v_cvt_pk_bf16_f32 v161, v130, v131
    v_mfma_f32_32x32x16_bf16 v[144:159], a[52:55], v[60:63], v[144:159]
    buffer_load_dword v30, v30, s[44:47], 0 offen offset:128 sc1
    v_exp_f32 v132, v132
    v_exp_f32 v133, v133
    v_exp_f32 v134, v134
    v_exp_f32 v135, v135
    v_cvt_pk_bf16_f32 v162, v132, v133
    v_cvt_pk_bf16_f32 v163, v134, v135
    v_mfma_f32_32x32x16_bf16 v[112:127], a[24:27], v[168:171], v[112:127]
    s_waitcnt lgkmcnt(0)
    v_exp_f32 v136, v136
    v_exp_f32 v137, v137
    v_exp_f32 v138, v138
    v_exp_f32 v139, v139
    v_cvt_pk_bf16_f32 v164, v136, v137
    v_cvt_pk_bf16_f32 v165, v138, v139
    v_mfma_f32_32x32x16_bf16 v[112:127], a[28:31], v[172:175], v[112:127]
    s_barrier
    v_exp_f32 v140, v140
    v_exp_f32 v141, v141
    v_exp_f32 v142, v142
    v_exp_f32 v143, v143
    v_cvt_pk_bf16_f32 v166, v140, v141
    v_cvt_pk_bf16_f32 v167, v142, v143
    v_mfma_f32_32x32x16_bf16 v[128:143], a[64:67], v[56:59], 0
    ds_read_b128 v[72:75], v21 offset:10240
    ds_read_b128 v[68:71], v20 offset:10240
    v_exp_f32 v144, v144
    v_exp_f32 v145, v145
    v_exp_f32 v146, v146
    v_exp_f32 v147, v147
    v_cvt_pk_bf16_f32 v168, v144, v145
    v_cvt_pk_bf16_f32 v169, v146, v147
    v_mfma_f32_32x32x16_bf16 v[128:143], a[68:71], v[60:63], v[128:143]
    ds_read_b128 v[76:79], v22 offset:10240
    ds_read_b128 v[88:91], v21 offset:14336
    v_exp_f32 v148, v148
    v_exp_f32 v149, v149
    v_exp_f32 v150, v150
    v_exp_f32 v151, v151
    v_cvt_pk_bf16_f32 v170, v148, v149
    v_cvt_pk_bf16_f32 v171, v150, v151
    v_mfma_f32_32x32x16_bf16 v[112:127], a[40:43], v[160:163], v[112:127]
    ds_read_b128 v[84:87], v20 offset:14336
    ds_read_b128 v[92:95], v22 offset:14336
    v_exp_f32 v152, v152
    v_exp_f32 v153, v153
    v_exp_f32 v154, v154
    v_exp_f32 v155, v155
    v_cvt_pk_bf16_f32 v172, v152, v153
    v_cvt_pk_bf16_f32 v173, v154, v155
    v_mfma_f32_32x32x16_bf16 v[112:127], a[44:47], v[164:167], v[112:127]
    ds_read_b128 v[104:107], v21 offset:18432
    v_exp_f32 v156, v156
    v_exp_f32 v157, v157
    v_exp_f32 v158, v158
    v_exp_f32 v159, v159
    v_cvt_pk_bf16_f32 v174, v156, v157
    v_cvt_pk_bf16_f32 v175, v158, v159
    v_mfma_f32_32x32x16_bf16 v[144:159], a[80:83], v[56:59], 0
    s_waitcnt lgkmcnt(1)
    v_exp_f32 v128, v128
    v_exp_f32 v129, v129
    v_exp_f32 v130, v130
    v_exp_f32 v131, v131
    v_cvt_pk_bf16_f32 v160, v128, v129
    v_cvt_pk_bf16_f32 v161, v130, v131
    v_pk_add_f32 v[66:67], v[66:67], v[74:75]
    v_pk_add_f32 v[70:71], v[70:71], v[78:79]
    v_pk_add_f32 v[64:65], v[64:65], v[72:73]
    v_pk_add_f32 v[66:67], v[66:67], v[70:71]
    v_rcp_f32 v72, v67
    v_pk_add_f32 v[68:69], v[68:69], v[76:77]
    v_subrev_u32 v70, 0x2b800000, v67
    v_mov_b32 v74, v72
    v_pk_add_f32 v[64:65], v[64:65], v[68:69]
    v_cndmask_b32 v67, 0, v67, s[20:21]
    v_permlane32_swap_b32 v74, v72
    v_cmp_le_u32 s[82:83], s80, v70
    v_pk_mul_f32 v[64:65], v[64:65], v[72:73] op_sel_hi:[1,0]
    v_pk_mul_f32 v[66:67], v[66:67], v[72:73] op_sel_hi:[1,0]
    v_cvt_pk_bf16_f32 v32, v64, v65
    v_cvt_pk_bf16_f32 v33, v66, v67
    v_pk_add_f32 v[82:83], v[82:83], v[90:91]
    v_pk_add_f32 v[86:87], v[86:87], v[94:95]
    v_pk_add_f32 v[80:81], v[80:81], v[88:89]
    v_pk_add_f32 v[82:83], v[82:83], v[86:87]
    v_rcp_f32 v88, v83
    v_pk_add_f32 v[84:85], v[84:85], v[92:93]
    v_subrev_u32 v86, 0x2b800000, v83
    v_mov_b32 v90, v88
    v_pk_add_f32 v[80:81], v[80:81], v[84:85]
    v_cndmask_b32 v83, 0, v83, s[20:21]
    v_permlane32_swap_b32 v90, v88
    v_cmp_le_u32 vcc, s80, v86
    v_pk_mul_f32 v[80:81], v[80:81], v[88:89] op_sel_hi:[1,0]
    v_pk_mul_f32 v[82:83], v[82:83], v[88:89] op_sel_hi:[1,0]
    v_cvt_pk_bf16_f32 v34, v80, v81
    v_cvt_pk_bf16_f32 v35, v82, v83
    v_mfma_f32_32x32x16_bf16 v[144:159], a[84:87], v[60:63], v[144:159]
    s_or_b32 s12, s83, vcc_hi
    s_cselect_b32 s11, 1073741824, s78
    s_cselect_b32 s75, 3, 0
    ds_read_b128 v[100:103], v20 offset:18432
    ds_read_b128 v[108:111], v22 offset:18432
    v_exp_f32 v132, v132
    v_exp_f32 v133, v133
    v_exp_f32 v134, v134
    v_exp_f32 v135, v135
    v_cvt_pk_bf16_f32 v162, v132, v133
    v_cvt_pk_bf16_f32 v163, v134, v135
    v_permlane32_swap_b32 v32, v34
    v_permlane32_swap_b32 v33, v35
    v_mfma_f32_32x32x16_bf16 v[112:127], a[56:59], v[168:171], v[112:127]
    buffer_store_dwordx4 v[32:35], v18, s[36:39], s11 offen sc1
    v_exp_f32 v136, v136
    v_exp_f32 v137, v137
    v_exp_f32 v138, v138
    v_exp_f32 v139, v139
    v_cvt_pk_bf16_f32 v164, v136, v137
    v_cvt_pk_bf16_f32 v165, v138, v139
    v_mfma_f32_32x32x16_bf16 v[112:127], a[60:63], v[172:175], v[112:127]
    s_waitcnt lgkmcnt(0)
    v_exp_f32 v140, v140
    v_exp_f32 v141, v141
    v_exp_f32 v142, v142
    v_exp_f32 v143, v143
    v_cvt_pk_bf16_f32 v166, v140, v141
    v_cvt_pk_bf16_f32 v167, v142, v143
    v_pk_add_f32 v[98:99], v[98:99], v[106:107]
    v_pk_add_f32 v[102:103], v[102:103], v[110:111]
    v_pk_add_f32 v[96:97], v[96:97], v[104:105]
    v_pk_add_f32 v[98:99], v[98:99], v[102:103]
    v_rcp_f32 v104, v99
    v_pk_add_f32 v[100:101], v[100:101], v[108:109]
    v_subrev_u32 v102, 0x2b800000, v99
    v_mov_b32 v106, v104
    v_pk_add_f32 v[96:97], v[96:97], v[100:101]
    v_cndmask_b32 v99, 0, v99, s[20:21]
    v_permlane32_swap_b32 v106, v104
    v_cmp_le_u32 vcc, s80, v102
    v_pk_mul_f32 v[96:97], v[96:97], v[104:105] op_sel_hi:[1,0]
    v_pk_mul_f32 v[98:99], v[98:99], v[104:105] op_sel_hi:[1,0]
    v_cvt_pk_bf16_f32 v36, v96, v97
    v_cvt_pk_bf16_f32 v37, v98, v99
    v_mfma_f32_32x32x16_bf16 v[128:143], a[96:99], v[56:59], 0
    s_cmp_lg_u32 vcc_hi, 0
    s_cselect_b32 s11, 1073741824, s101
    s_cselect_b32 s12, 4, 0
    v_exp_f32 v144, v144
    v_exp_f32 v145, v145
    v_exp_f32 v146, v146
    v_exp_f32 v147, v147
    v_cvt_pk_bf16_f32 v168, v144, v145
    v_cvt_pk_bf16_f32 v169, v146, v147
    v_permlane32_swap_b32 v36, v38
    v_permlane32_swap_b32 v37, v39
    v_mfma_f32_32x32x16_bf16 v[128:143], a[100:103], v[60:63], v[128:143]
    s_waitcnt vmcnt(4)
    buffer_store_dwordx4 v[36:39], v19, s[36:39], s11 offen sc1
    v_exp_f32 v148, v148
    v_exp_f32 v149, v149
    v_exp_f32 v150, v150
    v_exp_f32 v151, v151
    v_cvt_pk_bf16_f32 v170, v148, v149
    v_cvt_pk_bf16_f32 v171, v150, v151
    v_mfma_f32_32x32x16_bf16 v[112:127], a[72:75], v[160:163], v[112:127]
    s_or_b32 s75, s75, s12
    ds_read_b64_tr_b16 a[0:1], v24 offset:0
    ds_read_b64_tr_b16 a[2:3], v26 offset:512
    v_exp_f32 v152, v152
    v_exp_f32 v153, v153
    v_exp_f32 v154, v154
    v_exp_f32 v155, v155
    v_cvt_pk_bf16_f32 v172, v152, v153
    v_cvt_pk_bf16_f32 v173, v154, v155
    v_mfma_f32_32x32x16_bf16 v[112:127], a[76:79], v[164:167], v[112:127]
    s_add_u32 s12, s78, 98304
    ds_read_b64_tr_b16 a[4:5], v25 offset:0
    ds_read_b64_tr_b16 a[6:7], v27 offset:512
    v_exp_f32 v156, v156
    v_exp_f32 v157, v157
    v_exp_f32 v158, v158
    v_exp_f32 v159, v159
    v_cvt_pk_bf16_f32 v174, v156, v157
    v_cvt_pk_bf16_f32 v175, v158, v159
    v_mfma_f32_32x32x16_bf16 v[144:159], a[112:115], v[56:59], 0
    s_waitcnt vmcnt(2)
    ds_read_b64_tr_b16 a[8:9], v26 offset:0
    ds_read_b64_tr_b16 a[10:11], v24 offset:512
    v_exp_f32 v128, v128
    v_exp_f32 v129, v129
    v_exp_f32 v130, v130
    v_exp_f32 v131, v131
    v_cvt_pk_bf16_f32 v160, v128, v129
    v_cvt_pk_bf16_f32 v161, v130, v131
    v_cmp_eq_u32 vcc, 0, v30
    v_mfma_f32_32x32x16_bf16 v[144:159], a[116:119], v[60:63], v[144:159]
    s_cbranch_vccnz L_srt
L_sok:
    ds_read_b64_tr_b16 a[12:13], v27 offset:0
    ds_read_b64_tr_b16 a[14:15], v25 offset:512
    v_exp_f32 v132, v132
    v_exp_f32 v133, v133
    v_exp_f32 v134, v134
    v_exp_f32 v135, v135
    v_cvt_pk_bf16_f32 v162, v132, v133
    v_cvt_pk_bf16_f32 v163, v134, v135
    v_mfma_f32_32x32x16_bf16 v[112:127], a[88:91], v[168:171], v[112:127]
    s_bitcmp1_b32 s69, 0
    s_cselect_b32 s95, 0, 64
    s_cselect_b32 s73, s73, s74
    ds_read_b64_tr_b16 a[16:17], v26 offset:3584
    ds_read_b64_tr_b16 a[18:19], v24 offset:4096
    v_exp_f32 v136, v136
    v_exp_f32 v137, v137
    v_exp_f32 v138, v138
    v_exp_f32 v139, v139
    v_cvt_pk_bf16_f32 v164, v136, v137
    v_cvt_pk_bf16_f32 v165, v138, v139
    v_mfma_f32_32x32x16_bf16 v[112:127], a[92:95], v[172:175], v[112:127]
    s_lshl_b32 s14, s40, 8
    ds_read_b64_tr_b16 a[20:21], v27 offset:3584
    ds_read_b64_tr_b16 a[22:23], v25 offset:4096
L_tch6:
    s_cbranch_execz L_tch_ret
    v_exp_f32 v140, v140
    v_exp_f32 v141, v141
    v_exp_f32 v142, v142
    v_exp_f32 v143, v143
    v_cvt_pk_bf16_f32 v166, v140, v141
    v_cvt_pk_bf16_f32 v167, v142, v143
    v_mfma_f32_32x32x16_bf16 v[128:143], a[128:131], v[56:59], 0
    s_add_u32 s95, s95, s14
    ds_read_b64_tr_b16 a[24:25], v24 offset:3584
    ds_read_b64_tr_b16 a[26:27], v26 offset:4096
    v_exp_f32 v144, v144
    v_exp_f32 v145, v145
    v_exp_f32 v146, v146
    v_exp_f32 v147, v147
    v_cvt_pk_bf16_f32 v168, v144, v145
    v_cvt_pk_bf16_f32 v169, v146, v147
    v_mfma_f32_32x32x16_bf16 v[128:143], a[132:135], v[60:63], v[128:143]
    s_add_u32 s95, s95, 5767168
    ds_read_b64_tr_b16 a[28:29], v25 offset:3584
    ds_read_b64_tr_b16 a[30:31], v27 offset:4096
    v_exp_f32 v148, v148
    v_exp_f32 v149, v149
    v_exp_f32 v150, v150
    v_exp_f32 v151, v151
    v_cvt_pk_bf16_f32 v170, v148, v149
    v_cvt_pk_bf16_f32 v171, v150, v151
    v_mfma_f32_32x32x16_bf16 v[112:127], a[104:107], v[160:163], v[112:127]
    s_mul_i32 s16, s73, 896
    ds_read_b64_tr_b16 a[32:33], v24 offset:7168
    ds_read_b64_tr_b16 a[34:35], v26 offset:7680
    v_exp_f32 v152, v152
    v_exp_f32 v153, v153
    v_exp_f32 v154, v154
    v_exp_f32 v155, v155
    v_cvt_pk_bf16_f32 v172, v152, v153
    v_cvt_pk_bf16_f32 v173, v154, v155
    v_mfma_f32_32x32x16_bf16 v[112:127], a[108:111], v[164:167], v[112:127]
    s_add_u32 s16, s16, s93
    ds_read_b64_tr_b16 a[36:37], v25 offset:7168
    ds_read_b64_tr_b16 a[38:39], v27 offset:7680
    v_exp_f32 v156, v156
    v_exp_f32 v157, v157
    v_exp_f32 v158, v158
    v_exp_f32 v159, v159
    v_cvt_pk_bf16_f32 v174, v156, v157
    v_cvt_pk_bf16_f32 v175, v158, v159
    v_mfma_f32_32x32x16_bf16 v[144:159], a[144:147], v[56:59], 0
    s_and_b32 s14, s69, 3
    s_cselect_b32 s95, s95, 1073741824
    ds_read_b64_tr_b16 a[40:41], v26 offset:7168
    ds_read_b64_tr_b16 a[42:43], v24 offset:7680
    v_exp_f32 v128, v128
    v_exp_f32 v129, v129
    v_exp_f32 v130, v130
    v_exp_f32 v131, v131
    v_cvt_pk_bf16_f32 v160, v128, v129
    v_cvt_pk_bf16_f32 v161, v130, v131
    v_mfma_f32_32x32x16_bf16 v[144:159], a[148:151], v[60:63], v[144:159]
    ds_read_b64_tr_b16 a[44:45], v27 offset:7168
    ds_read_b64_tr_b16 a[46:47], v25 offset:7680
    v_exp_f32 v132, v132
    v_exp_f32 v133, v133
    v_exp_f32 v134, v134
    v_exp_f32 v135, v135
    v_cvt_pk_bf16_f32 v162, v132, v133
    v_cvt_pk_bf16_f32 v163, v134, v135
    v_mfma_f32_32x32x16_bf16 v[112:127], a[120:123], v[168:171], v[112:127]
    ds_read_b64_tr_b16 a[48:49], v26 offset:10752
    ds_read_b64_tr_b16 a[50:51], v24 offset:11264
    v_exp_f32 v136, v136
    v_exp_f32 v137, v137
    v_exp_f32 v138, v138
    v_exp_f32 v139, v139
    v_cvt_pk_bf16_f32 v164, v136, v137
    v_cvt_pk_bf16_f32 v165, v138, v139
    v_mfma_f32_32x32x16_bf16 v[112:127], a[124:127], v[172:175], v[112:127]
    ds_read_b64_tr_b16 a[52:53], v27 offset:10752
    ds_read_b64_tr_b16 a[54:55], v25 offset:11264
    v_exp_f32 v140, v140
    v_exp_f32 v141, v141
    v_exp_f32 v142, v142
    v_exp_f32 v143, v143
    v_cvt_pk_bf16_f32 v166, v140, v141
    v_cvt_pk_bf16_f32 v167, v142, v143
    v_mfma_f32_32x32x16_bf16 v[128:143], a[160:163], v[56:59], 0
    buffer_load_dwordx2 v[52:53], v50, s[28:31], s16 offen
    v_exp_f32 v144, v144
    v_exp_f32 v145, v145
    v_exp_f32 v146, v146
    v_exp_f32 v147, v147
    v_cvt_pk_bf16_f32 v168, v144, v145
    v_cvt_pk_bf16_f32 v169, v146, v147
    v_mfma_f32_32x32x16_bf16 v[128:143], a[164:167], v[60:63], v[128:143]
    buffer_load_dwordx4 v[40:43], v48, s[36:39], s95 offen sc1
    v_exp_f32 v148, v148
    v_exp_f32 v149, v149
    v_exp_f32 v150, v150
    v_exp_f32 v151, v151
    v_cvt_pk_bf16_f32 v170, v148, v149
    v_cvt_pk_bf16_f32 v171, v150, v151
    v_mfma_f32_32x32x16_bf16 v[112:127], a[136:139], v[160:163], v[112:127]
    buffer_load_dwordx4 v[44:47], v49, s[36:39], s95 offen sc1
    v_exp_f32 v152, v152
    v_exp_f32 v153, v153
    v_exp_f32 v154, v154
    v_exp_f32 v155, v155
    v_cvt_pk_bf16_f32 v172, v152, v153
    v_cvt_pk_bf16_f32 v173, v154, v155
    v_mfma_f32_32x32x16_bf16 v[112:127], a[140:143], v[164:167], v[112:127]
    ds_read_b64_tr_b16 a[56:57], v24 offset:10752
    ds_read_b64_tr_b16 a[58:59], v26 offset:11264
    v_exp_f32 v156, v156
    v_exp_f32 v157, v157
    v_exp_f32 v158, v158
    v_exp_f32 v159, v159
    v_cvt_pk_bf16_f32 v174, v156, v157
    v_cvt_pk_bf16_f32 v175, v158, v159
    v_mfma_f32_32x32x16_bf16 v[144:159], a[176:179], v[56:59], 0
    s_add_u32 s13, s79, 0
    ds_read_b64_tr_b16 a[60:61], v25 offset:10752
    ds_read_b64_tr_b16 a[62:63], v27 offset:11264
    v_exp_f32 v128, v128
    v_exp_f32 v129, v129
    v_exp_f32 v130, v130
    v_exp_f32 v131, v131
    v_cvt_pk_bf16_f32 v160, v128, v129
    v_cvt_pk_bf16_f32 v161, v130, v131
    v_mfma_f32_32x32x16_bf16 v[144:159], a[180:183], v[60:63], v[144:159]
    buffer_load_dwordx4 v[64:67], v2, s[36:39], s13 offen offset:0 sc1
    v_exp_f32 v132, v132
    v_exp_f32 v133, v133
    v_exp_f32 v134, v134
    v_exp_f32 v135, v135
    v_cvt_pk_bf16_f32 v162, v132, v133
    v_cvt_pk_bf16_f32 v163, v134, v135
    v_mfma_f32_32x32x16_bf16 v[112:127], a[152:155], v[168:171], v[112:127]
    v_exp_f32 v136, v136
    v_exp_f32 v137, v137
    v_exp_f32 v138, v138
    v_exp_f32 v139, v139
    v_cvt_pk_bf16_f32 v164, v136, v137
    v_cvt_pk_bf16_f32 v165, v138, v139
    v_mfma_f32_32x32x16_bf16 v[112:127], a[156:159], v[172:175], v[112:127]
    buffer_load_dwordx4 v[68:71], v2, s[36:39], s13 offen offset:1024 sc1
    v_exp_f32 v140, v140
    v_exp_f32 v141, v141
    v_exp_f32 v142, v142
    v_exp_f32 v143, v143
    v_cvt_pk_bf16_f32 v166, v140, v141
    v_cvt_pk_bf16_f32 v167, v142, v143
    v_mfma_f32_32x32x16_bf16 v[128:143], a[192:195], v[56:59], 0
    v_exp_f32 v144, v144
    v_exp_f32 v145, v145
    v_exp_f32 v146, v146
    v_exp_f32 v147, v147
    v_cvt_pk_bf16_f32 v168, v144, v145
    v_cvt_pk_bf16_f32 v169, v146, v147
    v_mfma_f32_32x32x16_bf16 v[128:143], a[196:199], v[60:63], v[128:143]
    buffer_load_dwordx4 v[72:75], v2, s[36:39], s13 offen offset:2048 sc1
    v_exp_f32 v148, v148
    v_exp_f32 v149, v149
    v_exp_f32 v150, v150
    v_exp_f32 v151, v151
    v_cvt_pk_bf16_f32 v170, v148, v149
    v_cvt_pk_bf16_f32 v171, v150, v151
    v_mfma_f32_32x32x16_bf16 v[112:127], a[168:171], v[160:163], v[112:127]
    v_exp_f32 v152, v152
    v_exp_f32 v153, v153
    v_exp_f32 v154, v154
    v_exp_f32 v155, v155
    v_cvt_pk_bf16_f32 v172, v152, v153
    v_cvt_pk_bf16_f32 v173, v154, v155
    v_mfma_f32_32x32x16_bf16 v[112:127], a[172:175], v[164:167], v[112:127]
    buffer_load_dwordx4 v[76:79], v2, s[36:39], s13 offen offset:3072 sc1
    v_exp_f32 v156, v156
    v_exp_f32 v157, v157
    v_exp_f32 v158, v158
    v_exp_f32 v159, v159
    v_cvt_pk_bf16_f32 v174, v156, v157
    v_cvt_pk_bf16_f32 v175, v158, v159
    v_mfma_f32_32x32x16_bf16 v[144:159], a[208:211], v[56:59], 0
    s_add_u32 s13, s79, 32768
    v_exp_f32 v128, v128
    v_exp_f32 v129, v129
    v_exp_f32 v130, v130
    v_exp_f32 v131, v131
    v_cvt_pk_bf16_f32 v160, v128, v129
    v_cvt_pk_bf16_f32 v161, v130, v131
    v_mfma_f32_32x32x16_bf16 v[144:159], a[212:215], v[60:63], v[144:159]
    buffer_load_dwordx4 v[80:83], v2, s[36:39], s13 offen offset:0 sc1
    v_exp_f32 v132, v132
    v_exp_f32 v133, v133
    v_exp_f32 v134, v134
    v_exp_f32 v135, v135
    v_cvt_pk_bf16_f32 v162, v132, v133
    v_cvt_pk_bf16_f32 v163, v134, v135
    v_mfma_f32_32x32x16_bf16 v[112:127], a[184:187], v[168:171], v[112:127]
    v_exp_f32 v136, v136
    v_exp_f32 v137, v137
    v_exp_f32 v138, v138
    v_exp_f32 v139, v139
    v_cvt_pk_bf16_f32 v164, v136, v137
    v_cvt_pk_bf16_f32 v165, v138, v139
    v_mfma_f32_32x32x16_bf16 v[112:127], a[188:191], v[172:175], v[112:127]
    buffer_load_dwordx4 v[84:87], v2, s[36:39], s13 offen offset:1024 sc1
    v_exp_f32 v140, v140
    v_exp_f32 v141, v141
    v_exp_f32 v142, v142
    v_exp_f32 v143, v143
    v_cvt_pk_bf16_f32 v166, v140, v141
    v_cvt_pk_bf16_f32 v167, v142, v143
    v_mfma_f32_32x32x16_bf16 v[128:143], a[224:227], v[56:59], 0
    v_exp_f32 v144, v144
    v_exp_f32 v145, v145
    v_exp_f32 v146, v146
    v_exp_f32 v147, v147
    v_cvt_pk_bf16_f32 v168, v144, v145
    v_cvt_pk_bf16_f32 v169, v146, v147
    v_mfma_f32_32x32x16_bf16 v[128:143], a[228:231], v[60:63], v[128:143]
    buffer_load_dwordx4 v[88:91], v2, s[36:39], s13 offen offset:2048 sc1
    v_exp_f32 v148, v148
    v_exp_f32 v149, v149
    v_exp_f32 v150, v150
    v_exp_f32 v151, v151
    v_cvt_pk_bf16_f32 v170, v148, v149
    v_cvt_pk_bf16_f32 v171, v150, v151
    v_mfma_f32_32x32x16_bf16 v[112:127], a[200:203], v[160:163], v[112:127]
    v_exp_f32 v152, v152
    v_exp_f32 v153, v153
    v_exp_f32 v154, v154
    v_exp_f32 v155, v155
    v_cvt_pk_bf16_f32 v172, v152, v153
    v_cvt_pk_bf16_f32 v173, v154, v155
    v_mfma_f32_32x32x16_bf16 v[112:127], a[204:207], v[164:167], v[112:127]
    buffer_load_dwordx4 v[92:95], v2, s[36:39], s13 offen offset:3072 sc1
    v_exp_f32 v156, v156
    v_exp_f32 v157, v157
    v_exp_f32 v158, v158
    v_exp_f32 v159, v159
    v_cvt_pk_bf16_f32 v174, v156, v157
    v_cvt_pk_bf16_f32 v175, v158, v159
    v_mfma_f32_32x32x16_bf16 v[144:159], a[240:243], v[56:59], 0
    v_exp_f32 v128, v128
    v_exp_f32 v129, v129
    v_exp_f32 v130, v130
    v_exp_f32 v131, v131
    v_cvt_pk_bf16_f32 v160, v128, v129
    v_cvt_pk_bf16_f32 v161, v130, v131
    v_mfma_f32_32x32x16_bf16 v[144:159], a[244:247], v[60:63], v[144:159]
    v_exp_f32 v132, v132
    v_exp_f32 v133, v133
    v_exp_f32 v134, v134
    v_exp_f32 v135, v135
    v_cvt_pk_bf16_f32 v162, v132, v133
    v_cvt_pk_bf16_f32 v163, v134, v135
    v_mfma_f32_32x32x16_bf16 v[112:127], a[216:219], v[168:171], v[112:127]
    v_exp_f32 v136, v136
    v_exp_f32 v137, v137
    v_exp_f32 v138, v138
    v_exp_f32 v139, v139
    v_cvt_pk_bf16_f32 v164, v136, v137
    v_cvt_pk_bf16_f32 v165, v138, v139
    v_mfma_f32_32x32x16_bf16 v[112:127], a[220:223], v[172:175], v[112:127]
    v_exp_f32 v140, v140
    v_exp_f32 v141, v141
    v_exp_f32 v142, v142
    v_exp_f32 v143, v143
    v_cvt_pk_bf16_f32 v166, v140, v141
    v_cvt_pk_bf16_f32 v167, v142, v143
    v_mfma_f32_32x32x16_bf16 v[112:127], a[232:235], v[160:163], v[112:127]
    v_exp_f32 v144, v144
    v_exp_f32 v145, v145
    v_exp_f32 v146, v146
    v_exp_f32 v147, v147
    v_cvt_pk_bf16_f32 v168, v144, v145
    v_cvt_pk_bf16_f32 v169, v146, v147
    v_mfma_f32_32x32x16_bf16 v[112:127], a[236:239], v[164:167], v[112:127]
    v_exp_f32 v148, v148
    v_exp_f32 v149, v149
    v_exp_f32 v150, v150
    v_exp_f32 v151, v151
    v_cvt_pk_bf16_f32 v170, v148, v149
    v_cvt_pk_bf16_f32 v171, v150, v151
    v_exp_f32 v152, v152
    v_exp_f32 v153, v153
    v_exp_f32 v154, v154
    v_exp_f32 v155, v155
    v_cvt_pk_bf16_f32 v172, v152, v153
    v_cvt_pk_bf16_f32 v173, v154, v155
    v_mfma_f32_32x32x16_bf16 v[112:127], a[248:251], v[168:171], v[112:127]
    v_exp_f32 v156, v156
    v_exp_f32 v157, v157
    v_exp_f32 v158, v158
    v_exp_f32 v159, v159
    v_cvt_pk_bf16_f32 v174, v156, v157
    v_cvt_pk_bf16_f32 v175, v158, v159
    s_nop 1
    v_mfma_f32_32x32x16_bf16 v[112:127], a[252:255], v[172:175], v[112:127]
L_pub:
    s_add_u32 s13, s79, 65536
    buffer_load_dwordx4 v[96:99], v2, s[36:39], s13 offen offset:0 sc1
    buffer_load_dwordx4 v[100:103], v2, s[36:39], s13 offen offset:1024 sc1
    buffer_load_dwordx4 v[104:107], v2, s[36:39], s13 offen offset:2048 sc1
    buffer_load_dwordx4 v[108:111], v2, s[36:39], s13 offen offset:3072 sc1
    s_nop 6
    ds_write_b128 v28, v[116:119] offset:2048
    ds_write_b128 v28, v[120:123] offset:3072
    ds_write_b128 v28, v[124:127] offset:4096
    s_waitcnt lgkmcnt(0)
    s_barrier
    ds_read_b128 v[120:123], v21 offset:2048
    ds_read_b128 v[116:119], v20 offset:2048
    ds_read_b128 v[124:127], v22 offset:2048
    s_waitcnt vmcnt(8)
    v_max3_u32 v58, v64, v65, v66
    v_max3_u32 v59, v67, v68, v69
    v_max3_u32 v58, v58, v70, v71
    v_max3_u32 v59, v59, v72, v73
    v_max3_u32 v58, v58, v74, v75
    v_max3_u32 v59, v59, v76, v77
    v_max3_u32 v58, v58, v78, v79
    v_max_u32 v58, v58, v59
    s_waitcnt lgkmcnt(0)
    v_pk_add_f32 v[114:115], v[114:115], v[122:123]
    v_pk_add_f32 v[118:119], v[118:119], v[126:127]
    v_pk_add_f32 v[112:113], v[112:113], v[120:121]
    v_pk_add_f32 v[114:115], v[114:115], v[118:119]
    v_rcp_f32 v120, v115
    v_pk_add_f32 v[116:117], v[116:117], v[124:125]
    v_subrev_u32 v118, 0x2b800000, v115
    v_mov_b32 v122, v120
    v_pk_add_f32 v[112:113], v[112:113], v[116:117]
    v_cndmask_b32 v115, 0, v115, s[20:21]
    v_permlane32_swap_b32 v122, v120
    v_cmp_le_u32 vcc, s80, v118
    v_pk_mul_f32 v[112:113], v[112:113], v[120:121] op_sel_hi:[1,0]
    v_pk_mul_f32 v[114:115], v[114:115], v[120:121] op_sel_hi:[1,0]
    v_cvt_pk_bf16_f32 v244, v112, v113
    v_cvt_pk_bf16_f32 v245, v114, v115
    s_and_b32 s11, vcc_hi, s77
    s_cselect_b32 s12, 1073741824, s12
    v_permlane32_swap_b32 v244, v246
    v_permlane32_swap_b32 v245, v247
    buffer_store_dwordx4 v[244:247], v19, s[36:39], s12 offen sc1
    s_cselect_b32 s11, 8, 0
    v_cmp_eq_u32 vcc, -1, v58
    s_or_b32 s75, s75, s11
    s_cbranch_scc1 L_slow
    s_bitcmp1_b32 s69, 2
    s_cbranch_scc1 L_fin
    s_cbranch_vccnz L_ort0
L_ook0:
    v_mfma_f32_16x16x32_bf16 v[132:135], a[4:7], v[64:67], 0
    s_waitcnt vmcnt(5)
    v_max3_u32 v58, v80, v81, v82
    v_max3_u32 v59, v83, v84, v85
    v_mfma_f32_16x16x32_bf16 v[132:135], a[20:23], v[68:71], v[132:135]
    v_max3_u32 v58, v58, v86, v87
    v_max3_u32 v59, v59, v88, v89
    v_mfma_f32_16x16x32_bf16 v[132:135], a[36:39], v[72:75], v[132:135]
    v_max3_u32 v58, v58, v90, v91
    v_max3_u32 v59, v59, v92, v93
    v_mfma_f32_16x16x32_bf16 v[132:135], a[52:55], v[76:79], v[132:135]
    s_nop 0
    v_max3_u32 v58, v58, v94, v95
    v_max_u32 v58, v58, v59
    v_mfma_f32_16x16x32_bf16 v[136:139], a[8:11], v[64:67], 0
    s_nop 1
    v_cmp_eq_u32 vcc, -1, v58
    v_mfma_f32_16x16x32_bf16 v[136:139], a[24:27], v[68:71], v[136:139]
    ds_write_b128 v28, v[132:135] offset:10240
    v_mfma_f32_16x16x32_bf16 v[136:139], a[40:43], v[72:75], v[136:139]
    v_mfma_f32_16x16x32_bf16 v[136:139], a[56:59], v[76:79], v[136:139]
    s_nop 2
    v_mfma_f32_16x16x32_bf16 v[140:143], a[12:15], v[64:67], 0
    s_nop 2
    v_mfma_f32_16x16x32_bf16 v[140:143], a[28:31], v[68:71], v[140:143]
    ds_write_b128 v28, v[136:139] offset:11264
    v_mfma_f32_16x16x32_bf16 v[140:143], a[44:47], v[72:75], v[140:143]
    v_mfma_f32_16x16x32_bf16 v[140:143], a[60:63], v[76:79], v[140:143]
    s_nop 2
    v_mfma_f32_16x16x32_bf16 v[128:131], a[0:3], v[64:67], 0
    s_nop 2
    v_mfma_f32_16x16x32_bf16 v[128:131], a[16:19], v[68:71], v[128:131]
    ds_write_b128 v28, v[140:143] offset:12288
    v_mfma_f32_16x16x32_bf16 v[128:131], a[32:35], v[72:75], v[128:131]
    v_mfma_f32_16x16x32_bf16 v[128:131], a[48:51], v[76:79], v[128:131]
    s_cbranch_vccnz L_ort1
L_ook1:
    v_mfma_f32_16x16x32_bf16 v[148:151], a[4:7], v[80:83], 0
    s_waitcnt vmcnt(1)
    v_max3_u32 v58, v96, v97, v98
    v_max3_u32 v59, v99, v100, v101
    v_mfma_f32_16x16x32_bf16 v[148:151], a[20:23], v[84:87], v[148:151]
    s_waitcnt lgkmcnt(0)
    s_barrier
    v_max3_u32 v58, v58, v102, v103
    v_max3_u32 v59, v59, v104, v105
    v_mfma_f32_16x16x32_bf16 v[148:151], a[36:39], v[88:91], v[148:151]
    ds_read_b128 v[136:139], v21 offset:10240
    ds_read_b128 v[132:135], v20 offset:10240
    v_max3_u32 v58, v58, v106, v107
    v_max3_u32 v59, v59, v108, v109
    v_mfma_f32_16x16x32_bf16 v[148:151], a[52:55], v[92:95], v[148:151]
    ds_read_b128 v[140:143], v22 offset:10240
    v_max3_u32 v58, v58, v110, v111
    v_max_u32 v58, v58, v59
    v_mfma_f32_16x16x32_bf16 v[152:155], a[8:11], v[80:83], 0
    s_nop 1
    v_cmp_eq_u32 vcc, -1, v58
    v_mfma_f32_16x16x32_bf16 v[152:155], a[24:27], v[84:87], v[152:155]
    ds_write_b128 v28, v[148:151] offset:14336
    v_mfma_f32_16x16x32_bf16 v[152:155], a[40:43], v[88:91], v[152:155]
    s_waitcnt lgkmcnt(1)
    v_add_f32 v128, v128, v136
    v_mfma_f32_16x16x32_bf16 v[152:155], a[56:59], v[92:95], v[152:155]
    s_nop 0
    v_add_f32 v129, v129, v137
    v_add_f32 v130, v130, v138
    v_mfma_f32_16x16x32_bf16 v[156:159], a[12:15], v[80:83], 0
    s_nop 0
    v_add_f32 v131, v131, v139
    v_add_f32 v132, v132, v140
    v_mfma_f32_16x16x32_bf16 v[156:159], a[28:31], v[84:87], v[156:159]
    ds_write_b128 v28, v[152:155] offset:15360
    v_mfma_f32_16x16x32_bf16 v[156:159], a[44:47], v[88:91], v[156:159]
    v_add_f32 v133, v133, v141
    v_add_f32 v134, v134, v142
    v_mfma_f32_16x16x32_bf16 v[156:159], a[60:63], v[92:95], v[156:159]
    s_nop 0
    v_add_f32 v135, v135, v143
    v_add_f32 v128, v128, v132
    v_mfma_f32_16x16x32_bf16 v[144:147], a[0:3], v[80:83], 0
    s_nop 0
    v_add_f32 v129, v129, v133
    v_add_f32 v130, v130, v134
    v_mfma_f32_16x16x32_bf16 v[144:147], a[16:19], v[84:87], v[144:147]
    ds_write_b128 v28, v[156:159] offset:16384
    v_mfma_f32_16x16x32_bf16 v[144:147], a[32:35], v[88:91], v[144:147]
    v_add_f32 v131, v131, v135
    v_fma_f32 v136, v128, v224, v208
    v_mfma_f32_16x16x32_bf16 v[144:147], a[48:51], v[92:95], v[144:147]
    v_fma_f32 v137, v129, v225, v209
    v_fma_f32 v138, v130, v226, v210
    v_fma_f32 v139, v131, v227, v211
    v_cvt_pk_bf16_f32 v133, v138, v139
    v_cvt_pk_bf16_f32 v132, v136, v137
    buffer_store_dwordx2 v[132:133], v23, s[48:51], s85 offen
    s_cbranch_vccnz L_ort2
L_ook2:
    v_mfma_f32_16x16x32_bf16 v[164:167], a[4:7], v[96:99], 0
    v_mfma_f32_16x16x32_bf16 v[164:167], a[20:23], v[100:103], v[164:167]
    s_waitcnt lgkmcnt(0)
    s_barrier
    v_mfma_f32_16x16x32_bf16 v[164:167], a[36:39], v[104:107], v[164:167]
    ds_read_b128 v[152:155], v21 offset:14336
    ds_read_b128 v[148:151], v20 offset:14336
    v_mfma_f32_16x16x32_bf16 v[164:167], a[52:55], v[108:111], v[164:167]
    s_nop 1
    ds_read_b128 v[156:159], v22 offset:14336
    v_mfma_f32_16x16x32_bf16 v[168:171], a[8:11], v[96:99], 0
    s_nop 2
    v_mfma_f32_16x16x32_bf16 v[168:171], a[24:27], v[100:103], v[168:171]
    ds_write_b128 v28, v[164:167] offset:18432
    v_mfma_f32_16x16x32_bf16 v[168:171], a[40:43], v[104:107], v[168:171]
    s_waitcnt lgkmcnt(1)
    v_add_f32 v144, v144, v152
    v_mfma_f32_16x16x32_bf16 v[168:171], a[56:59], v[108:111], v[168:171]
    s_nop 0
    v_add_f32 v145, v145, v153
    v_add_f32 v146, v146, v154
    v_mfma_f32_16x16x32_bf16 v[172:175], a[12:15], v[96:99], 0
    s_nop 0
    v_add_f32 v147, v147, v155
    v_add_f32 v148, v148, v156
    v_mfma_f32_16x16x32_bf16 v[172:175], a[28:31], v[100:103], v[172:175]
    ds_write_b128 v28, v[168:171] offset:19456
    v_mfma_f32_16x16x32_bf16 v[172:175], a[44:47], v[104:107], v[172:175]
    v_add_f32 v149, v149, v157
    v_add_f32 v150, v150, v158
    v_mfma_f32_16x16x32_bf16 v[172:175], a[60:63], v[108:111], v[172:175]
    s_nop 0
    v_add_f32 v151, v151, v159
    v_add_f32 v144, v144, v148
    v_mfma_f32_16x16x32_bf16 v[160:163], a[0:3], v[96:99], 0
    s_nop 0
    v_add_f32 v145, v145, v149
    v_add_f32 v146, v146, v150
    v_mfma_f32_16x16x32_bf16 v[160:163], a[16:19], v[100:103], v[160:163]
    ds_write_b128 v28, v[172:175] offset:20480
    v_mfma_f32_16x16x32_bf16 v[160:163], a[32:35], v[104:107], v[160:163]
    v_add_f32 v147, v147, v151
    v_fma_f32 v152, v144, v228, v212
    v_mfma_f32_16x16x32_bf16 v[160:163], a[48:51], v[108:111], v[160:163]
    v_fma_f32 v153, v145, v229, v213
    v_fma_f32 v154, v146, v230, v214
    v_fma_f32 v155, v147, v231, v215
    v_cvt_pk_bf16_f32 v149, v154, v155
    v_cvt_pk_bf16_f32 v148, v152, v153
    buffer_store_dwordx2 v[148:149], v23, s[48:51], s23 offen
    s_add_u32 s13, s79, 98304
    buffer_load_dwordx4 v[240:243], v2, s[36:39], s13 offen offset:0 sc1
    buffer_load_dwordx4 v[244:247], v2, s[36:39], s13 offen offset:1024 sc1
    buffer_load_dwordx4 v[248:251], v2, s[36:39], s13 offen offset:2048 sc1
    buffer_load_dwordx4 v[252:255], v2, s[36:39], s13 offen offset:3072 sc1
    s_waitcnt lgkmcnt(0)
    s_barrier
    ds_read_b128 v[168:171], v21 offset:18432
    ds_read_b128 v[164:167], v20 offset:18432
    ds_read_b128 v[172:175], v22 offset:18432
    v_mov_b32 v184, 0xbfb8aa3b
    v_and_b32 v176, s81, v232
    v_lshlrev_b32 v178, 16, v232
    v_rcp_f32 v176, v176
    v_lshlrev_b32 v216, 16, v218
    v_and_b32 v217, s81, v218
    v_mul_f32 v178, v178, v176
    v_lshlrev_b32 v218, 16, v219
    v_and_b32 v219, s81, v219
    v_pk_fma_f32 v[232:233], v[216:217], v[176:177], v[178:179] op_sel_hi:[1,0,0] neg_lo:[0,0,1] neg_hi:[0,0,1]
    v_pk_fma_f32 v[234:235], v[218:219], v[176:177], v[178:179] op_sel_hi:[1,0,0] neg_lo:[0,0,1] neg_hi:[0,0,1]
    v_pk_mul_f32 v[180:181], v[232:233], v[184:185] op_sel_hi:[1,0]
    v_pk_mul_f32 v[182:183], v[234:235], v[184:185] op_sel_hi:[1,0]
    v_exp_f32 v180, v180
    v_exp_f32 v181, v181
    v_exp_f32 v182, v182
    v_exp_f32 v183, v183
    v_pk_add_f32 v[180:181], v[180:181], 1.0 op_sel_hi:[1,0]
    v_pk_add_f32 v[182:183], v[182:183], 1.0 op_sel_hi:[1,0]
    v_rcp_f32 v180, v180
    v_rcp_f32 v181, v181
    v_rcp_f32 v182, v182
    v_rcp_f32 v183, v183
    v_pk_mul_f32 v[232:233], v[232:233], v[180:181]
    v_pk_mul_f32 v[234:235], v[234:235], v[182:183]
    v_and_b32 v176, s81, v236
    v_lshlrev_b32 v178, 16, v236
    v_rcp_f32 v176, v176
    v_lshlrev_b32 v220, 16, v222
    v_and_b32 v221, s81, v222
    v_mul_f32 v178, v178, v176
    v_lshlrev_b32 v222, 16, v223
    v_and_b32 v223, s81, v223
    v_pk_fma_f32 v[236:237], v[220:221], v[176:177], v[178:179] op_sel_hi:[1,0,0] neg_lo:[0,0,1] neg_hi:[0,0,1]
    v_pk_fma_f32 v[238:239], v[222:223], v[176:177], v[178:179] op_sel_hi:[1,0,0] neg_lo:[0,0,1] neg_hi:[0,0,1]
    v_pk_mul_f32 v[180:181], v[236:237], v[184:185] op_sel_hi:[1,0]
    v_pk_mul_f32 v[182:183], v[238:239], v[184:185] op_sel_hi:[1,0]
    s_waitcnt lgkmcnt(0)
    v_pk_add_f32 v[162:163], v[162:163], v[170:171]
    v_pk_add_f32 v[166:167], v[166:167], v[174:175]
    v_pk_add_f32 v[160:161], v[160:161], v[168:169]
    v_pk_add_f32 v[162:163], v[162:163], v[166:167]
    v_pk_add_f32 v[164:165], v[164:165], v[172:173]
    v_pk_add_f32 v[160:161], v[160:161], v[164:165]
    v_pk_fma_f32 v[170:171], v[162:163], v[234:235], v[218:219]
    v_pk_fma_f32 v[168:169], v[160:161], v[232:233], v[216:217]
    v_cvt_pk_bf16_f32 v165, v170, v171
    v_cvt_pk_bf16_f32 v164, v168, v169
    buffer_store_dwordx2 v[164:165], v23, s[48:51], s24 offen
    v_exp_f32 v180, v180
    v_exp_f32 v181, v181
    v_exp_f32 v182, v182
    v_exp_f32 v183, v183
    v_pk_add_f32 v[180:181], v[180:181], 1.0 op_sel_hi:[1,0]
    v_pk_add_f32 v[182:183], v[182:183], 1.0 op_sel_hi:[1,0]
    v_rcp_f32 v180, v180
    v_rcp_f32 v181, v181
    v_rcp_f32 v182, v182
    v_rcp_f32 v183, v183
    v_pk_mul_f32 v[236:237], v[236:237], v[180:181]
    v_pk_mul_f32 v[238:239], v[238:239], v[182:183]
    s_cmp_lg_u32 s69, 0
    s_cbranch_scc1 L_y2
L_y2_ret:
    s_waitcnt vmcnt(1)
    v_max3_u32 v58, v240, v241, v242
    v_max3_u32 v59, v243, v244, v245
    v_max3_u32 v58, v58, v246, v247
    v_max3_u32 v59, v59, v248, v249
    v_max3_u32 v58, v58, v250, v251
    v_max3_u32 v59, v59, v252, v253
    v_max3_u32 v58, v58, v254, v255
    v_max_u32 v58, v58, v59
    v_cmp_eq_u32 vcc, -1, v58
    s_cbranch_vccnz L_ort3
L_ook3:
    v_mfma_f32_16x16x32_bf16 v[116:119], a[4:7], v[240:243], 0
    v_mfma_f32_16x16x32_bf16 v[116:119], a[20:23], v[244:247], v[116:119]
    v_mfma_f32_16x16x32_bf16 v[116:119], a[36:39], v[248:251], v[116:119]
    v_mfma_f32_16x16x32_bf16 v[116:119], a[52:55], v[252:255], v[116:119]
    s_nop 2
    v_mfma_f32_16x16x32_bf16 v[120:123], a[8:11], v[240:243], 0
    s_nop 2
    v_mfma_f32_16x16x32_bf16 v[120:123], a[24:27], v[244:247], v[120:123]
    ds_write_b128 v28, v[116:119] offset:2048
    v_mfma_f32_16x16x32_bf16 v[120:123], a[40:43], v[248:251], v[120:123]
    v_mfma_f32_16x16x32_bf16 v[120:123], a[56:59], v[252:255], v[120:123]
    s_nop 2
    v_mfma_f32_16x16x32_bf16 v[124:127], a[12:15], v[240:243], 0
    s_nop 2
    v_mfma_f32_16x16x32_bf16 v[124:127], a[28:31], v[244:247], v[124:127]
    ds_write_b128 v28, v[120:123] offset:3072
    v_mfma_f32_16x16x32_bf16 v[124:127], a[44:47], v[248:251], v[124:127]
    v_mfma_f32_16x16x32_bf16 v[124:127], a[60:63], v[252:255], v[124:127]
    s_nop 2
    v_mfma_f32_16x16x32_bf16 v[112:115], a[0:3], v[240:243], 0
    s_nop 2
    v_mfma_f32_16x16x32_bf16 v[112:115], a[16:19], v[244:247], v[112:115]
    ds_write_b128 v28, v[124:127] offset:4096
    v_mfma_f32_16x16x32_bf16 v[112:115], a[32:35], v[248:251], v[112:115]
    v_mfma_f32_16x16x32_bf16 v[112:115], a[48:51], v[252:255], v[112:115]
    s_waitcnt lgkmcnt(0)
    s_barrier
    ds_read_b128 v[120:123], v21 offset:2048
    ds_read_b128 v[116:119], v20 offset:2048
    ds_read_b128 v[124:127], v22 offset:2048
    s_waitcnt lgkmcnt(0)
    s_nop 1
    v_pk_add_f32 v[114:115], v[114:115], v[122:123]
    v_pk_add_f32 v[118:119], v[118:119], v[126:127]
    v_pk_add_f32 v[112:113], v[112:113], v[120:121]
    v_pk_add_f32 v[114:115], v[114:115], v[118:119]
    v_pk_add_f32 v[116:117], v[116:117], v[124:125]
    v_pk_add_f32 v[112:113], v[112:113], v[116:117]
    v_pk_fma_f32 v[122:123], v[114:115], v[238:239], v[222:223]
    v_pk_fma_f32 v[120:121], v[112:113], v[236:237], v[220:221]
    v_cvt_pk_bf16_f32 v117, v122, v123
    v_cvt_pk_bf16_f32 v116, v120, v121
    buffer_store_dwordx2 v[116:117], v23, s[48:51], s25 offen
L_fin:
    s_endpgm
L_clrF:
    v_mov_b32 v244, 0
    v_mov_b32 v245, 0
    v_mov_b32 v246, 0
    v_mov_b32 v247, 0
    buffer_store_dwordx4 v[244:247], v2, s[36:39], s25 offen sc1
    buffer_store_dwordx4 v[244:247], v2, s[36:39], s25 offen offset:1024 sc1
    buffer_store_dwordx4 v[244:247], v2, s[36:39], s25 offen offset:2048 sc1
    s_mul_i32 s77, s4, 9216
    s_add_u32 s77, s77, 4194304
    buffer_store_dwordx4 v[244:247], v2, s[36:39], s77 offen sc1
    s_branch L_clrF_ret
L_sgA0:
    s_lshl_b32 s77, s4, 2
    v_mov_b32 v244, 1
    buffer_store_dword v244, v29, s[44:47], s77 offen sc1
    s_branch L_sgA_ret0
L_sgA1:
    s_lshl_b32 s77, s4, 2
    v_mov_b32 v244, 1
    buffer_store_dword v244, v29, s[44:47], s77 offen sc1
    s_branch L_sgA_ret1
L_sigA0:
    s_mov_b32 s70, 0
L_sigA_l0:
    buffer_load_dword v22, v31, s[44:47], 0 offen sc1
    s_add_u32 s70, s70, 1
    s_waitcnt vmcnt(0)
    s_cmp_gt_u32 s70, 200000
    s_cbranch_scc1 L_sigA_ok0
    v_cmp_eq_u32 vcc, 0, v22
    s_and_b32 s11, vcc_lo, 0xff
    s_cbranch_scc1 L_sigA_l0
    s_branch L_sigA_ok0
L_sigA1:
    s_mov_b32 s70, 0
L_sigA_l1:
    buffer_load_dword v22, v31, s[44:47], 0 offen sc1
    s_add_u32 s70, s70, 1
    s_waitcnt vmcnt(0)
    s_cmp_gt_u32 s70, 200000
    s_cbranch_scc1 L_sigA_ok1
    v_cmp_eq_u32 vcc, 0, v22
    s_and_b32 s11, vcc_lo, 0xff
    s_cbranch_scc1 L_sigA_l1
    s_branch L_sigA_ok1
L_trt:
    s_add_u32 s70, s70, 1
    s_cmp_gt_u32 s70, 200000
    s_cbranch_scc1 L_trt_out
L_tch7:
    s_cbranch_execz L_tch_ret
    buffer_load_dword v64, v78, s[36:39], s100 offen sc1
    buffer_load_dword v65, v78, s[36:39], s100 offen offset:128 sc1
    buffer_load_dword v66, v78, s[36:39], s100 offen offset:256 sc1
    buffer_load_dword v67, v78, s[36:39], s100 offen offset:384 sc1
    s_waitcnt vmcnt(0)
    v_min3_u32 v116, v64, v65, v66
    v_min_u32 v116, v116, v67
    v_cmp_eq_u32 vcc, 0, v116
    s_cbranch_vccnz L_trt
L_trt_out:
    s_mov_b32 s70, 0
    s_branch L_tok
L_fretry:
    s_add_u32 s70, s70, 1
    s_cmp_lt_u32 s70, 64
    s_cbranch_scc1 L_fagain
    s_cmp_gt_u32 s70, 200000
    s_cbranch_scc1 L_fok
    s_cmp_eq_u32 s70, 64
    s_cbranch_scc0 L_gpoll
    buffer_store_dword v115, v114, s[36:39], s99 offen offset:1024 sc1
L_gpoll:
    buffer_load_dwordx4 v[80:83], v2, s[36:39], s25 offen offset:1024 sc1
    s_waitcnt vmcnt(0)
    v_min3_u32 v116, v80, v81, v82
    v_min_u32 v116, v116, v83
    v_cmp_eq_u32 vcc, 0, v116
    s_cbranch_vccz L_fok
L_fagain:
    buffer_load_dwordx4 v[80:83], v2, s[36:39], s25 offen sc1
    s_waitcnt vmcnt(0)
    s_branch L_fchk
L_crt:
    v_cmp_eq_u32 vcc, 0, v243
    s_cbranch_vccz L_crt_ok
    s_add_u32 s70, s70, 1
    s_cmp_gt_u32 s70, 200000
    s_cbranch_scc1 L_crt_ok
    buffer_load_dword v243, v31, s[36:39], s97 offen sc1
    s_waitcnt vmcnt(0)
    s_branch L_crt
L_crt_ok:
    s_cmp_eq_u32 s86, 0
    s_cbranch_scc1 L_cok
    s_lshl_b32 s86, s7, 2
    buffer_store_dword v244, v29, s[44:47], s86 offen offset:128 sc1
    s_branch L_cok
L_srt:
    s_add_u32 s70, s70, 1
    s_cmp_gt_u32 s70, 200000
    s_cbranch_scc1 L_sok
    v_and_b32 v30, 60, v31
    buffer_load_dword v30, v30, s[44:47], 0 offen offset:128 sc1
    s_waitcnt vmcnt(0)
    v_cmp_eq_u32 vcc, 0, v30
    s_cbranch_vccnz L_srt
    s_branch L_sok
L_zrt:
    s_add_u32 s70, s70, 1
    buffer_load_dwordx4 v[176:179], v10, s[36:39], s95 offen sc1
    buffer_load_dwordx4 v[180:183], v10, s[36:39], s95 offen offset:128 sc1
    s_waitcnt vmcnt(0)
    v_max3_u32 v200, v176, v177, v178
    v_max3_u32 v200, v200, v179, v180
    v_max3_u32 v200, v200, v181, v182
    v_max_u32 v200, v200, v183
    v_cmp_eq_u32 vcc, -1, v200
    s_cmp_gt_u32 s70, 200000
    s_cbranch_scc1 L_zgo
    s_cbranch_vccnz L_zrt
L_zgo:
    v_permlane32_swap_b32 v176, v178
    v_permlane32_swap_b32 v177, v179
    v_permlane32_swap_b32 v180, v182
    v_permlane32_swap_b32 v181, v183
    v_add_f32 v176, v176, v178
    v_add_f32 v177, v177, v179
    v_add_f32 v180, v180, v182
    v_add_f32 v181, v181, v183
    v_permlane16_swap_b32 v176, v177
    v_add_f32 v176, v176, v177
    v_permlane16_swap_b32 v180, v181
    v_add_f32 v180, v180, v181
    s_nop 1
    s_branch L_zok
L_ort0:
    s_add_u32 s70, s70, 1
    s_cmp_gt_u32 s70, 200000
    s_cbranch_scc1 L_ook0
    s_add_u32 s13, s79, 0
    buffer_load_dwordx4 v[64:67], v2, s[36:39], s13 offen offset:0 sc1
    buffer_load_dwordx4 v[68:71], v2, s[36:39], s13 offen offset:1024 sc1
    buffer_load_dwordx4 v[72:75], v2, s[36:39], s13 offen offset:2048 sc1
    buffer_load_dwordx4 v[76:79], v2, s[36:39], s13 offen offset:3072 sc1
    s_waitcnt vmcnt(0)
    v_max3_u32 v58, v64, v65, v66
    v_max3_u32 v59, v67, v68, v69
    v_max3_u32 v58, v58, v70, v71
    v_max3_u32 v59, v59, v72, v73
    v_max3_u32 v58, v58, v74, v75
    v_max3_u32 v59, v59, v76, v77
    v_max3_u32 v58, v58, v78, v79
    v_max_u32 v58, v58, v59
    v_cmp_eq_u32 vcc, -1, v58
    s_cbranch_vccnz L_ort0
    s_branch L_ook0
L_ort1:
    s_add_u32 s70, s70, 1
    s_cmp_gt_u32 s70, 200000
    s_cbranch_scc1 L_ook1
    s_add_u32 s13, s79, 32768
    buffer_load_dwordx4 v[80:83], v2, s[36:39], s13 offen offset:0 sc1
    buffer_load_dwordx4 v[84:87], v2, s[36:39], s13 offen offset:1024 sc1
    buffer_load_dwordx4 v[88:91], v2, s[36:39], s13 offen offset:2048 sc1
    buffer_load_dwordx4 v[92:95], v2, s[36:39], s13 offen offset:3072 sc1
    s_waitcnt vmcnt(0)
    v_max3_u32 v58, v80, v81, v82
    v_max3_u32 v59, v83, v84, v85
    v_max3_u32 v58, v58, v86, v87
    v_max3_u32 v59, v59, v88, v89
    v_max3_u32 v58, v58, v90, v91
    v_max3_u32 v59, v59, v92, v93
    v_max3_u32 v58, v58, v94, v95
    v_max_u32 v58, v58, v59
    v_cmp_eq_u32 vcc, -1, v58
    s_cbranch_vccnz L_ort1
    s_branch L_ook1
L_ort2:
    s_add_u32 s70, s70, 1
    s_cmp_gt_u32 s70, 200000
    s_cbranch_scc1 L_ook2
    s_add_u32 s13, s79, 65536
    buffer_load_dwordx4 v[96:99], v2, s[36:39], s13 offen offset:0 sc1
    buffer_load_dwordx4 v[100:103], v2, s[36:39], s13 offen offset:1024 sc1
    buffer_load_dwordx4 v[104:107], v2, s[36:39], s13 offen offset:2048 sc1
    buffer_load_dwordx4 v[108:111], v2, s[36:39], s13 offen offset:3072 sc1
    s_waitcnt vmcnt(0)
    v_max3_u32 v58, v96, v97, v98
    v_max3_u32 v59, v99, v100, v101
    v_max3_u32 v58, v58, v102, v103
    v_max3_u32 v59, v59, v104, v105
    v_max3_u32 v58, v58, v106, v107
    v_max3_u32 v59, v59, v108, v109
    v_max3_u32 v58, v58, v110, v111
    v_max_u32 v58, v58, v59
    v_cmp_eq_u32 vcc, -1, v58
    s_cbranch_vccnz L_ort2
    s_branch L_ook2
L_ort3:
L_tch8:
    s_cbranch_execz L_tch_ret
    s_add_u32 s70, s70, 1
    s_cmp_gt_u32 s70, 200000
    s_cbranch_scc1 L_ook3
    s_add_u32 s13, s79, 98304
    buffer_load_dwordx4 v[240:243], v2, s[36:39], s13 offen offset:0 sc1
    buffer_load_dwordx4 v[244:247], v2, s[36:39], s13 offen offset:1024 sc1
    buffer_load_dwordx4 v[248:251], v2, s[36:39], s13 offen offset:2048 sc1
    buffer_load_dwordx4 v[252:255], v2, s[36:39], s13 offen offset:3072 sc1
    s_waitcnt vmcnt(0)
    v_max3_u32 v58, v240, v241, v242
    v_max3_u32 v59, v243, v244, v245
    v_max3_u32 v58, v58, v246, v247
    v_max3_u32 v59, v59, v248, v249
    v_max3_u32 v58, v58, v250, v251
    v_max3_u32 v59, v59, v252, v253
    v_max3_u32 v58, v58, v254, v255
    v_max_u32 v58, v58, v59
    v_cmp_eq_u32 vcc, -1, v58
    s_cbranch_vccnz L_ort3
    s_branch L_ook3
L_y1:
    s_bitcmp1_b32 s69, 0
    s_cselect_b32 s95, 0, 64
    s_cselect_b32 s73, s73, s74
    s_lshl_b32 s14, s40, 8
    s_add_u32 s95, s95, s14
    s_add_u32 s95, s95, 5767168
    s_mul_i32 s16, s73, 896
    s_add_u32 s16, s16, s93
    s_and_b32 s14, s69, 3
    s_cselect_b32 s95, s95, 1073741824
L_y1b:
    buffer_load_dwordx2 v[52:53], v50, s[28:31], s16 offen
    buffer_load_dwordx4 v[40:43], v48, s[36:39], s95 offen sc1
    buffer_load_dwordx4 v[44:47], v49, s[36:39], s95 offen sc1
    s_waitcnt vmcnt(0)
L_y2:
    s_bitcmp1_b32 s69, 0
    s_cselect_b32 s71, s71, s72
    s_cselect_b32 s9, s9, s15
    v_max3_u32 v32, v40, v41, v42
    v_max3_u32 v33, v43, v44, v45
    v_max3_u32 v32, v32, v46, v47
    v_max_u32 v32, v32, v33
    v_cmp_eq_u32 vcc, -1, v32
    s_and_b32 s11, s71, 0xfffff800
    s_cmp_lt_i32 s11, 0
    s_cselect_b32 s14, 0x80000000, -1
    s_xor_b32 s11, s11, s14
    v_mov_b32 v34, s11
    v_and_b32 v32, 15, v1
    s_and_b32 s14, s73, 15
    v_cvt_pk_bf16_f32 v34, v34, v34
    v_cmp_eq_u32 s[82:83], s14, v32
    s_cbranch_vccz L_y2a
    s_add_u32 s70, s70, 1
    s_cmp_gt_u32 s70, 200000
    s_cbranch_scc0 L_y1b
L_y2a:
    v_pk_add_f32 v[40:41], v[40:41], v[44:45]
    v_pk_add_f32 v[42:43], v[42:43], v[46:47]
    v_and_b32 v34, s81, v34
    s_and_b32 s11, s9, s81
    s_lshl_b32 s14, s9, 16
    v_add_f32_dpp v40, v40, v40 quad_perm:[1,0,3,2] row_mask:0xf bank_mask:0xf
    v_add_f32_dpp v41, v41, v41 quad_perm:[1,0,3,2] row_mask:0xf bank_mask:0xf
    v_add_f32_dpp v42, v42, v42 quad_perm:[1,0,3,2] row_mask:0xf bank_mask:0xf
    v_add_f32_dpp v43, v43, v43 quad_perm:[1,0,3,2] row_mask:0xf bank_mask:0xf
    v_add_f32_dpp v40, v40, v40 quad_perm:[2,3,0,1] row_mask:0xf bank_mask:0xf
    v_add_f32_dpp v41, v41, v41 quad_perm:[2,3,0,1] row_mask:0xf bank_mask:0xf
    v_add_f32_dpp v42, v42, v42 quad_perm:[2,3,0,1] row_mask:0xf bank_mask:0xf
    v_add_f32_dpp v43, v43, v43 quad_perm:[2,3,0,1] row_mask:0xf bank_mask:0xf
    v_add_f32_dpp v40, v40, v40 row_half_mirror row_mask:0xf bank_mask:0xf
    v_add_f32_dpp v41, v41, v41 row_half_mirror row_mask:0xf bank_mask:0xf
    v_add_f32_dpp v42, v42, v42 row_half_mirror row_mask:0xf bank_mask:0xf
    v_add_f32_dpp v43, v43, v43 row_half_mirror row_mask:0xf bank_mask:0xf
    v_add_f32_dpp v40, v40, v40 row_mirror row_mask:0xf bank_mask:0xf
    v_add_f32_dpp v41, v41, v41 row_mirror row_mask:0xf bank_mask:0xf
    v_add_f32_dpp v42, v42, v42 row_mirror row_mask:0xf bank_mask:0xf
    v_add_f32_dpp v43, v43, v43 row_mirror row_mask:0xf bank_mask:0xf
    v_mul_f32 v34, 0xbfb8aa3b, v34
    v_rcp_f32 v32, s11
    v_exp_f32 v34, v34
    v_lshlrev_b32 v44, 16, v52
    v_and_b32 v45, s81, v52
    v_add_f32 v34, 1.0, v34
    v_lshlrev_b32 v46, 16, v53
    v_rcp_f32 v34, v34
    v_and_b32 v47, s81, v53
    v_mul_f32 v36, s14, v32
    v_mov_b32 v52, 0xbfb8aa3b
    v_pk_fma_f32 v[44:45], v[44:45], v[32:33], v[36:37] op_sel_hi:[1,0,0] neg_lo:[0,0,1] neg_hi:[0,0,1]
    v_pk_fma_f32 v[46:47], v[46:47], v[32:33], v[36:37] op_sel_hi:[1,0,0] neg_lo:[0,0,1] neg_hi:[0,0,1]
    s_bfe_u32 s11, s73, 0x20005
    v_pk_fma_f32 v[40:41], v[40:41], v[34:35], v[44:45] op_sel_hi:[1,0,1]
    v_pk_fma_f32 v[42:43], v[42:43], v[34:35], v[46:47] op_sel_hi:[1,0,1]
    v_pk_mul_f32 v[44:45], v[40:41], v[52:53] op_sel_hi:[1,0]
    v_pk_mul_f32 v[46:47], v[42:43], v[52:53] op_sel_hi:[1,0]
    v_exp_f32 v44, v44
    v_exp_f32 v45, v45
    v_exp_f32 v46, v46
    v_exp_f32 v47, v47
    v_pk_add_f32 v[44:45], v[44:45], 1.0 op_sel_hi:[1,0]
    v_pk_add_f32 v[46:47], v[46:47], 1.0 op_sel_hi:[1,0]
    v_rcp_f32 v44, v44
    v_rcp_f32 v45, v45
    v_rcp_f32 v46, v46
    v_rcp_f32 v47, v47
    v_pk_mul_f32 v[40:41], v[40:41], v[44:45]
    v_pk_mul_f32 v[42:43], v[42:43], v[46:47]
    s_mov_b64 exec, s[82:83]
    s_cmp_eq_u32 s11, 0
    s_cbranch_scc0 L_y3_0
    v_pk_fma_f32 v[40:41], v[128:129], v[40:41], v[208:209]
    v_pk_fma_f32 v[42:43], v[130:131], v[42:43], v[210:211]
    v_cvt_pk_bf16_f32 v44, v40, v41
    v_cvt_pk_bf16_f32 v45, v42, v43
    buffer_store_dwordx2 v[44:45], v23, s[48:51], s85 offen
    s_branch L_y3_e
L_y3_0:
    s_cmp_eq_u32 s11, 1
    s_cbranch_scc0 L_y3_1
    v_pk_fma_f32 v[40:41], v[144:145], v[40:41], v[212:213]
    v_pk_fma_f32 v[42:43], v[146:147], v[42:43], v[214:215]
    v_cvt_pk_bf16_f32 v44, v40, v41
    v_cvt_pk_bf16_f32 v45, v42, v43
    buffer_store_dwordx2 v[44:45], v23, s[48:51], s23 offen
    s_branch L_y3_e
L_y3_1:
    s_cmp_eq_u32 s11, 2
    s_cbranch_scc0 L_y3_2
    v_pk_fma_f32 v[40:41], v[160:161], v[40:41], v[216:217]
    v_pk_fma_f32 v[42:43], v[162:163], v[42:43], v[218:219]
    v_cvt_pk_bf16_f32 v44, v40, v41
    v_cvt_pk_bf16_f32 v45, v42, v43
    buffer_store_dwordx2 v[44:45], v23, s[48:51], s24 offen
    s_branch L_y3_e
L_y3_2:
    v_mov_b64 v[236:237], v[40:41]
    v_mov_b64 v[238:239], v[42:43]
L_y3_e:
    s_mov_b64 exec, -1
    s_cmp_eq_u32 s69, 3
    s_cbranch_scc0 L_y2_ret
    s_mov_b32 s69, 2
    s_branch L_y1
L_slow:
    s_ff1_i32_b32 s76, s75
    s_bitset0_b32 s75, s76
    s_mov_b32 s77, 0
    s_mul_i32 s11, s76, 24576
    s_add_u32 s11, s11, 57344
    v_add_u32 v240, s11, v2
    ds_read_b128 v[56:59], v240
    ds_read_b128 v[60:63], v240 offset:1024
    s_mov_b32 s11, s88
    s_add_u32 s14, s88, 65536
    v_mov_b32 v241, 0xff800000
    s_waitcnt vmcnt(0) lgkmcnt(0)
L_slow1:
    buffer_load_dwordx4 v[144:147], v2, s[36:39], s11 offen sc1
    buffer_load_dwordx4 v[148:151], v2, s[36:39], s11 offen offset:1024 sc1
    s_waitcnt vmcnt(0)
    v_mfma_f32_32x32x16_bf16 v[128:143], v[144:147], v[56:59], 0
    v_mfma_f32_32x32x16_bf16 v[128:143], v[148:151], v[60:63], v[128:143]
    s_nop 11
    v_max3_f32 v241, v241, v128, v129
    v_max3_f32 v241, v241, v130, v131
    v_max3_f32 v241, v241, v132, v133
    v_max3_f32 v241, v241, v134, v135
    v_max3_f32 v241, v241, v136, v137
    v_max3_f32 v241, v241, v138, v139
    v_max3_f32 v241, v241, v140, v141
    v_max3_f32 v241, v241, v142, v143
    s_add_u32 s11, s11, 4096
    s_cmp_lt_u32 s11, s14
    s_cbranch_scc1 L_slow1
    v_mov_b32 v242, v241
    v_and_b32 v240, 0x1f0, v2
    v_add_u32 v240, 156160, v240
    v_lshl_add_u32 v243, s3, 2, v240
    s_nop 1
    v_permlane32_swap_b32 v241, v242
    v_max_f32 v241, v241, v242
    ds_write_b32 v243, v241 offset:3072
    s_waitcnt lgkmcnt(0)
    s_barrier
    ds_read_b128 v[244:247], v240 offset:3072
    s_mov_b32 s11, s88
    s_add_u32 s14, s88, 65536
    v_mov_b32 v112, 0
    v_mov_b32 v113, 0
    v_mov_b32 v114, 0
    v_mov_b32 v115, 0
    v_mov_b32 v116, 0
    v_mov_b32 v117, 0
    v_mov_b32 v118, 0
    v_mov_b32 v119, 0
    v_mov_b32 v120, 0
    v_mov_b32 v121, 0
    v_mov_b32 v122, 0
    v_mov_b32 v123, 0
    v_mov_b32 v124, 0
    v_mov_b32 v125, 0
    v_mov_b32 v126, 0
    v_mov_b32 v127, 0
    s_waitcnt lgkmcnt(0)
    v_max3_f32 v241, v244, v245, v246
    v_max_f32 v241, v241, v247
L_slow2:
    buffer_load_dwordx4 v[144:147], v2, s[36:39], s11 offen sc1
    buffer_load_dwordx4 v[148:151], v2, s[36:39], s11 offen offset:1024 sc1
    buffer_load_dwordx4 v[152:155], v3, s[36:39], s11 offen offset:2048 sc1
    buffer_load_dwordx4 v[156:159], v3, s[36:39], s11 offen offset:3072 sc1
    s_waitcnt vmcnt(0)
    v_mfma_f32_32x32x16_bf16 v[128:143], v[144:147], v[56:59], 0
    v_mfma_f32_32x32x16_bf16 v[128:143], v[148:151], v[60:63], v[128:143]
    s_nop 11
    v_sub_f32 v128, v128, v241
    v_sub_f32 v129, v129, v241
    v_sub_f32 v130, v130, v241
    v_sub_f32 v131, v131, v241
    v_sub_f32 v132, v132, v241
    v_sub_f32 v133, v133, v241
    v_sub_f32 v134, v134, v241
    v_sub_f32 v135, v135, v241
    v_sub_f32 v136, v136, v241
    v_sub_f32 v137, v137, v241
    v_sub_f32 v138, v138, v241
    v_sub_f32 v139, v139, v241
    v_sub_f32 v140, v140, v241
    v_sub_f32 v141, v141, v241
    v_sub_f32 v142, v142, v241
    v_sub_f32 v143, v143, v241
    v_exp_f32 v128, v128
    v_exp_f32 v129, v129
    v_exp_f32 v130, v130
    v_exp_f32 v131, v131
    v_exp_f32 v132, v132
    v_exp_f32 v133, v133
    v_exp_f32 v134, v134
    v_exp_f32 v135, v135
    v_exp_f32 v136, v136
    v_exp_f32 v137, v137
    v_exp_f32 v138, v138
    v_exp_f32 v139, v139
    v_exp_f32 v140, v140
    v_exp_f32 v141, v141
    v_exp_f32 v142, v142
    v_exp_f32 v143, v143
    v_cvt_pk_bf16_f32 v160, v128, v129
    v_cvt_pk_bf16_f32 v161, v130, v131
    v_cvt_pk_bf16_f32 v162, v132, v133
    v_cvt_pk_bf16_f32 v163, v134, v135
    v_cvt_pk_bf16_f32 v164, v136, v137
    v_cvt_pk_bf16_f32 v165, v138, v139
    v_cvt_pk_bf16_f32 v166, v140, v141
    v_cvt_pk_bf16_f32 v167, v142, v143
    v_mfma_f32_32x32x16_bf16 v[112:127], v[152:155], v[160:163], v[112:127]
    s_nop 0
    v_mfma_f32_32x32x16_bf16 v[112:127], v[156:159], v[164:167], v[112:127]
    s_add_u32 s11, s11, 4096
    s_cmp_lt_u32 s11, s14
    s_nop 15
    s_cbranch_scc1 L_slow2
    s_lshl_b32 s12, s76, 15
    s_add_u32 s12, s12, s78
    s_branch L_pub
L_end:
    s_endpgm
.p2align 7
.type L_tab,@object
L_tab:
.long 0x0,0x0,0x0,0x0
.long 0x10,0x10,0x10,0x80
.long 0x80,0x20,0x20,0x100
.long 0x90,0x30,0x30,0x180
.long 0x80000,0x40,0x40,0x0
.long 0x80040,0x50,0x50,0x80
.long 0x40000000,0x60,0x60,0x100
.long 0x40000000,0x70,0x70,0x180
.long 0x40000000,0xe00,0x380,0x0
.long 0x40000000,0xe10,0x390,0x80
.long 0x40000000,0xe20,0x3a0,0x100
.long 0x40000000,0xe30,0x3b0,0x180
.long 0x40000000,0xe40,0x3c0,0x0
.long 0x40000000,0xe50,0x3d0,0x80
.long 0x40000000,0xe60,0x3e0,0x100
.long 0x40000000,0xe70,0x3f0,0x180
.long 0x20,0x1c00,0x700,0x0
.long 0x30,0x1c10,0x710,0x80
.long 0xa0,0x1c20,0x720,0x100
.long 0xb0,0x1c30,0x730,0x180
.long 0x80010,0x1c40,0x740,0x0
.long 0x80050,0x1c50,0x750,0x80
.long 0x40000000,0x1c60,0x760,0x100
.long 0x40000000,0x1c70,0x770,0x180
.long 0x40000000,0x2a00,0xa80,0x0
.long 0x40000000,0x2a10,0xa90,0x80
.long 0x40000000,0x2a20,0xaa0,0x100
.long 0x40000000,0x2a30,0xab0,0x180
.long 0x40000000,0x2a40,0xac0,0x0
.long 0x40000000,0x2a50,0xad0,0x80
.long 0x40000000,0x2a60,0xae0,0x100
.long 0x40000000,0x2a70,0xaf0,0x180
.long 0x40,0x3800,0xe00,0x0
.long 0x50,0x3810,0xe10,0x80
.long 0xc0,0x3820,0xe20,0x100
.long 0xd0,0x3830,0xe30,0x180
.long 0x80020,0x3840,0xe40,0x0
.long 0x80060,0x3850,0xe50,0x80
.long 0x40000000,0x3860,0xe60,0x100
.long 0x40000000,0x3870,0xe70,0x180
.long 0x40000000,0x4600,0x1180,0x0
.long 0x40000000,0x4610,0x1190,0x80
.long 0x40000000,0x4620,0x11a0,0x100
.long 0x40000000,0x4630,0x11b0,0x180
.long 0x40000000,0x4640,0x11c0,0x0
.long 0x40000000,0x4650,0x11d0,0x80
.long 0x40000000,0x4660,0x11e0,0x100
.long 0x40000000,0x4670,0x11f0,0x180
.long 0x60,0x5400,0x1500,0x0
.long 0x70,0x5410,0x1510,0x80
.long 0xe0,0x5420,0x1520,0x100
.long 0xf0,0x5430,0x1530,0x180
.long 0x80030,0x5440,0x1540,0x0
.long 0x80070,0x5450,0x1550,0x80
.long 0x40000000,0x5460,0x1560,0x100
.long 0x40000000,0x5470,0x1570,0x180
.long 0x40000000,0x6200,0x1880,0x0
.long 0x40000000,0x6210,0x1890,0x80
.long 0x40000000,0x6220,0x18a0,0x100
.long 0x40000000,0x6230,0x18b0,0x180
.long 0x40000000,0x6240,0x18c0,0x0
.long 0x40000000,0x6250,0x18d0,0x80
.long 0x40000000,0x6260,0x18e0,0x100
.long 0x40000000,0x6270,0x18f0,0x180
.long 0xe000,0x0,0x0,0x27000
.long 0xe008,0x10,0x10,0x27080
.long 0xe010,0x40000000,0x20,0x27008
.long 0xe018,0x40000000,0x30,0x27088
.long 0xe080,0x40000000,0x40,0x27010
.long 0xe088,0x40000000,0x50,0x27090
.long 0xe090,0x40000000,0x60,0x27018
.long 0xe098,0x40000000,0x70,0x27098
.long 0xe100,0x40000000,0x100,0x27000
.long 0xe108,0x40000000,0x110,0x27080
.long 0xe110,0x40000000,0x120,0x27008
.long 0xe118,0x40000000,0x130,0x27088
.long 0xe180,0x40000000,0x140,0x27010
.long 0xe188,0x40000000,0x150,0x27090
.long 0xe190,0x40000000,0x160,0x27018
.long 0xe198,0x40000000,0x170,0x27098
.long 0xe400,0x20,0x200,0x27002
.long 0xe408,0x30,0x210,0x27082
.long 0xe410,0x40000000,0x220,0x2700a
.long 0xe418,0x40000000,0x230,0x2708a
.long 0xe480,0x40000000,0x240,0x27012
.long 0xe488,0x40000000,0x250,0x27092
.long 0xe490,0x40000000,0x260,0x2701a
.long 0xe498,0x40000000,0x270,0x2709a
.long 0xe500,0x40000000,0x300,0x27002
.long 0xe508,0x40000000,0x310,0x27082
.long 0xe510,0x40000000,0x320,0x2700a
.long 0xe518,0x40000000,0x330,0x2708a
.long 0xe580,0x40000000,0x340,0x27012
.long 0xe588,0x40000000,0x350,0x27092
.long 0xe590,0x40000000,0x360,0x2701a
.long 0xe598,0x40000000,0x370,0x2709a
.long 0x14000,0x40,0x400,0x27004
.long 0x14008,0x50,0x410,0x27084
.long 0x14010,0x40000000,0x420,0x2700c
.long 0x14018,0x40000000,0x430,0x2708c
.long 0x14080,0x40000000,0x440,0x27014
.long 0x14088,0x40000000,0x450,0x27094
.long 0x14090,0x40000000,0x460,0x2701c
.long 0x14098,0x40000000,0x470,0x2709c
.long 0x14100,0x40000000,0x500,0x27004
.long 0x14108,0x40000000,0x510,0x27084
.long 0x14110,0x40000000,0x520,0x2700c
.long 0x14118,0x40000000,0x530,0x2708c
.long 0x14180,0x40000000,0x540,0x27014
.long 0x14188,0x40000000,0x550,0x27094
.long 0x14190,0x40000000,0x560,0x2701c
.long 0x14198,0x40000000,0x570,0x2709c
.long 0x14400,0x60,0x600,0x27006
.long 0x14408,0x70,0x610,0x27086
.long 0x14410,0x40000000,0x620,0x2700e
.long 0x14418,0x40000000,0x630,0x2708e
.long 0x14480,0x40000000,0x640,0x27016
.long 0x14488,0x40000000,0x650,0x27096
.long 0x14490,0x40000000,0x660,0x2701e
.long 0x14498,0x40000000,0x670,0x2709e
.long 0x14500,0x40000000,0x700,0x27006
.long 0x14508,0x40000000,0x710,0x27086
.long 0x14510,0x40000000,0x720,0x2700e
.long 0x14518,0x40000000,0x730,0x2708e
.long 0x14580,0x40000000,0x740,0x27016
.long 0x14588,0x40000000,0x750,0x27096
.long 0x14590,0x40000000,0x760,0x2701e
.long 0x14598,0x40000000,0x770,0x2709e
.long 0x0,0x1800,0x3000,0x4800
.long 0x10,0x1810,0x3010,0x4810
.long 0x20,0x1820,0x3020,0x4820
.long 0x30,0x1830,0x3030,0x4830
.long 0x40,0x1840,0x3040,0x4840
.long 0x50,0x1850,0x3050,0x4850
.long 0x60,0x1860,0x3060,0x4860
.long 0x70,0x1870,0x3070,0x4870
.long 0x380,0x1b80,0x3380,0x4b80
.long 0x390,0x1b90,0x3390,0x4b90
.long 0x3a0,0x1ba0,0x33a0,0x4ba0
.long 0x3b0,0x1bb0,0x33b0,0x4bb0
.long 0x3c0,0x1bc0,0x33c0,0x4bc0
.long 0x3d0,0x1bd0,0x33d0,0x4bd0
.long 0x3e0,0x1be0,0x33e0,0x4be0
.long 0x3f0,0x1bf0,0x33f0,0x4bf0
.long 0x720,0x1f20,0x3720,0x4f20
.long 0x730,0x1f30,0x3730,0x4f30
.long 0x700,0x1f00,0x3700,0x4f00
.long 0x710,0x1f10,0x3710,0x4f10
.long 0x760,0x1f60,0x3760,0x4f60
.long 0x770,0x1f70,0x3770,0x4f70
.long 0x740,0x1f40,0x3740,0x4f40
.long 0x750,0x1f50,0x3750,0x4f50
.long 0xaa0,0x22a0,0x3aa0,0x52a0
.long 0xab0,0x22b0,0x3ab0,0x52b0
.long 0xa80,0x2280,0x3a80,0x5280
.long 0xa90,0x2290,0x3a90,0x5290
.long 0xae0,0x22e0,0x3ae0,0x52e0
.long 0xaf0,0x22f0,0x3af0,0x52f0
.long 0xac0,0x22c0,0x3ac0,0x52c0
.long 0xad0,0x22d0,0x3ad0,0x52d0
.long 0xe40,0x2640,0x3e40,0x5640
.long 0xe50,0x2650,0x3e50,0x5650
.long 0xe60,0x2660,0x3e60,0x5660
.long 0xe70,0x2670,0x3e70,0x5670
.long 0xe00,0x2600,0x3e00,0x5600
.long 0xe10,0x2610,0x3e10,0x5610
.long 0xe20,0x2620,0x3e20,0x5620
.long 0xe30,0x2630,0x3e30,0x5630
.long 0x11c0,0x29c0,0x41c0,0x59c0
.long 0x11d0,0x29d0,0x41d0,0x59d0
.long 0x11e0,0x29e0,0x41e0,0x59e0
.long 0x11f0,0x29f0,0x41f0,0x59f0
.long 0x1180,0x2980,0x4180,0x5980
.long 0x1190,0x2990,0x4190,0x5990
.long 0x11a0,0x29a0,0x41a0,0x59a0
.long 0x11b0,0x29b0,0x41b0,0x59b0
.long 0x1560,0x2d60,0x4560,0x5d60
.long 0x1570,0x2d70,0x4570,0x5d70
.long 0x1540,0x2d40,0x4540,0x5d40
.long 0x1550,0x2d50,0x4550,0x5d50
.long 0x1520,0x2d20,0x4520,0x5d20
.long 0x1530,0x2d30,0x4530,0x5d30
.long 0x1500,0x2d00,0x4500,0x5d00
.long 0x1510,0x2d10,0x4510,0x5d10
.long 0x18e0,0x30e0,0x48e0,0x60e0
.long 0x18f0,0x30f0,0x48f0,0x60f0
.long 0x18c0,0x30c0,0x48c0,0x60c0
.long 0x18d0,0x30d0,0x48d0,0x60d0
.long 0x18a0,0x30a0,0x48a0,0x60a0
.long 0x18b0,0x30b0,0x48b0,0x60b0
.long 0x1880,0x3080,0x4880,0x6080
.long 0x1890,0x3090,0x4890,0x6090
.long 0x27000,0x80000,0x0,0x0
.long 0x27080,0x80040,0x10,0x10
.long 0x27000,0x40000000,0x20,0x20
.long 0x27080,0x40000000,0x30,0x30
.long 0x27000,0x40000000,0x40,0x40
.long 0x27080,0x40000000,0x50,0x50
.long 0x27000,0x40000000,0x60,0x60
.long 0x27080,0x40000000,0x70,0x70
.long 0x27000,0x40000000,0x80,0x80
.long 0x27080,0x40000000,0x90,0x90
.long 0x27000,0x40000000,0xa0,0xa0
.long 0x27080,0x40000000,0xb0,0xb0
.long 0x27000,0x40000000,0xc0,0xc0
.long 0x27080,0x40000000,0xd0,0xd0
.long 0x27000,0x40000000,0xe0,0xe0
.long 0x27080,0x40000000,0xf0,0xf0
.long 0x27010,0x80010,0x4000,0x4000
.long 0x27090,0x80050,0x4010,0x4010
.long 0x27010,0x40000000,0x4020,0x4020
.long 0x27090,0x40000000,0x4030,0x4030
.long 0x27010,0x40000000,0x4040,0x4040
.long 0x27090,0x40000000,0x4050,0x4050
.long 0x27010,0x40000000,0x4060,0x4060
.long 0x27090,0x40000000,0x4070,0x4070
.long 0x27010,0x40000000,0x4080,0x4080
.long 0x27090,0x40000000,0x4090,0x4090
.long 0x27010,0x40000000,0x40a0,0x40a0
.long 0x27090,0x40000000,0x40b0,0x40b0
.long 0x27010,0x40000000,0x40c0,0x40c0
.long 0x27090,0x40000000,0x40d0,0x40d0
.long 0x27010,0x40000000,0x40e0,0x40e0
.long 0x27090,0x40000000,0x40f0,0x40f0
.long 0x27020,0x80020,0x8000,0x40000000
.long 0x270a0,0x80060,0x8010,0x40000000
.long 0x27020,0x40000000,0x8020,0x40000000
.long 0x270a0,0x40000000,0x8030,0x40000000
.long 0x27020,0x40000000,0x8040,0x40000000
.long 0x270a0,0x40000000,0x8050,0x40000000
.long 0x27020,0x40000000,0x8060,0x40000000
.long 0x270a0,0x40000000,0x8070,0x40000000
.long 0x27020,0x40000000,0x8080,0x40000000
.long 0x270a0,0x40000000,0x8090,0x40000000
.long 0x27020,0x40000000,0x80a0,0x40000000
.long 0x270a0,0x40000000,0x80b0,0x40000000
.long 0x27020,0x40000000,0x80c0,0x40000000
.long 0x270a0,0x40000000,0x80d0,0x40000000
.long 0x27020,0x40000000,0x80e0,0x40000000
.long 0x270a0,0x40000000,0x80f0,0x40000000
.long 0x27030,0x80030,0xc000,0x40000000
.long 0x270b0,0x80070,0xc010,0x40000000
.long 0x27030,0x40000000,0xc020,0x40000000
.long 0x270b0,0x40000000,0xc030,0x40000000
.long 0x27030,0x40000000,0xc040,0x40000000
.long 0x270b0,0x40000000,0xc050,0x40000000
.long 0x27030,0x40000000,0xc060,0x40000000
.long 0x270b0,0x40000000,0xc070,0x40000000
.long 0x27030,0x40000000,0xc080,0x40000000
.long 0x270b0,0x40000000,0xc090,0x40000000
.long 0x27030,0x40000000,0xc0a0,0x40000000
.long 0x270b0,0x40000000,0xc0b0,0x40000000
.long 0x27030,0x40000000,0xc0c0,0x40000000
.long 0x270b0,0x40000000,0xc0d0,0x40000000
.long 0x27030,0x40000000,0xc0e0,0x40000000
.long 0x270b0,0x40000000,0xc0f0,0x40000000
.long 0x20000,0x1a400,0x14800,0x0
.long 0x20010,0x1a410,0x14810,0x380
.long 0x20020,0x1a420,0x14820,0x700
.long 0x20030,0x1a430,0x14830,0xa80
.long 0x20040,0x1a440,0x14840,0xe00
.long 0x20050,0x1a450,0x14850,0x1180
.long 0x20060,0x1a460,0x14860,0x1500
.long 0x20070,0x1a470,0x14870,0x1880
.long 0x20080,0x1a480,0x14880,0x1c00
.long 0x20090,0x1a490,0x14890,0x1f80
.long 0x200a0,0x1a4a0,0x148a0,0x2300
.long 0x200b0,0x1a4b0,0x148b0,0x2680
.long 0x200c0,0x1a4c0,0x148c0,0x2a00
.long 0x200d0,0x1a4d0,0x148d0,0x2d80
.long 0x200e0,0x1a4e0,0x148e0,0x3100
.long 0x200f0,0x1a4f0,0x148f0,0x3480
.long 0x20100,0x1a500,0x14900,0x8
.long 0x20110,0x1a510,0x14910,0x388
.long 0x20120,0x1a520,0x14920,0x708
.long 0x20130,0x1a530,0x14930,0xa88
.long 0x20140,0x1a540,0x14940,0xe08
.long 0x20150,0x1a550,0x14950,0x1188
.long 0x20160,0x1a560,0x14960,0x1508
.long 0x20170,0x1a570,0x14970,0x1888
.long 0x20180,0x1a580,0x14980,0x1c08
.long 0x20190,0x1a590,0x14990,0x1f88
.long 0x201a0,0x1a5a0,0x149a0,0x2308
.long 0x201b0,0x1a5b0,0x149b0,0x2688
.long 0x201c0,0x1a5c0,0x149c0,0x2a08
.long 0x201d0,0x1a5d0,0x149d0,0x2d88
.long 0x201e0,0x1a5e0,0x149e0,0x3108
.long 0x201f0,0x1a5f0,0x149f0,0x3488
.long 0x20200,0x1a600,0x14a00,0x10
.long 0x20210,0x1a610,0x14a10,0x390
.long 0x20220,0x1a620,0x14a20,0x710
.long 0x20230,0x1a630,0x14a30,0xa90
.long 0x20240,0x1a640,0x14a40,0xe10
.long 0x20250,0x1a650,0x14a50,0x1190
.long 0x20260,0x1a660,0x14a60,0x1510
.long 0x20270,0x1a670,0x14a70,0x1890
.long 0x20280,0x1a680,0x14a80,0x1c10
.long 0x20290,0x1a690,0x14a90,0x1f90
.long 0x202a0,0x1a6a0,0x14aa0,0x2310
.long 0x202b0,0x1a6b0,0x14ab0,0x2690
.long 0x202c0,0x1a6c0,0x14ac0,0x2a10
.long 0x202d0,0x1a6d0,0x14ad0,0x2d90
.long 0x202e0,0x1a6e0,0x14ae0,0x3110
.long 0x202f0,0x1a6f0,0x14af0,0x3490
.long 0x20300,0x1a700,0x14b00,0x18
.long 0x20310,0x1a710,0x14b10,0x398
.long 0x20320,0x1a720,0x14b20,0x718
.long 0x20330,0x1a730,0x14b30,0xa98
.long 0x20340,0x1a740,0x14b40,0xe18
.long 0x20350,0x1a750,0x14b50,0x1198
.long 0x20360,0x1a760,0x14b60,0x1518
.long 0x20370,0x1a770,0x14b70,0x1898
.long 0x20380,0x1a780,0x14b80,0x1c18
.long 0x20390,0x1a790,0x14b90,0x1f98
.long 0x203a0,0x1a7a0,0x14ba0,0x2318
.long 0x203b0,0x1a7b0,0x14bb0,0x2698
.long 0x203c0,0x1a7c0,0x14bc0,0x2a18
.long 0x203d0,0x1a7d0,0x14bd0,0x2d98
.long 0x203e0,0x1a7e0,0x14be0,0x3118
.long 0x203f0,0x1a7f0,0x14bf0,0x3498
.long 0x0,0x20,0x40,0x60
.long 0x8,0x28,0x48,0x68
.long 0x10,0x30,0x50,0x70
.long 0x18,0x38,0x58,0x78
.long 0x80,0xa0,0xc0,0xe0
.long 0x88,0xa8,0xc8,0xe8
.long 0x90,0xb0,0xd0,0xf0
.long 0x98,0xb8,0xd8,0xf8
.long 0x120,0x100,0x160,0x140
.long 0x128,0x108,0x168,0x148
.long 0x130,0x110,0x170,0x150
.long 0x138,0x118,0x178,0x158
.long 0x1a0,0x180,0x1e0,0x1c0
.long 0x1a8,0x188,0x1e8,0x1c8
.long 0x1b0,0x190,0x1f0,0x1d0
.long 0x1b8,0x198,0x1f8,0x1d8
.long 0x3e0,0x3c0,0x3a0,0x380
.long 0x3e8,0x3c8,0x3a8,0x388
.long 0x3f0,0x3d0,0x3b0,0x390
.long 0x3f8,0x3d8,0x3b8,0x398
.long 0x400,0x420,0x440,0x460
.long 0x408,0x428,0x448,0x468
.long 0x410,0x430,0x450,0x470
.long 0x418,0x438,0x458,0x478
.long 0x480,0x4a0,0x4c0,0x4e0
.long 0x488,0x4a8,0x4c8,0x4e8
.long 0x490,0x4b0,0x4d0,0x4f0
.long 0x498,0x4b8,0x4d8,0x4f8
.long 0x520,0x500,0x560,0x540
.long 0x528,0x508,0x568,0x548
.long 0x530,0x510,0x570,0x550
.long 0x538,0x518,0x578,0x558
.long 0x760,0x740,0x720,0x700
.long 0x768,0x748,0x728,0x708
.long 0x770,0x750,0x730,0x710
.long 0x778,0x758,0x738,0x718
.long 0x7e0,0x7c0,0x7a0,0x780
.long 0x7e8,0x7c8,0x7a8,0x788
.long 0x7f0,0x7d0,0x7b0,0x790
.long 0x7f8,0x7d8,0x7b8,0x798
.long 0x800,0x820,0x840,0x860
.long 0x808,0x828,0x848,0x868
.long 0x810,0x830,0x850,0x870
.long 0x818,0x838,0x858,0x878
.long 0x880,0x8a0,0x8c0,0x8e0
.long 0x888,0x8a8,0x8c8,0x8e8
.long 0x890,0x8b0,0x8d0,0x8f0
.long 0x898,0x8b8,0x8d8,0x8f8
.long 0xac0,0xae0,0xa80,0xaa0
.long 0xac8,0xae8,0xa88,0xaa8
.long 0xad0,0xaf0,0xa90,0xab0
.long 0xad8,0xaf8,0xa98,0xab8
.long 0xb60,0xb40,0xb20,0xb00
.long 0xb68,0xb48,0xb28,0xb08
.long 0xb70,0xb50,0xb30,0xb10
.long 0xb78,0xb58,0xb38,0xb18
.long 0xbe0,0xbc0,0xba0,0xb80
.long 0xbe8,0xbc8,0xba8,0xb88
.long 0xbf0,0xbd0,0xbb0,0xb90
.long 0xbf8,0xbd8,0xbb8,0xb98
.long 0xc00,0xc20,0xc40,0xc60
.long 0xc08,0xc28,0xc48,0xc68
.long 0xc10,0xc30,0xc50,0xc70
.long 0xc18,0xc38,0xc58,0xc78
.long 0x0,0x20000,0x0,0x0
.long 0x2000,0x22000,0x0,0x0
.long 0x4000,0x24000,0x0,0x0
.long 0x6000,0x26000,0x0,0x0
.long 0x8000,0x28000,0x0,0x0
.long 0xa000,0x2a000,0x0,0x0
.long 0xc000,0x2c000,0x0,0x0
.long 0xe000,0x2e000,0x0,0x0
.long 0x10000,0x30000,0x0,0x0
.long 0x12000,0x32000,0x0,0x0
.long 0x14000,0x34000,0x0,0x0
.long 0x16000,0x36000,0x0,0x0
.long 0x18000,0x40000000,0x0,0x0
.long 0x1a000,0x40000000,0x0,0x0
.long 0x1c000,0x40000000,0x0,0x0
.long 0x1e000,0x40000000,0x0,0x0
.long 0x10,0x20010,0x8,0x0
.long 0x2010,0x22010,0x8,0x0
.long 0x4010,0x24010,0x8,0x0
.long 0x6010,0x26010,0x8,0x0
.long 0x8010,0x28010,0x8,0x0
.long 0xa010,0x2a010,0x8,0x0
.long 0xc010,0x2c010,0x8,0x0
.long 0xe010,0x2e010,0x8,0x0
.long 0x10010,0x30010,0x8,0x0
.long 0x12010,0x32010,0x8,0x0
.long 0x14010,0x34010,0x8,0x0
.long 0x16010,0x36010,0x8,0x0
.long 0x18010,0x40000000,0x8,0x0
.long 0x1a010,0x40000000,0x8,0x0
.long 0x1c010,0x40000000,0x8,0x0
.long 0x1e010,0x40000000,0x8,0x0
.long 0x20,0x20020,0x10,0x0
.long 0x2020,0x22020,0x10,0x0
.long 0x4020,0x24020,0x10,0x0
.long 0x6020,0x26020,0x10,0x0
.long 0x8020,0x28020,0x10,0x0
.long 0xa020,0x2a020,0x10,0x0
.long 0xc020,0x2c020,0x10,0x0
.long 0xe020,0x2e020,0x10,0x0
.long 0x10020,0x30020,0x10,0x0
.long 0x12020,0x32020,0x10,0x0
.long 0x14020,0x34020,0x10,0x0
.long 0x16020,0x36020,0x10,0x0
.long 0x18020,0x40000000,0x10,0x0
.long 0x1a020,0x40000000,0x10,0x0
.long 0x1c020,0x40000000,0x10,0x0
.long 0x1e020,0x40000000,0x10,0x0
.long 0x30,0x20030,0x18,0x0
.long 0x2030,0x22030,0x18,0x0
.long 0x4030,0x24030,0x18,0x0
.long 0x6030,0x26030,0x18,0x0
.long 0x8030,0x28030,0x18,0x0
.long 0xa030,0x2a030,0x18,0x0
.long 0xc030,0x2c030,0x18,0x0
.long 0xe030,0x2e030,0x18,0x0
.long 0x10030,0x30030,0x18,0x0
.long 0x12030,0x32030,0x18,0x0
.long 0x14030,0x34030,0x18,0x0
.long 0x16030,0x36030,0x18,0x0
.long 0x18030,0x40000000,0x18,0x0
.long 0x1a030,0x40000000,0x18,0x0
.long 0x1c030,0x40000000,0x18,0x0
.long 0x1e030,0x40000000,0x18,0x0
.long 0x0,0x0,0x0,0x200
.long 0x10,0x10,0x10,0x280
.long 0x80,0x20,0x20,0x300
.long 0x90,0x30,0x30,0x380
.long 0x80000,0x40,0x40,0x200
.long 0x80040,0x50,0x50,0x280
.long 0x40000000,0x60,0x60,0x300
.long 0x40000000,0x70,0x70,0x380
.long 0x40000000,0xe00,0x380,0x200
.long 0x40000000,0xe10,0x390,0x280
.long 0x40000000,0xe20,0x3a0,0x300
.long 0x40000000,0xe30,0x3b0,0x380
.long 0x40000000,0xe40,0x3c0,0x200
.long 0x40000000,0xe50,0x3d0,0x280
.long 0x40000000,0xe60,0x3e0,0x300
.long 0x40000000,0xe70,0x3f0,0x380
.long 0x20,0x1c00,0x700,0x200
.long 0x30,0x1c10,0x710,0x280
.long 0xa0,0x1c20,0x720,0x300
.long 0xb0,0x1c30,0x730,0x380
.long 0x80010,0x1c40,0x740,0x200
.long 0x80050,0x1c50,0x750,0x280
.long 0x40000000,0x1c60,0x760,0x300
.long 0x40000000,0x1c70,0x770,0x380
.long 0x40000000,0x2a00,0xa80,0x200
.long 0x40000000,0x2a10,0xa90,0x280
.long 0x40000000,0x2a20,0xaa0,0x300
.long 0x40000000,0x2a30,0xab0,0x380
.long 0x40000000,0x2a40,0xac0,0x200
.long 0x40000000,0x2a50,0xad0,0x280
.long 0x40000000,0x2a60,0xae0,0x300
.long 0x40000000,0x2a70,0xaf0,0x380
.long 0x40,0x3800,0xe00,0x200
.long 0x50,0x3810,0xe10,0x280
.long 0xc0,0x3820,0xe20,0x300
.long 0xd0,0x3830,0xe30,0x380
.long 0x80020,0x3840,0xe40,0x200
.long 0x80060,0x3850,0xe50,0x280
.long 0x40000000,0x3860,0xe60,0x300
.long 0x40000000,0x3870,0xe70,0x380
.long 0x40000000,0x4600,0x1180,0x200
.long 0x40000000,0x4610,0x1190,0x280
.long 0x40000000,0x4620,0x11a0,0x300
.long 0x40000000,0x4630,0x11b0,0x380
.long 0x40000000,0x4640,0x11c0,0x200
.long 0x40000000,0x4650,0x11d0,0x280
.long 0x40000000,0x4660,0x11e0,0x300
.long 0x40000000,0x4670,0x11f0,0x380
.long 0x60,0x5400,0x1500,0x200
.long 0x70,0x5410,0x1510,0x280
.long 0xe0,0x5420,0x1520,0x300
.long 0xf0,0x5430,0x1530,0x380
.long 0x80030,0x5440,0x1540,0x200
.long 0x80070,0x5450,0x1550,0x280
.long 0x40000000,0x5460,0x1560,0x300
.long 0x40000000,0x5470,0x1570,0x380
.long 0x40000000,0x6200,0x1880,0x200
.long 0x40000000,0x6210,0x1890,0x280
.long 0x40000000,0x6220,0x18a0,0x300
.long 0x40000000,0x6230,0x18b0,0x380
.long 0x40000000,0x6240,0x18c0,0x200
.long 0x40000000,0x6250,0x18d0,0x280
.long 0x40000000,0x6260,0x18e0,0x300
.long 0x40000000,0x6270,0x18f0,0x380
.long 0xe020,0x0,0x0,0x27020
.long 0xe028,0x10,0x10,0x270a0
.long 0xe030,0x40000000,0x20,0x27028
.long 0xe038,0x40000000,0x30,0x270a8
.long 0xe0a0,0x40000000,0x40,0x27030
.long 0xe0a8,0x40000000,0x50,0x270b0
.long 0xe0b0,0x40000000,0x60,0x27038
.long 0xe0b8,0x40000000,0x70,0x270b8
.long 0xe120,0x40000000,0x100,0x27020
.long 0xe128,0x40000000,0x110,0x270a0
.long 0xe130,0x40000000,0x120,0x27028
.long 0xe138,0x40000000,0x130,0x270a8
.long 0xe1a0,0x40000000,0x140,0x27030
.long 0xe1a8,0x40000000,0x150,0x270b0
.long 0xe1b0,0x40000000,0x160,0x27038
.long 0xe1b8,0x40000000,0x170,0x270b8
.long 0xe420,0x20,0x200,0x27022
.long 0xe428,0x30,0x210,0x270a2
.long 0xe430,0x40000000,0x220,0x2702a
.long 0xe438,0x40000000,0x230,0x270aa
.long 0xe4a0,0x40000000,0x240,0x27032
.long 0xe4a8,0x40000000,0x250,0x270b2
.long 0xe4b0,0x40000000,0x260,0x2703a
.long 0xe4b8,0x40000000,0x270,0x270ba
.long 0xe520,0x40000000,0x300,0x27022
.long 0xe528,0x40000000,0x310,0x270a2
.long 0xe530,0x40000000,0x320,0x2702a
.long 0xe538,0x40000000,0x330,0x270aa
.long 0xe5a0,0x40000000,0x340,0x27032
.long 0xe5a8,0x40000000,0x350,0x270b2
.long 0xe5b0,0x40000000,0x360,0x2703a
.long 0xe5b8,0x40000000,0x370,0x270ba
.long 0x14020,0x40,0x400,0x27024
.long 0x14028,0x50,0x410,0x270a4
.long 0x14030,0x40000000,0x420,0x2702c
.long 0x14038,0x40000000,0x430,0x270ac
.long 0x140a0,0x40000000,0x440,0x27034
.long 0x140a8,0x40000000,0x450,0x270b4
.long 0x140b0,0x40000000,0x460,0x2703c
.long 0x140b8,0x40000000,0x470,0x270bc
.long 0x14120,0x40000000,0x500,0x27024
.long 0x14128,0x40000000,0x510,0x270a4
.long 0x14130,0x40000000,0x520,0x2702c
.long 0x14138,0x40000000,0x530,0x270ac
.long 0x141a0,0x40000000,0x540,0x27034
.long 0x141a8,0x40000000,0x550,0x270b4
.long 0x141b0,0x40000000,0x560,0x2703c
.long 0x141b8,0x40000000,0x570,0x270bc
.long 0x14420,0x60,0x600,0x27026
.long 0x14428,0x70,0x610,0x270a6
.long 0x14430,0x40000000,0x620,0x2702e
.long 0x14438,0x40000000,0x630,0x270ae
.long 0x144a0,0x40000000,0x640,0x27036
.long 0x144a8,0x40000000,0x650,0x270b6
.long 0x144b0,0x40000000,0x660,0x2703e
.long 0x144b8,0x40000000,0x670,0x270be
.long 0x14520,0x40000000,0x700,0x27026
.long 0x14528,0x40000000,0x710,0x270a6
.long 0x14530,0x40000000,0x720,0x2702e
.long 0x14538,0x40000000,0x730,0x270ae
.long 0x145a0,0x40000000,0x740,0x27036
.long 0x145a8,0x40000000,0x750,0x270b6
.long 0x145b0,0x40000000,0x760,0x2703e
.long 0x145b8,0x40000000,0x770,0x270be
.long 0x18800,0x1a000,0x1b800,0x1d000
.long 0x18810,0x1a010,0x1b810,0x1d010
.long 0x18820,0x1a020,0x1b820,0x1d020
.long 0x18830,0x1a030,0x1b830,0x1d030
.long 0x18840,0x1a040,0x1b840,0x1d040
.long 0x18850,0x1a050,0x1b850,0x1d050
.long 0x18860,0x1a060,0x1b860,0x1d060
.long 0x18870,0x1a070,0x1b870,0x1d070
.long 0x18b80,0x1a380,0x1bb80,0x1d380
.long 0x18b90,0x1a390,0x1bb90,0x1d390
.long 0x18ba0,0x1a3a0,0x1bba0,0x1d3a0
.long 0x18bb0,0x1a3b0,0x1bbb0,0x1d3b0
.long 0x18bc0,0x1a3c0,0x1bbc0,0x1d3c0
.long 0x18bd0,0x1a3d0,0x1bbd0,0x1d3d0
.long 0x18be0,0x1a3e0,0x1bbe0,0x1d3e0
.long 0x18bf0,0x1a3f0,0x1bbf0,0x1d3f0
.long 0x18f20,0x1a720,0x1bf20,0x1d720
.long 0x18f30,0x1a730,0x1bf30,0x1d730
.long 0x18f00,0x1a700,0x1bf00,0x1d700
.long 0x18f10,0x1a710,0x1bf10,0x1d710
.long 0x18f60,0x1a760,0x1bf60,0x1d760
.long 0x18f70,0x1a770,0x1bf70,0x1d770
.long 0x18f40,0x1a740,0x1bf40,0x1d740
.long 0x18f50,0x1a750,0x1bf50,0x1d750
.long 0x192a0,0x1aaa0,0x1c2a0,0x1daa0
.long 0x192b0,0x1aab0,0x1c2b0,0x1dab0
.long 0x19280,0x1aa80,0x1c280,0x1da80
.long 0x19290,0x1aa90,0x1c290,0x1da90
.long 0x192e0,0x1aae0,0x1c2e0,0x1dae0
.long 0x192f0,0x1aaf0,0x1c2f0,0x1daf0
.long 0x192c0,0x1aac0,0x1c2c0,0x1dac0
.long 0x192d0,0x1aad0,0x1c2d0,0x1dad0
.long 0x19640,0x1ae40,0x1c640,0x1de40
.long 0x19650,0x1ae50,0x1c650,0x1de50
.long 0x19660,0x1ae60,0x1c660,0x1de60
.long 0x19670,0x1ae70,0x1c670,0x1de70
.long 0x19600,0x1ae00,0x1c600,0x1de00
.long 0x19610,0x1ae10,0x1c610,0x1de10
.long 0x19620,0x1ae20,0x1c620,0x1de20
.long 0x19630,0x1ae30,0x1c630,0x1de30
.long 0x199c0,0x1b1c0,0x1c9c0,0x1e1c0
.long 0x199d0,0x1b1d0,0x1c9d0,0x1e1d0
.long 0x199e0,0x1b1e0,0x1c9e0,0x1e1e0
.long 0x199f0,0x1b1f0,0x1c9f0,0x1e1f0
.long 0x19980,0x1b180,0x1c980,0x1e180
.long 0x19990,0x1b190,0x1c990,0x1e190
.long 0x199a0,0x1b1a0,0x1c9a0,0x1e1a0
.long 0x199b0,0x1b1b0,0x1c9b0,0x1e1b0
.long 0x19d60,0x1b560,0x1cd60,0x1e560
.long 0x19d70,0x1b570,0x1cd70,0x1e570
.long 0x19d40,0x1b540,0x1cd40,0x1e540
.long 0x19d50,0x1b550,0x1cd50,0x1e550
.long 0x19d20,0x1b520,0x1cd20,0x1e520
.long 0x19d30,0x1b530,0x1cd30,0x1e530
.long 0x19d00,0x1b500,0x1cd00,0x1e500
.long 0x19d10,0x1b510,0x1cd10,0x1e510
.long 0x1a0e0,0x1b8e0,0x1d0e0,0x1e8e0
.long 0x1a0f0,0x1b8f0,0x1d0f0,0x1e8f0
.long 0x1a0c0,0x1b8c0,0x1d0c0,0x1e8c0
.long 0x1a0d0,0x1b8d0,0x1d0d0,0x1e8d0
.long 0x1a0a0,0x1b8a0,0x1d0a0,0x1e8a0
.long 0x1a0b0,0x1b8b0,0x1d0b0,0x1e8b0
.long 0x1a080,0x1b880,0x1d080,0x1e880
.long 0x1a090,0x1b890,0x1d090,0x1e890
.long 0x27000,0x80000,0x100,0x100
.long 0x27080,0x80040,0x110,0x110
.long 0x27000,0x40000000,0x120,0x120
.long 0x27080,0x40000000,0x130,0x130
.long 0x27000,0x40000000,0x140,0x140
.long 0x27080,0x40000000,0x150,0x150
.long 0x27000,0x40000000,0x160,0x160
.long 0x27080,0x40000000,0x170,0x170
.long 0x27000,0x40000000,0x180,0x180
.long 0x27080,0x40000000,0x190,0x190
.long 0x27000,0x40000000,0x1a0,0x1a0
.long 0x27080,0x40000000,0x1b0,0x1b0
.long 0x27000,0x40000000,0x1c0,0x1c0
.long 0x27080,0x40000000,0x1d0,0x1d0
.long 0x27000,0x40000000,0x1e0,0x1e0
.long 0x27080,0x40000000,0x1f0,0x1f0
.long 0x27010,0x80010,0x4100,0x4100
.long 0x27090,0x80050,0x4110,0x4110
.long 0x27010,0x40000000,0x4120,0x4120
.long 0x27090,0x40000000,0x4130,0x4130
.long 0x27010,0x40000000,0x4140,0x4140
.long 0x27090,0x40000000,0x4150,0x4150
.long 0x27010,0x40000000,0x4160,0x4160
.long 0x27090,0x40000000,0x4170,0x4170
.long 0x27010,0x40000000,0x4180,0x4180
.long 0x27090,0x40000000,0x4190,0x4190
.long 0x27010,0x40000000,0x41a0,0x41a0
.long 0x27090,0x40000000,0x41b0,0x41b0
.long 0x27010,0x40000000,0x41c0,0x41c0
.long 0x27090,0x40000000,0x41d0,0x41d0
.long 0x27010,0x40000000,0x41e0,0x41e0
.long 0x27090,0x40000000,0x41f0,0x41f0
.long 0x27020,0x80020,0x8100,0x40000000
.long 0x270a0,0x80060,0x8110,0x40000000
.long 0x27020,0x40000000,0x8120,0x40000000
.long 0x270a0,0x40000000,0x8130,0x40000000
.long 0x27020,0x40000000,0x8140,0x40000000
.long 0x270a0,0x40000000,0x8150,0x40000000
.long 0x27020,0x40000000,0x8160,0x40000000
.long 0x270a0,0x40000000,0x8170,0x40000000
.long 0x27020,0x40000000,0x8180,0x40000000
.long 0x270a0,0x40000000,0x8190,0x40000000
.long 0x27020,0x40000000,0x81a0,0x40000000
.long 0x270a0,0x40000000,0x81b0,0x40000000
.long 0x27020,0x40000000,0x81c0,0x40000000
.long 0x270a0,0x40000000,0x81d0,0x40000000
.long 0x27020,0x40000000,0x81e0,0x40000000
.long 0x270a0,0x40000000,0x81f0,0x40000000
.long 0x27030,0x80030,0xc100,0x40000000
.long 0x270b0,0x80070,0xc110,0x40000000
.long 0x27030,0x40000000,0xc120,0x40000000
.long 0x270b0,0x40000000,0xc130,0x40000000
.long 0x27030,0x40000000,0xc140,0x40000000
.long 0x270b0,0x40000000,0xc150,0x40000000
.long 0x27030,0x40000000,0xc160,0x40000000
.long 0x270b0,0x40000000,0xc170,0x40000000
.long 0x27030,0x40000000,0xc180,0x40000000
.long 0x270b0,0x40000000,0xc190,0x40000000
.long 0x27030,0x40000000,0xc1a0,0x40000000
.long 0x270b0,0x40000000,0xc1b0,0x40000000
.long 0x27030,0x40000000,0xc1c0,0x40000000
.long 0x270b0,0x40000000,0xc1d0,0x40000000
.long 0x27030,0x40000000,0xc1e0,0x40000000
.long 0x270b0,0x40000000,0xc1f0,0x40000000
.long 0xe000,0x20400,0x1a800,0x20
.long 0xe010,0x20410,0x1a810,0x3a0
.long 0xe020,0x20420,0x1a820,0x720
.long 0xe030,0x20430,0x1a830,0xaa0
.long 0xe040,0x20440,0x1a840,0xe20
.long 0xe050,0x20450,0x1a850,0x11a0
.long 0xe060,0x20460,0x1a860,0x1520
.long 0xe070,0x20470,0x1a870,0x18a0
.long 0xe080,0x20480,0x1a880,0x1c20
.long 0xe090,0x20490,0x1a890,0x1fa0
.long 0xe0a0,0x204a0,0x1a8a0,0x2320
.long 0xe0b0,0x204b0,0x1a8b0,0x26a0
.long 0xe0c0,0x204c0,0x1a8c0,0x2a20
.long 0xe0d0,0x204d0,0x1a8d0,0x2da0
.long 0xe0e0,0x204e0,0x1a8e0,0x3120
.long 0xe0f0,0x204f0,0x1a8f0,0x34a0
.long 0xe100,0x20500,0x1a900,0x28
.long 0xe110,0x20510,0x1a910,0x3a8
.long 0xe120,0x20520,0x1a920,0x728
.long 0xe130,0x20530,0x1a930,0xaa8
.long 0xe140,0x20540,0x1a940,0xe28
.long 0xe150,0x20550,0x1a950,0x11a8
.long 0xe160,0x20560,0x1a960,0x1528
.long 0xe170,0x20570,0x1a970,0x18a8
.long 0xe180,0x20580,0x1a980,0x1c28
.long 0xe190,0x20590,0x1a990,0x1fa8
.long 0xe1a0,0x205a0,0x1a9a0,0x2328
.long 0xe1b0,0x205b0,0x1a9b0,0x26a8
.long 0xe1c0,0x205c0,0x1a9c0,0x2a28
.long 0xe1d0,0x205d0,0x1a9d0,0x2da8
.long 0xe1e0,0x205e0,0x1a9e0,0x3128
.long 0xe1f0,0x205f0,0x1a9f0,0x34a8
.long 0xe200,0x20600,0x1aa00,0x30
.long 0xe210,0x20610,0x1aa10,0x3b0
.long 0xe220,0x20620,0x1aa20,0x730
.long 0xe230,0x20630,0x1aa30,0xab0
.long 0xe240,0x20640,0x1aa40,0xe30
.long 0xe250,0x20650,0x1aa50,0x11b0
.long 0xe260,0x20660,0x1aa60,0x1530
.long 0xe270,0x20670,0x1aa70,0x18b0
.long 0xe280,0x20680,0x1aa80,0x1c30
.long 0xe290,0x20690,0x1aa90,0x1fb0
.long 0xe2a0,0x206a0,0x1aaa0,0x2330
.long 0xe2b0,0x206b0,0x1aab0,0x26b0
.long 0xe2c0,0x206c0,0x1aac0,0x2a30
.long 0xe2d0,0x206d0,0x1aad0,0x2db0
.long 0xe2e0,0x206e0,0x1aae0,0x3130
.long 0xe2f0,0x206f0,0x1aaf0,0x34b0
.long 0xe300,0x20700,0x1ab00,0x38
.long 0xe310,0x20710,0x1ab10,0x3b8
.long 0xe320,0x20720,0x1ab20,0x738
.long 0xe330,0x20730,0x1ab30,0xab8
.long 0xe340,0x20740,0x1ab40,0xe38
.long 0xe350,0x20750,0x1ab50,0x11b8
.long 0xe360,0x20760,0x1ab60,0x1538
.long 0xe370,0x20770,0x1ab70,0x18b8
.long 0xe380,0x20780,0x1ab80,0x1c38
.long 0xe390,0x20790,0x1ab90,0x1fb8
.long 0xe3a0,0x207a0,0x1aba0,0x2338
.long 0xe3b0,0x207b0,0x1abb0,0x26b8
.long 0xe3c0,0x207c0,0x1abc0,0x2a38
.long 0xe3d0,0x207d0,0x1abd0,0x2db8
.long 0xe3e0,0x207e0,0x1abe0,0x3138
.long 0xe3f0,0x207f0,0x1abf0,0x34b8
.long 0x3820,0x3840,0x3860,0x3800
.long 0x3828,0x3848,0x3868,0x3808
.long 0x3830,0x3850,0x3870,0x3810
.long 0x3838,0x3858,0x3878,0x3818
.long 0x38a0,0x38c0,0x38e0,0x3880
.long 0x38a8,0x38c8,0x38e8,0x3888
.long 0x38b0,0x38d0,0x38f0,0x3890
.long 0x38b8,0x38d8,0x38f8,0x3898
.long 0x3900,0x3960,0x3940,0x3920
.long 0x3908,0x3968,0x3948,0x3928
.long 0x3910,0x3970,0x3950,0x3930
.long 0x3918,0x3978,0x3958,0x3938
.long 0x3980,0x39e0,0x39c0,0x39a0
.long 0x3988,0x39e8,0x39c8,0x39a8
.long 0x3990,0x39f0,0x39d0,0x39b0
.long 0x3998,0x39f8,0x39d8,0x39b8
.long 0x3bc0,0x3ba0,0x3b80,0x3be0
.long 0x3bc8,0x3ba8,0x3b88,0x3be8
.long 0x3bd0,0x3bb0,0x3b90,0x3bf0
.long 0x3bd8,0x3bb8,0x3b98,0x3bf8
.long 0x3c20,0x3c40,0x3c60,0x3c00
.long 0x3c28,0x3c48,0x3c68,0x3c08
.long 0x3c30,0x3c50,0x3c70,0x3c10
.long 0x3c38,0x3c58,0x3c78,0x3c18
.long 0x3ca0,0x3cc0,0x3ce0,0x3c80
.long 0x3ca8,0x3cc8,0x3ce8,0x3c88
.long 0x3cb0,0x3cd0,0x3cf0,0x3c90
.long 0x3cb8,0x3cd8,0x3cf8,0x3c98
.long 0x3d00,0x3d60,0x3d40,0x3d20
.long 0x3d08,0x3d68,0x3d48,0x3d28
.long 0x3d10,0x3d70,0x3d50,0x3d30
.long 0x3d18,0x3d78,0x3d58,0x3d38
.long 0x3f40,0x3f20,0x3f00,0x3f60
.long 0x3f48,0x3f28,0x3f08,0x3f68
.long 0x3f50,0x3f30,0x3f10,0x3f70
.long 0x3f58,0x3f38,0x3f18,0x3f78
.long 0x3fc0,0x3fa0,0x3f80,0x3fe0
.long 0x3fc8,0x3fa8,0x3f88,0x3fe8
.long 0x3fd0,0x3fb0,0x3f90,0x3ff0
.long 0x3fd8,0x3fb8,0x3f98,0x3ff8
.long 0x4020,0x4040,0x4060,0x4000
.long 0x4028,0x4048,0x4068,0x4008
.long 0x4030,0x4050,0x4070,0x4010
.long 0x4038,0x4058,0x4078,0x4018
.long 0x40a0,0x40c0,0x40e0,0x4080
.long 0x40a8,0x40c8,0x40e8,0x4088
.long 0x40b0,0x40d0,0x40f0,0x4090
.long 0x40b8,0x40d8,0x40f8,0x4098
.long 0x42e0,0x4280,0x42a0,0x42c0
.long 0x42e8,0x4288,0x42a8,0x42c8
.long 0x42f0,0x4290,0x42b0,0x42d0
.long 0x42f8,0x4298,0x42b8,0x42d8
.long 0x4340,0x4320,0x4300,0x4360
.long 0x4348,0x4328,0x4308,0x4368
.long 0x4350,0x4330,0x4310,0x4370
.long 0x4358,0x4338,0x4318,0x4378
.long 0x43c0,0x43a0,0x4380,0x43e0
.long 0x43c8,0x43a8,0x4388,0x43e8
.long 0x43d0,0x43b0,0x4390,0x43f0
.long 0x43d8,0x43b8,0x4398,0x43f8
.long 0x4420,0x4440,0x4460,0x4400
.long 0x4428,0x4448,0x4468,0x4408
.long 0x4430,0x4450,0x4470,0x4410
.long 0x4438,0x4458,0x4478,0x4418
.long 0x800,0x20800,0x20,0x0
.long 0x2800,0x22800,0x20,0x0
.long 0x4800,0x24800,0x20,0x0
.long 0x6800,0x26800,0x20,0x0
.long 0x8800,0x28800,0x20,0x0
.long 0xa800,0x2a800,0x20,0x0
.long 0xc800,0x2c800,0x20,0x0
.long 0xe800,0x2e800,0x20,0x0
.long 0x10800,0x30800,0x20,0x0
.long 0x12800,0x32800,0x20,0x0
.long 0x14800,0x34800,0x20,0x0
.long 0x16800,0x36800,0x20,0x0
.long 0x18800,0x40000000,0x20,0x0
.long 0x1a800,0x40000000,0x20,0x0
.long 0x1c800,0x40000000,0x20,0x0
.long 0x1e800,0x40000000,0x20,0x0
.long 0x810,0x20810,0x28,0x0
.long 0x2810,0x22810,0x28,0x0
.long 0x4810,0x24810,0x28,0x0
.long 0x6810,0x26810,0x28,0x0
.long 0x8810,0x28810,0x28,0x0
.long 0xa810,0x2a810,0x28,0x0
.long 0xc810,0x2c810,0x28,0x0
.long 0xe810,0x2e810,0x28,0x0
.long 0x10810,0x30810,0x28,0x0
.long 0x12810,0x32810,0x28,0x0
.long 0x14810,0x34810,0x28,0x0
.long 0x16810,0x36810,0x28,0x0
.long 0x18810,0x40000000,0x28,0x0
.long 0x1a810,0x40000000,0x28,0x0
.long 0x1c810,0x40000000,0x28,0x0
.long 0x1e810,0x40000000,0x28,0x0
.long 0x820,0x20820,0x30,0x0
.long 0x2820,0x22820,0x30,0x0
.long 0x4820,0x24820,0x30,0x0
.long 0x6820,0x26820,0x30,0x0
.long 0x8820,0x28820,0x30,0x0
.long 0xa820,0x2a820,0x30,0x0
.long 0xc820,0x2c820,0x30,0x0
.long 0xe820,0x2e820,0x30,0x0
.long 0x10820,0x30820,0x30,0x0
.long 0x12820,0x32820,0x30,0x0
.long 0x14820,0x34820,0x30,0x0
.long 0x16820,0x36820,0x30,0x0
.long 0x18820,0x40000000,0x30,0x0
.long 0x1a820,0x40000000,0x30,0x0
.long 0x1c820,0x40000000,0x30,0x0
.long 0x1e820,0x40000000,0x30,0x0
.long 0x830,0x20830,0x38,0x0
.long 0x2830,0x22830,0x38,0x0
.long 0x4830,0x24830,0x38,0x0
.long 0x6830,0x26830,0x38,0x0
.long 0x8830,0x28830,0x38,0x0
.long 0xa830,0x2a830,0x38,0x0
.long 0xc830,0x2c830,0x38,0x0
.long 0xe830,0x2e830,0x38,0x0
.long 0x10830,0x30830,0x38,0x0
.long 0x12830,0x32830,0x38,0x0
.long 0x14830,0x34830,0x38,0x0
.long 0x16830,0x36830,0x38,0x0
.long 0x18830,0x40000000,0x38,0x0
.long 0x1a830,0x40000000,0x38,0x0
.long 0x1c830,0x40000000,0x38,0x0
.long 0x1e830,0x40000000,0x38,0x0
.long 0x0,0x0,0x0,0x400
.long 0x10,0x10,0x10,0x480
.long 0x80,0x20,0x20,0x500
.long 0x90,0x30,0x30,0x580
.long 0x80000,0x40,0x40,0x400
.long 0x80040,0x50,0x50,0x480
.long 0x40000000,0x60,0x60,0x500
.long 0x40000000,0x70,0x70,0x580
.long 0x40000000,0xe00,0x380,0x400
.long 0x40000000,0xe10,0x390,0x480
.long 0x40000000,0xe20,0x3a0,0x500
.long 0x40000000,0xe30,0x3b0,0x580
.long 0x40000000,0xe40,0x3c0,0x400
.long 0x40000000,0xe50,0x3d0,0x480
.long 0x40000000,0xe60,0x3e0,0x500
.long 0x40000000,0xe70,0x3f0,0x580
.long 0x20,0x1c00,0x700,0x400
.long 0x30,0x1c10,0x710,0x480
.long 0xa0,0x1c20,0x720,0x500
.long 0xb0,0x1c30,0x730,0x580
.long 0x80010,0x1c40,0x740,0x400
.long 0x80050,0x1c50,0x750,0x480
.long 0x40000000,0x1c60,0x760,0x500
.long 0x40000000,0x1c70,0x770,0x580
.long 0x40000000,0x2a00,0xa80,0x400
.long 0x40000000,0x2a10,0xa90,0x480
.long 0x40000000,0x2a20,0xaa0,0x500
.long 0x40000000,0x2a30,0xab0,0x580
.long 0x40000000,0x2a40,0xac0,0x400
.long 0x40000000,0x2a50,0xad0,0x480
.long 0x40000000,0x2a60,0xae0,0x500
.long 0x40000000,0x2a70,0xaf0,0x580
.long 0x40,0x3800,0xe00,0x400
.long 0x50,0x3810,0xe10,0x480
.long 0xc0,0x3820,0xe20,0x500
.long 0xd0,0x3830,0xe30,0x580
.long 0x80020,0x3840,0xe40,0x400
.long 0x80060,0x3850,0xe50,0x480
.long 0x40000000,0x3860,0xe60,0x500
.long 0x40000000,0x3870,0xe70,0x580
.long 0x40000000,0x4600,0x1180,0x400
.long 0x40000000,0x4610,0x1190,0x480
.long 0x40000000,0x4620,0x11a0,0x500
.long 0x40000000,0x4630,0x11b0,0x580
.long 0x40000000,0x4640,0x11c0,0x400
.long 0x40000000,0x4650,0x11d0,0x480
.long 0x40000000,0x4660,0x11e0,0x500
.long 0x40000000,0x4670,0x11f0,0x580
.long 0x60,0x5400,0x1500,0x400
.long 0x70,0x5410,0x1510,0x480
.long 0xe0,0x5420,0x1520,0x500
.long 0xf0,0x5430,0x1530,0x580
.long 0x80030,0x5440,0x1540,0x400
.long 0x80070,0x5450,0x1550,0x480
.long 0x40000000,0x5460,0x1560,0x500
.long 0x40000000,0x5470,0x1570,0x580
.long 0x40000000,0x6200,0x1880,0x400
.long 0x40000000,0x6210,0x1890,0x480
.long 0x40000000,0x6220,0x18a0,0x500
.long 0x40000000,0x6230,0x18b0,0x580
.long 0x40000000,0x6240,0x18c0,0x400
.long 0x40000000,0x6250,0x18d0,0x480
.long 0x40000000,0x6260,0x18e0,0x500
.long 0x40000000,0x6270,0x18f0,0x580
.long 0xe040,0x0,0x0,0x27040
.long 0xe048,0x10,0x10,0x270c0
.long 0xe050,0x40000000,0x20,0x27048
.long 0xe058,0x40000000,0x30,0x270c8
.long 0xe0c0,0x40000000,0x40,0x27050
.long 0xe0c8,0x40000000,0x50,0x270d0
.long 0xe0d0,0x40000000,0x60,0x27058
.long 0xe0d8,0x40000000,0x70,0x270d8
.long 0xe140,0x40000000,0x100,0x27040
.long 0xe148,0x40000000,0x110,0x270c0
.long 0xe150,0x40000000,0x120,0x27048
.long 0xe158,0x40000000,0x130,0x270c8
.long 0xe1c0,0x40000000,0x140,0x27050
.long 0xe1c8,0x40000000,0x150,0x270d0
.long 0xe1d0,0x40000000,0x160,0x27058
.long 0xe1d8,0x40000000,0x170,0x270d8
.long 0xe440,0x20,0x200,0x27042
.long 0xe448,0x30,0x210,0x270c2
.long 0xe450,0x40000000,0x220,0x2704a
.long 0xe458,0x40000000,0x230,0x270ca
.long 0xe4c0,0x40000000,0x240,0x27052
.long 0xe4c8,0x40000000,0x250,0x270d2
.long 0xe4d0,0x40000000,0x260,0x2705a
.long 0xe4d8,0x40000000,0x270,0x270da
.long 0xe540,0x40000000,0x300,0x27042
.long 0xe548,0x40000000,0x310,0x270c2
.long 0xe550,0x40000000,0x320,0x2704a
.long 0xe558,0x40000000,0x330,0x270ca
.long 0xe5c0,0x40000000,0x340,0x27052
.long 0xe5c8,0x40000000,0x350,0x270d2
.long 0xe5d0,0x40000000,0x360,0x2705a
.long 0xe5d8,0x40000000,0x370,0x270da
.long 0x14040,0x40,0x400,0x27044
.long 0x14048,0x50,0x410,0x270c4
.long 0x14050,0x40000000,0x420,0x2704c
.long 0x14058,0x40000000,0x430,0x270cc
.long 0x140c0,0x40000000,0x440,0x27054
.long 0x140c8,0x40000000,0x450,0x270d4
.long 0x140d0,0x40000000,0x460,0x2705c
.long 0x140d8,0x40000000,0x470,0x270dc
.long 0x14140,0x40000000,0x500,0x27044
.long 0x14148,0x40000000,0x510,0x270c4
.long 0x14150,0x40000000,0x520,0x2704c
.long 0x14158,0x40000000,0x530,0x270cc
.long 0x141c0,0x40000000,0x540,0x27054
.long 0x141c8,0x40000000,0x550,0x270d4
.long 0x141d0,0x40000000,0x560,0x2705c
.long 0x141d8,0x40000000,0x570,0x270dc
.long 0x14440,0x60,0x600,0x27046
.long 0x14448,0x70,0x610,0x270c6
.long 0x14450,0x40000000,0x620,0x2704e
.long 0x14458,0x40000000,0x630,0x270ce
.long 0x144c0,0x40000000,0x640,0x27056
.long 0x144c8,0x40000000,0x650,0x270d6
.long 0x144d0,0x40000000,0x660,0x2705e
.long 0x144d8,0x40000000,0x670,0x270de
.long 0x14540,0x40000000,0x700,0x27046
.long 0x14548,0x40000000,0x710,0x270c6
.long 0x14550,0x40000000,0x720,0x2704e
.long 0x14558,0x40000000,0x730,0x270ce
.long 0x145c0,0x40000000,0x740,0x27056
.long 0x145c8,0x40000000,0x750,0x270d6
.long 0x145d0,0x40000000,0x760,0x2705e
.long 0x145d8,0x40000000,0x770,0x270de
.long 0x31000,0x32800,0x34000,0x35800
.long 0x31010,0x32810,0x34010,0x35810
.long 0x31020,0x32820,0x34020,0x35820
.long 0x31030,0x32830,0x34030,0x35830
.long 0x31040,0x32840,0x34040,0x35840
.long 0x31050,0x32850,0x34050,0x35850
.long 0x31060,0x32860,0x34060,0x35860
.long 0x31070,0x32870,0x34070,0x35870
.long 0x31380,0x32b80,0x34380,0x35b80
.long 0x31390,0x32b90,0x34390,0x35b90
.long 0x313a0,0x32ba0,0x343a0,0x35ba0
.long 0x313b0,0x32bb0,0x343b0,0x35bb0
.long 0x313c0,0x32bc0,0x343c0,0x35bc0
.long 0x313d0,0x32bd0,0x343d0,0x35bd0
.long 0x313e0,0x32be0,0x343e0,0x35be0
.long 0x313f0,0x32bf0,0x343f0,0x35bf0
.long 0x31720,0x32f20,0x34720,0x35f20
.long 0x31730,0x32f30,0x34730,0x35f30
.long 0x31700,0x32f00,0x34700,0x35f00
.long 0x31710,0x32f10,0x34710,0x35f10
.long 0x31760,0x32f60,0x34760,0x35f60
.long 0x31770,0x32f70,0x34770,0x35f70
.long 0x31740,0x32f40,0x34740,0x35f40
.long 0x31750,0x32f50,0x34750,0x35f50
.long 0x31aa0,0x332a0,0x34aa0,0x362a0
.long 0x31ab0,0x332b0,0x34ab0,0x362b0
.long 0x31a80,0x33280,0x34a80,0x36280
.long 0x31a90,0x33290,0x34a90,0x36290
.long 0x31ae0,0x332e0,0x34ae0,0x362e0
.long 0x31af0,0x332f0,0x34af0,0x362f0
.long 0x31ac0,0x332c0,0x34ac0,0x362c0
.long 0x31ad0,0x332d0,0x34ad0,0x362d0
.long 0x31e40,0x33640,0x34e40,0x36640
.long 0x31e50,0x33650,0x34e50,0x36650
.long 0x31e60,0x33660,0x34e60,0x36660
.long 0x31e70,0x33670,0x34e70,0x36670
.long 0x31e00,0x33600,0x34e00,0x36600
.long 0x31e10,0x33610,0x34e10,0x36610
.long 0x31e20,0x33620,0x34e20,0x36620
.long 0x31e30,0x33630,0x34e30,0x36630
.long 0x321c0,0x339c0,0x351c0,0x369c0
.long 0x321d0,0x339d0,0x351d0,0x369d0
.long 0x321e0,0x339e0,0x351e0,0x369e0
.long 0x321f0,0x339f0,0x351f0,0x369f0
.long 0x32180,0x33980,0x35180,0x36980
.long 0x32190,0x33990,0x35190,0x36990
.long 0x321a0,0x339a0,0x351a0,0x369a0
.long 0x321b0,0x339b0,0x351b0,0x369b0
.long 0x32560,0x33d60,0x35560,0x36d60
.long 0x32570,0x33d70,0x35570,0x36d70
.long 0x32540,0x33d40,0x35540,0x36d40
.long 0x32550,0x33d50,0x35550,0x36d50
.long 0x32520,0x33d20,0x35520,0x36d20
.long 0x32530,0x33d30,0x35530,0x36d30
.long 0x32500,0x33d00,0x35500,0x36d00
.long 0x32510,0x33d10,0x35510,0x36d10
.long 0x328e0,0x340e0,0x358e0,0x370e0
.long 0x328f0,0x340f0,0x358f0,0x370f0
.long 0x328c0,0x340c0,0x358c0,0x370c0
.long 0x328d0,0x340d0,0x358d0,0x370d0
.long 0x328a0,0x340a0,0x358a0,0x370a0
.long 0x328b0,0x340b0,0x358b0,0x370b0
.long 0x32880,0x34080,0x35880,0x37080
.long 0x32890,0x34090,0x35890,0x37090
.long 0x27000,0x80000,0x200,0x200
.long 0x27080,0x80040,0x210,0x210
.long 0x27000,0x40000000,0x220,0x220
.long 0x27080,0x40000000,0x230,0x230
.long 0x27000,0x40000000,0x240,0x240
.long 0x27080,0x40000000,0x250,0x250
.long 0x27000,0x40000000,0x260,0x260
.long 0x27080,0x40000000,0x270,0x270
.long 0x27000,0x40000000,0x280,0x280
.long 0x27080,0x40000000,0x290,0x290
.long 0x27000,0x40000000,0x2a0,0x2a0
.long 0x27080,0x40000000,0x2b0,0x2b0
.long 0x27000,0x40000000,0x2c0,0x2c0
.long 0x27080,0x40000000,0x2d0,0x2d0
.long 0x27000,0x40000000,0x2e0,0x2e0
.long 0x27080,0x40000000,0x2f0,0x2f0
.long 0x27010,0x80010,0x4200,0x4200
.long 0x27090,0x80050,0x4210,0x4210
.long 0x27010,0x40000000,0x4220,0x4220
.long 0x27090,0x40000000,0x4230,0x4230
.long 0x27010,0x40000000,0x4240,0x4240
.long 0x27090,0x40000000,0x4250,0x4250
.long 0x27010,0x40000000,0x4260,0x4260
.long 0x27090,0x40000000,0x4270,0x4270
.long 0x27010,0x40000000,0x4280,0x4280
.long 0x27090,0x40000000,0x4290,0x4290
.long 0x27010,0x40000000,0x42a0,0x42a0
.long 0x27090,0x40000000,0x42b0,0x42b0
.long 0x27010,0x40000000,0x42c0,0x42c0
.long 0x27090,0x40000000,0x42d0,0x42d0
.long 0x27010,0x40000000,0x42e0,0x42e0
.long 0x27090,0x40000000,0x42f0,0x42f0
.long 0x27020,0x80020,0x8200,0x40000000
.long 0x270a0,0x80060,0x8210,0x40000000
.long 0x27020,0x40000000,0x8220,0x40000000
.long 0x270a0,0x40000000,0x8230,0x40000000
.long 0x27020,0x40000000,0x8240,0x40000000
.long 0x270a0,0x40000000,0x8250,0x40000000
.long 0x27020,0x40000000,0x8260,0x40000000
.long 0x270a0,0x40000000,0x8270,0x40000000
.long 0x27020,0x40000000,0x8280,0x40000000
.long 0x270a0,0x40000000,0x8290,0x40000000
.long 0x27020,0x40000000,0x82a0,0x40000000
.long 0x270a0,0x40000000,0x82b0,0x40000000
.long 0x27020,0x40000000,0x82c0,0x40000000
.long 0x270a0,0x40000000,0x82d0,0x40000000
.long 0x27020,0x40000000,0x82e0,0x40000000
.long 0x270a0,0x40000000,0x82f0,0x40000000
.long 0x27030,0x80030,0xc200,0x40000000
.long 0x270b0,0x80070,0xc210,0x40000000
.long 0x27030,0x40000000,0xc220,0x40000000
.long 0x270b0,0x40000000,0xc230,0x40000000
.long 0x27030,0x40000000,0xc240,0x40000000
.long 0x270b0,0x40000000,0xc250,0x40000000
.long 0x27030,0x40000000,0xc260,0x40000000
.long 0x270b0,0x40000000,0xc270,0x40000000
.long 0x27030,0x40000000,0xc280,0x40000000
.long 0x270b0,0x40000000,0xc290,0x40000000
.long 0x27030,0x40000000,0xc2a0,0x40000000
.long 0x270b0,0x40000000,0xc2b0,0x40000000
.long 0x27030,0x40000000,0xc2c0,0x40000000
.long 0x270b0,0x40000000,0xc2d0,0x40000000
.long 0x27030,0x40000000,0xc2e0,0x40000000
.long 0x270b0,0x40000000,0xc2f0,0x40000000
.long 0x14000,0xe400,0x20800,0x40
.long 0x14010,0xe410,0x20810,0x3c0
.long 0x14020,0xe420,0x20820,0x740
.long 0x14030,0xe430,0x20830,0xac0
.long 0x14040,0xe440,0x20840,0xe40
.long 0x14050,0xe450,0x20850,0x11c0
.long 0x14060,0xe460,0x20860,0x1540
.long 0x14070,0xe470,0x20870,0x18c0
.long 0x14080,0xe480,0x20880,0x1c40
.long 0x14090,0xe490,0x20890,0x1fc0
.long 0x140a0,0xe4a0,0x208a0,0x2340
.long 0x140b0,0xe4b0,0x208b0,0x26c0
.long 0x140c0,0xe4c0,0x208c0,0x2a40
.long 0x140d0,0xe4d0,0x208d0,0x2dc0
.long 0x140e0,0xe4e0,0x208e0,0x3140
.long 0x140f0,0xe4f0,0x208f0,0x34c0
.long 0x14100,0xe500,0x20900,0x48
.long 0x14110,0xe510,0x20910,0x3c8
.long 0x14120,0xe520,0x20920,0x748
.long 0x14130,0xe530,0x20930,0xac8
.long 0x14140,0xe540,0x20940,0xe48
.long 0x14150,0xe550,0x20950,0x11c8
.long 0x14160,0xe560,0x20960,0x1548
.long 0x14170,0xe570,0x20970,0x18c8
.long 0x14180,0xe580,0x20980,0x1c48
.long 0x14190,0xe590,0x20990,0x1fc8
.long 0x141a0,0xe5a0,0x209a0,0x2348
.long 0x141b0,0xe5b0,0x209b0,0x26c8
.long 0x141c0,0xe5c0,0x209c0,0x2a48
.long 0x141d0,0xe5d0,0x209d0,0x2dc8
.long 0x141e0,0xe5e0,0x209e0,0x3148
.long 0x141f0,0xe5f0,0x209f0,0x34c8
.long 0x14200,0xe600,0x20a00,0x50
.long 0x14210,0xe610,0x20a10,0x3d0
.long 0x14220,0xe620,0x20a20,0x750
.long 0x14230,0xe630,0x20a30,0xad0
.long 0x14240,0xe640,0x20a40,0xe50
.long 0x14250,0xe650,0x20a50,0x11d0
.long 0x14260,0xe660,0x20a60,0x1550
.long 0x14270,0xe670,0x20a70,0x18d0
.long 0x14280,0xe680,0x20a80,0x1c50
.long 0x14290,0xe690,0x20a90,0x1fd0
.long 0x142a0,0xe6a0,0x20aa0,0x2350
.long 0x142b0,0xe6b0,0x20ab0,0x26d0
.long 0x142c0,0xe6c0,0x20ac0,0x2a50
.long 0x142d0,0xe6d0,0x20ad0,0x2dd0
.long 0x142e0,0xe6e0,0x20ae0,0x3150
.long 0x142f0,0xe6f0,0x20af0,0x34d0
.long 0x14300,0xe700,0x20b00,0x58
.long 0x14310,0xe710,0x20b10,0x3d8
.long 0x14320,0xe720,0x20b20,0x758
.long 0x14330,0xe730,0x20b30,0xad8
.long 0x14340,0xe740,0x20b40,0xe58
.long 0x14350,0xe750,0x20b50,0x11d8
.long 0x14360,0xe760,0x20b60,0x1558
.long 0x14370,0xe770,0x20b70,0x18d8
.long 0x14380,0xe780,0x20b80,0x1c58
.long 0x14390,0xe790,0x20b90,0x1fd8
.long 0x143a0,0xe7a0,0x20ba0,0x2358
.long 0x143b0,0xe7b0,0x20bb0,0x26d8
.long 0x143c0,0xe7c0,0x20bc0,0x2a58
.long 0x143d0,0xe7d0,0x20bd0,0x2dd8
.long 0x143e0,0xe7e0,0x20be0,0x3158
.long 0x143f0,0xe7f0,0x20bf0,0x34d8
.long 0x7040,0x7060,0x7000,0x7020
.long 0x7048,0x7068,0x7008,0x7028
.long 0x7050,0x7070,0x7010,0x7030
.long 0x7058,0x7078,0x7018,0x7038
.long 0x70c0,0x70e0,0x7080,0x70a0
.long 0x70c8,0x70e8,0x7088,0x70a8
.long 0x70d0,0x70f0,0x7090,0x70b0
.long 0x70d8,0x70f8,0x7098,0x70b8
.long 0x7160,0x7140,0x7120,0x7100
.long 0x7168,0x7148,0x7128,0x7108
.long 0x7170,0x7150,0x7130,0x7110
.long 0x7178,0x7158,0x7138,0x7118
.long 0x71e0,0x71c0,0x71a0,0x7180
.long 0x71e8,0x71c8,0x71a8,0x7188
.long 0x71f0,0x71d0,0x71b0,0x7190
.long 0x71f8,0x71d8,0x71b8,0x7198
.long 0x73a0,0x7380,0x73e0,0x73c0
.long 0x73a8,0x7388,0x73e8,0x73c8
.long 0x73b0,0x7390,0x73f0,0x73d0
.long 0x73b8,0x7398,0x73f8,0x73d8
.long 0x7440,0x7460,0x7400,0x7420
.long 0x7448,0x7468,0x7408,0x7428
.long 0x7450,0x7470,0x7410,0x7430
.long 0x7458,0x7478,0x7418,0x7438
.long 0x74c0,0x74e0,0x7480,0x74a0
.long 0x74c8,0x74e8,0x7488,0x74a8
.long 0x74d0,0x74f0,0x7490,0x74b0
.long 0x74d8,0x74f8,0x7498,0x74b8
.long 0x7560,0x7540,0x7520,0x7500
.long 0x7568,0x7548,0x7528,0x7508
.long 0x7570,0x7550,0x7530,0x7510
.long 0x7578,0x7558,0x7538,0x7518
.long 0x7720,0x7700,0x7760,0x7740
.long 0x7728,0x7708,0x7768,0x7748
.long 0x7730,0x7710,0x7770,0x7750
.long 0x7738,0x7718,0x7778,0x7758
.long 0x77a0,0x7780,0x77e0,0x77c0
.long 0x77a8,0x7788,0x77e8,0x77c8
.long 0x77b0,0x7790,0x77f0,0x77d0
.long 0x77b8,0x7798,0x77f8,0x77d8
.long 0x7840,0x7860,0x7800,0x7820
.long 0x7848,0x7868,0x7808,0x7828
.long 0x7850,0x7870,0x7810,0x7830
.long 0x7858,0x7878,0x7818,0x7838
.long 0x78c0,0x78e0,0x7880,0x78a0
.long 0x78c8,0x78e8,0x7888,0x78a8
.long 0x78d0,0x78f0,0x7890,0x78b0
.long 0x78d8,0x78f8,0x7898,0x78b8
.long 0x7a80,0x7aa0,0x7ac0,0x7ae0
.long 0x7a88,0x7aa8,0x7ac8,0x7ae8
.long 0x7a90,0x7ab0,0x7ad0,0x7af0
.long 0x7a98,0x7ab8,0x7ad8,0x7af8
.long 0x7b20,0x7b00,0x7b60,0x7b40
.long 0x7b28,0x7b08,0x7b68,0x7b48
.long 0x7b30,0x7b10,0x7b70,0x7b50
.long 0x7b38,0x7b18,0x7b78,0x7b58
.long 0x7ba0,0x7b80,0x7be0,0x7bc0
.long 0x7ba8,0x7b88,0x7be8,0x7bc8
.long 0x7bb0,0x7b90,0x7bf0,0x7bd0
.long 0x7bb8,0x7b98,0x7bf8,0x7bd8
.long 0x7c40,0x7c60,0x7c00,0x7c20
.long 0x7c48,0x7c68,0x7c08,0x7c28
.long 0x7c50,0x7c70,0x7c10,0x7c30
.long 0x7c58,0x7c78,0x7c18,0x7c38
.long 0x1000,0x21000,0x40,0x0
.long 0x3000,0x23000,0x40,0x0
.long 0x5000,0x25000,0x40,0x0
.long 0x7000,0x27000,0x40,0x0
.long 0x9000,0x29000,0x40,0x0
.long 0xb000,0x2b000,0x40,0x0
.long 0xd000,0x2d000,0x40,0x0
.long 0xf000,0x2f000,0x40,0x0
.long 0x11000,0x31000,0x40,0x0
.long 0x13000,0x33000,0x40,0x0
.long 0x15000,0x35000,0x40,0x0
.long 0x17000,0x37000,0x40,0x0
.long 0x19000,0x40000000,0x40,0x0
.long 0x1b000,0x40000000,0x40,0x0
.long 0x1d000,0x40000000,0x40,0x0
.long 0x1f000,0x40000000,0x40,0x0
.long 0x1010,0x21010,0x48,0x0
.long 0x3010,0x23010,0x48,0x0
.long 0x5010,0x25010,0x48,0x0
.long 0x7010,0x27010,0x48,0x0
.long 0x9010,0x29010,0x48,0x0
.long 0xb010,0x2b010,0x48,0x0
.long 0xd010,0x2d010,0x48,0x0
.long 0xf010,0x2f010,0x48,0x0
.long 0x11010,0x31010,0x48,0x0
.long 0x13010,0x33010,0x48,0x0
.long 0x15010,0x35010,0x48,0x0
.long 0x17010,0x37010,0x48,0x0
.long 0x19010,0x40000000,0x48,0x0
.long 0x1b010,0x40000000,0x48,0x0
.long 0x1d010,0x40000000,0x48,0x0
.long 0x1f010,0x40000000,0x48,0x0
.long 0x1020,0x21020,0x50,0x0
.long 0x3020,0x23020,0x50,0x0
.long 0x5020,0x25020,0x50,0x0
.long 0x7020,0x27020,0x50,0x0
.long 0x9020,0x29020,0x50,0x0
.long 0xb020,0x2b020,0x50,0x0
.long 0xd020,0x2d020,0x50,0x0
.long 0xf020,0x2f020,0x50,0x0
.long 0x11020,0x31020,0x50,0x0
.long 0x13020,0x33020,0x50,0x0
.long 0x15020,0x35020,0x50,0x0
.long 0x17020,0x37020,0x50,0x0
.long 0x19020,0x40000000,0x50,0x0
.long 0x1b020,0x40000000,0x50,0x0
.long 0x1d020,0x40000000,0x50,0x0
.long 0x1f020,0x40000000,0x50,0x0
.long 0x1030,0x21030,0x58,0x0
.long 0x3030,0x23030,0x58,0x0
.long 0x5030,0x25030,0x58,0x0
.long 0x7030,0x27030,0x58,0x0
.long 0x9030,0x29030,0x58,0x0
.long 0xb030,0x2b030,0x58,0x0
.long 0xd030,0x2d030,0x58,0x0
.long 0xf030,0x2f030,0x58,0x0
.long 0x11030,0x31030,0x58,0x0
.long 0x13030,0x33030,0x58,0x0
.long 0x15030,0x35030,0x58,0x0
.long 0x17030,0x37030,0x58,0x0
.long 0x19030,0x40000000,0x58,0x0
.long 0x1b030,0x40000000,0x58,0x0
.long 0x1d030,0x40000000,0x58,0x0
.long 0x1f030,0x40000000,0x58,0x0
.long 0x0,0x0,0x0,0x600
.long 0x10,0x10,0x10,0x680
.long 0x80,0x20,0x20,0x700
.long 0x90,0x30,0x30,0x780
.long 0x80000,0x40,0x40,0x600
.long 0x80040,0x50,0x50,0x680
.long 0x40000000,0x60,0x60,0x700
.long 0x40000000,0x70,0x70,0x780
.long 0x40000000,0xe00,0x380,0x600
.long 0x40000000,0xe10,0x390,0x680
.long 0x40000000,0xe20,0x3a0,0x700
.long 0x40000000,0xe30,0x3b0,0x780
.long 0x40000000,0xe40,0x3c0,0x600
.long 0x40000000,0xe50,0x3d0,0x680
.long 0x40000000,0xe60,0x3e0,0x700
.long 0x40000000,0xe70,0x3f0,0x780
.long 0x20,0x1c00,0x700,0x600
.long 0x30,0x1c10,0x710,0x680
.long 0xa0,0x1c20,0x720,0x700
.long 0xb0,0x1c30,0x730,0x780
.long 0x80010,0x1c40,0x740,0x600
.long 0x80050,0x1c50,0x750,0x680
.long 0x40000000,0x1c60,0x760,0x700
.long 0x40000000,0x1c70,0x770,0x780
.long 0x40000000,0x2a00,0xa80,0x600
.long 0x40000000,0x2a10,0xa90,0x680
.long 0x40000000,0x2a20,0xaa0,0x700
.long 0x40000000,0x2a30,0xab0,0x780
.long 0x40000000,0x2a40,0xac0,0x600
.long 0x40000000,0x2a50,0xad0,0x680
.long 0x40000000,0x2a60,0xae0,0x700
.long 0x40000000,0x2a70,0xaf0,0x780
.long 0x40,0x3800,0xe00,0x600
.long 0x50,0x3810,0xe10,0x680
.long 0xc0,0x3820,0xe20,0x700
.long 0xd0,0x3830,0xe30,0x780
.long 0x80020,0x3840,0xe40,0x600
.long 0x80060,0x3850,0xe50,0x680
.long 0x40000000,0x3860,0xe60,0x700
.long 0x40000000,0x3870,0xe70,0x780
.long 0x40000000,0x4600,0x1180,0x600
.long 0x40000000,0x4610,0x1190,0x680
.long 0x40000000,0x4620,0x11a0,0x700
.long 0x40000000,0x4630,0x11b0,0x780
.long 0x40000000,0x4640,0x11c0,0x600
.long 0x40000000,0x4650,0x11d0,0x680
.long 0x40000000,0x4660,0x11e0,0x700
.long 0x40000000,0x4670,0x11f0,0x780
.long 0x60,0x5400,0x1500,0x600
.long 0x70,0x5410,0x1510,0x680
.long 0xe0,0x5420,0x1520,0x700
.long 0xf0,0x5430,0x1530,0x780
.long 0x80030,0x5440,0x1540,0x600
.long 0x80070,0x5450,0x1550,0x680
.long 0x40000000,0x5460,0x1560,0x700
.long 0x40000000,0x5470,0x1570,0x780
.long 0x40000000,0x6200,0x1880,0x600
.long 0x40000000,0x6210,0x1890,0x680
.long 0x40000000,0x6220,0x18a0,0x700
.long 0x40000000,0x6230,0x18b0,0x780
.long 0x40000000,0x6240,0x18c0,0x600
.long 0x40000000,0x6250,0x18d0,0x680
.long 0x40000000,0x6260,0x18e0,0x700
.long 0x40000000,0x6270,0x18f0,0x780
.long 0xe060,0x0,0x0,0x27060
.long 0xe068,0x10,0x10,0x270e0
.long 0xe070,0x40000000,0x20,0x27068
.long 0xe078,0x40000000,0x30,0x270e8
.long 0xe0e0,0x40000000,0x40,0x27070
.long 0xe0e8,0x40000000,0x50,0x270f0
.long 0xe0f0,0x40000000,0x60,0x27078
.long 0xe0f8,0x40000000,0x70,0x270f8
.long 0xe160,0x40000000,0x100,0x27060
.long 0xe168,0x40000000,0x110,0x270e0
.long 0xe170,0x40000000,0x120,0x27068
.long 0xe178,0x40000000,0x130,0x270e8
.long 0xe1e0,0x40000000,0x140,0x27070
.long 0xe1e8,0x40000000,0x150,0x270f0
.long 0xe1f0,0x40000000,0x160,0x27078
.long 0xe1f8,0x40000000,0x170,0x270f8
.long 0xe460,0x20,0x200,0x27062
.long 0xe468,0x30,0x210,0x270e2
.long 0xe470,0x40000000,0x220,0x2706a
.long 0xe478,0x40000000,0x230,0x270ea
.long 0xe4e0,0x40000000,0x240,0x27072
.long 0xe4e8,0x40000000,0x250,0x270f2
.long 0xe4f0,0x40000000,0x260,0x2707a
.long 0xe4f8,0x40000000,0x270,0x270fa
.long 0xe560,0x40000000,0x300,0x27062
.long 0xe568,0x40000000,0x310,0x270e2
.long 0xe570,0x40000000,0x320,0x2706a
.long 0xe578,0x40000000,0x330,0x270ea
.long 0xe5e0,0x40000000,0x340,0x27072
.long 0xe5e8,0x40000000,0x350,0x270f2
.long 0xe5f0,0x40000000,0x360,0x2707a
.long 0xe5f8,0x40000000,0x370,0x270fa
.long 0x14060,0x40,0x400,0x27064
.long 0x14068,0x50,0x410,0x270e4
.long 0x14070,0x40000000,0x420,0x2706c
.long 0x14078,0x40000000,0x430,0x270ec
.long 0x140e0,0x40000000,0x440,0x27074
.long 0x140e8,0x40000000,0x450,0x270f4
.long 0x140f0,0x40000000,0x460,0x2707c
.long 0x140f8,0x40000000,0x470,0x270fc
.long 0x14160,0x40000000,0x500,0x27064
.long 0x14168,0x40000000,0x510,0x270e4
.long 0x14170,0x40000000,0x520,0x2706c
.long 0x14178,0x40000000,0x530,0x270ec
.long 0x141e0,0x40000000,0x540,0x27074
.long 0x141e8,0x40000000,0x550,0x270f4
.long 0x141f0,0x40000000,0x560,0x2707c
.long 0x141f8,0x40000000,0x570,0x270fc
.long 0x14460,0x60,0x600,0x27066
.long 0x14468,0x70,0x610,0x270e6
.long 0x14470,0x40000000,0x620,0x2706e
.long 0x14478,0x40000000,0x630,0x270ee
.long 0x144e0,0x40000000,0x640,0x27076
.long 0x144e8,0x40000000,0x650,0x270f6
.long 0x144f0,0x40000000,0x660,0x2707e
.long 0x144f8,0x40000000,0x670,0x270fe
.long 0x14560,0x40000000,0x700,0x27066
.long 0x14568,0x40000000,0x710,0x270e6
.long 0x14570,0x40000000,0x720,0x2706e
.long 0x14578,0x40000000,0x730,0x270ee
.long 0x145e0,0x40000000,0x740,0x27076
.long 0x145e8,0x40000000,0x750,0x270f6
.long 0x145f0,0x40000000,0x760,0x2707e
.long 0x145f8,0x40000000,0x770,0x270fe
.long 0x49800,0x4b000,0x4c800,0x4e000
.long 0x49810,0x4b010,0x4c810,0x4e010
.long 0x49820,0x4b020,0x4c820,0x4e020
.long 0x49830,0x4b030,0x4c830,0x4e030
.long 0x49840,0x4b040,0x4c840,0x4e040
.long 0x49850,0x4b050,0x4c850,0x4e050
.long 0x49860,0x4b060,0x4c860,0x4e060
.long 0x49870,0x4b070,0x4c870,0x4e070
.long 0x49b80,0x4b380,0x4cb80,0x4e380
.long 0x49b90,0x4b390,0x4cb90,0x4e390
.long 0x49ba0,0x4b3a0,0x4cba0,0x4e3a0
.long 0x49bb0,0x4b3b0,0x4cbb0,0x4e3b0
.long 0x49bc0,0x4b3c0,0x4cbc0,0x4e3c0
.long 0x49bd0,0x4b3d0,0x4cbd0,0x4e3d0
.long 0x49be0,0x4b3e0,0x4cbe0,0x4e3e0
.long 0x49bf0,0x4b3f0,0x4cbf0,0x4e3f0
.long 0x49f20,0x4b720,0x4cf20,0x4e720
.long 0x49f30,0x4b730,0x4cf30,0x4e730
.long 0x49f00,0x4b700,0x4cf00,0x4e700
.long 0x49f10,0x4b710,0x4cf10,0x4e710
.long 0x49f60,0x4b760,0x4cf60,0x4e760
.long 0x49f70,0x4b770,0x4cf70,0x4e770
.long 0x49f40,0x4b740,0x4cf40,0x4e740
.long 0x49f50,0x4b750,0x4cf50,0x4e750
.long 0x4a2a0,0x4baa0,0x4d2a0,0x4eaa0
.long 0x4a2b0,0x4bab0,0x4d2b0,0x4eab0
.long 0x4a280,0x4ba80,0x4d280,0x4ea80
.long 0x4a290,0x4ba90,0x4d290,0x4ea90
.long 0x4a2e0,0x4bae0,0x4d2e0,0x4eae0
.long 0x4a2f0,0x4baf0,0x4d2f0,0x4eaf0
.long 0x4a2c0,0x4bac0,0x4d2c0,0x4eac0
.long 0x4a2d0,0x4bad0,0x4d2d0,0x4ead0
.long 0x4a640,0x4be40,0x4d640,0x4ee40
.long 0x4a650,0x4be50,0x4d650,0x4ee50
.long 0x4a660,0x4be60,0x4d660,0x4ee60
.long 0x4a670,0x4be70,0x4d670,0x4ee70
.long 0x4a600,0x4be00,0x4d600,0x4ee00
.long 0x4a610,0x4be10,0x4d610,0x4ee10
.long 0x4a620,0x4be20,0x4d620,0x4ee20
.long 0x4a630,0x4be30,0x4d630,0x4ee30
.long 0x4a9c0,0x4c1c0,0x4d9c0,0x4f1c0
.long 0x4a9d0,0x4c1d0,0x4d9d0,0x4f1d0
.long 0x4a9e0,0x4c1e0,0x4d9e0,0x4f1e0
.long 0x4a9f0,0x4c1f0,0x4d9f0,0x4f1f0
.long 0x4a980,0x4c180,0x4d980,0x4f180
.long 0x4a990,0x4c190,0x4d990,0x4f190
.long 0x4a9a0,0x4c1a0,0x4d9a0,0x4f1a0
.long 0x4a9b0,0x4c1b0,0x4d9b0,0x4f1b0
.long 0x4ad60,0x4c560,0x4dd60,0x4f560
.long 0x4ad70,0x4c570,0x4dd70,0x4f570
.long 0x4ad40,0x4c540,0x4dd40,0x4f540
.long 0x4ad50,0x4c550,0x4dd50,0x4f550
.long 0x4ad20,0x4c520,0x4dd20,0x4f520
.long 0x4ad30,0x4c530,0x4dd30,0x4f530
.long 0x4ad00,0x4c500,0x4dd00,0x4f500
.long 0x4ad10,0x4c510,0x4dd10,0x4f510
.long 0x4b0e0,0x4c8e0,0x4e0e0,0x4f8e0
.long 0x4b0f0,0x4c8f0,0x4e0f0,0x4f8f0
.long 0x4b0c0,0x4c8c0,0x4e0c0,0x4f8c0
.long 0x4b0d0,0x4c8d0,0x4e0d0,0x4f8d0
.long 0x4b0a0,0x4c8a0,0x4e0a0,0x4f8a0
.long 0x4b0b0,0x4c8b0,0x4e0b0,0x4f8b0
.long 0x4b080,0x4c880,0x4e080,0x4f880
.long 0x4b090,0x4c890,0x4e090,0x4f890
.long 0x27000,0x80000,0x300,0x300
.long 0x27080,0x80040,0x310,0x310
.long 0x27000,0x40000000,0x320,0x320
.long 0x27080,0x40000000,0x330,0x330
.long 0x27000,0x40000000,0x340,0x340
.long 0x27080,0x40000000,0x350,0x350
.long 0x27000,0x40000000,0x360,0x360
.long 0x27080,0x40000000,0x370,0x370
.long 0x27000,0x40000000,0x380,0x380
.long 0x27080,0x40000000,0x390,0x390
.long 0x27000,0x40000000,0x3a0,0x3a0
.long 0x27080,0x40000000,0x3b0,0x3b0
.long 0x27000,0x40000000,0x3c0,0x3c0
.long 0x27080,0x40000000,0x3d0,0x3d0
.long 0x27000,0x40000000,0x3e0,0x3e0
.long 0x27080,0x40000000,0x3f0,0x3f0
.long 0x27010,0x80010,0x4300,0x4300
.long 0x27090,0x80050,0x4310,0x4310
.long 0x27010,0x40000000,0x4320,0x4320
.long 0x27090,0x40000000,0x4330,0x4330
.long 0x27010,0x40000000,0x4340,0x4340
.long 0x27090,0x40000000,0x4350,0x4350
.long 0x27010,0x40000000,0x4360,0x4360
.long 0x27090,0x40000000,0x4370,0x4370
.long 0x27010,0x40000000,0x4380,0x4380
.long 0x27090,0x40000000,0x4390,0x4390
.long 0x27010,0x40000000,0x43a0,0x43a0
.long 0x27090,0x40000000,0x43b0,0x43b0
.long 0x27010,0x40000000,0x43c0,0x43c0
.long 0x27090,0x40000000,0x43d0,0x43d0
.long 0x27010,0x40000000,0x43e0,0x43e0
.long 0x27090,0x40000000,0x43f0,0x43f0
.long 0x27020,0x80020,0x8300,0x40000000
.long 0x270a0,0x80060,0x8310,0x40000000
.long 0x27020,0x40000000,0x8320,0x40000000
.long 0x270a0,0x40000000,0x8330,0x40000000
.long 0x27020,0x40000000,0x8340,0x40000000
.long 0x270a0,0x40000000,0x8350,0x40000000
.long 0x27020,0x40000000,0x8360,0x40000000
.long 0x270a0,0x40000000,0x8370,0x40000000
.long 0x27020,0x40000000,0x8380,0x40000000
.long 0x270a0,0x40000000,0x8390,0x40000000
.long 0x27020,0x40000000,0x83a0,0x40000000
.long 0x270a0,0x40000000,0x83b0,0x40000000
.long 0x27020,0x40000000,0x83c0,0x40000000
.long 0x270a0,0x40000000,0x83d0,0x40000000
.long 0x27020,0x40000000,0x83e0,0x40000000
.long 0x270a0,0x40000000,0x83f0,0x40000000
.long 0x27030,0x80030,0xc300,0x40000000
.long 0x270b0,0x80070,0xc310,0x40000000
.long 0x27030,0x40000000,0xc320,0x40000000
.long 0x270b0,0x40000000,0xc330,0x40000000
.long 0x27030,0x40000000,0xc340,0x40000000
.long 0x270b0,0x40000000,0xc350,0x40000000
.long 0x27030,0x40000000,0xc360,0x40000000
.long 0x270b0,0x40000000,0xc370,0x40000000
.long 0x27030,0x40000000,0xc380,0x40000000
.long 0x270b0,0x40000000,0xc390,0x40000000
.long 0x27030,0x40000000,0xc3a0,0x40000000
.long 0x270b0,0x40000000,0xc3b0,0x40000000
.long 0x27030,0x40000000,0xc3c0,0x40000000
.long 0x270b0,0x40000000,0xc3d0,0x40000000
.long 0x27030,0x40000000,0xc3e0,0x40000000
.long 0x270b0,0x40000000,0xc3f0,0x40000000
.long 0x1a000,0x14400,0xe800,0x60
.long 0x1a010,0x14410,0xe810,0x3e0
.long 0x1a020,0x14420,0xe820,0x760
.long 0x1a030,0x14430,0xe830,0xae0
.long 0x1a040,0x14440,0xe840,0xe60
.long 0x1a050,0x14450,0xe850,0x11e0
.long 0x1a060,0x14460,0xe860,0x1560
.long 0x1a070,0x14470,0xe870,0x18e0
.long 0x1a080,0x14480,0xe880,0x1c60
.long 0x1a090,0x14490,0xe890,0x1fe0
.long 0x1a0a0,0x144a0,0xe8a0,0x2360
.long 0x1a0b0,0x144b0,0xe8b0,0x26e0
.long 0x1a0c0,0x144c0,0xe8c0,0x2a60
.long 0x1a0d0,0x144d0,0xe8d0,0x2de0
.long 0x1a0e0,0x144e0,0xe8e0,0x3160
.long 0x1a0f0,0x144f0,0xe8f0,0x34e0
.long 0x1a100,0x14500,0xe900,0x68
.long 0x1a110,0x14510,0xe910,0x3e8
.long 0x1a120,0x14520,0xe920,0x768
.long 0x1a130,0x14530,0xe930,0xae8
.long 0x1a140,0x14540,0xe940,0xe68
.long 0x1a150,0x14550,0xe950,0x11e8
.long 0x1a160,0x14560,0xe960,0x1568
.long 0x1a170,0x14570,0xe970,0x18e8
.long 0x1a180,0x14580,0xe980,0x1c68
.long 0x1a190,0x14590,0xe990,0x1fe8
.long 0x1a1a0,0x145a0,0xe9a0,0x2368
.long 0x1a1b0,0x145b0,0xe9b0,0x26e8
.long 0x1a1c0,0x145c0,0xe9c0,0x2a68
.long 0x1a1d0,0x145d0,0xe9d0,0x2de8
.long 0x1a1e0,0x145e0,0xe9e0,0x3168
.long 0x1a1f0,0x145f0,0xe9f0,0x34e8
.long 0x1a200,0x14600,0xea00,0x70
.long 0x1a210,0x14610,0xea10,0x3f0
.long 0x1a220,0x14620,0xea20,0x770
.long 0x1a230,0x14630,0xea30,0xaf0
.long 0x1a240,0x14640,0xea40,0xe70
.long 0x1a250,0x14650,0xea50,0x11f0
.long 0x1a260,0x14660,0xea60,0x1570
.long 0x1a270,0x14670,0xea70,0x18f0
.long 0x1a280,0x14680,0xea80,0x1c70
.long 0x1a290,0x14690,0xea90,0x1ff0
.long 0x1a2a0,0x146a0,0xeaa0,0x2370
.long 0x1a2b0,0x146b0,0xeab0,0x26f0
.long 0x1a2c0,0x146c0,0xeac0,0x2a70
.long 0x1a2d0,0x146d0,0xead0,0x2df0
.long 0x1a2e0,0x146e0,0xeae0,0x3170
.long 0x1a2f0,0x146f0,0xeaf0,0x34f0
.long 0x1a300,0x14700,0xeb00,0x78
.long 0x1a310,0x14710,0xeb10,0x3f8
.long 0x1a320,0x14720,0xeb20,0x778
.long 0x1a330,0x14730,0xeb30,0xaf8
.long 0x1a340,0x14740,0xeb40,0xe78
.long 0x1a350,0x14750,0xeb50,0x11f8
.long 0x1a360,0x14760,0xeb60,0x1578
.long 0x1a370,0x14770,0xeb70,0x18f8
.long 0x1a380,0x14780,0xeb80,0x1c78
.long 0x1a390,0x14790,0xeb90,0x1ff8
.long 0x1a3a0,0x147a0,0xeba0,0x2378
.long 0x1a3b0,0x147b0,0xebb0,0x26f8
.long 0x1a3c0,0x147c0,0xebc0,0x2a78
.long 0x1a3d0,0x147d0,0xebd0,0x2df8
.long 0x1a3e0,0x147e0,0xebe0,0x3178
.long 0x1a3f0,0x147f0,0xebf0,0x34f8
.long 0xa860,0xa800,0xa820,0xa840
.long 0xa868,0xa808,0xa828,0xa848
.long 0xa870,0xa810,0xa830,0xa850
.long 0xa878,0xa818,0xa838,0xa858
.long 0xa8e0,0xa880,0xa8a0,0xa8c0
.long 0xa8e8,0xa888,0xa8a8,0xa8c8
.long 0xa8f0,0xa890,0xa8b0,0xa8d0
.long 0xa8f8,0xa898,0xa8b8,0xa8d8
.long 0xa940,0xa920,0xa900,0xa960
.long 0xa948,0xa928,0xa908,0xa968
.long 0xa950,0xa930,0xa910,0xa970
.long 0xa958,0xa938,0xa918,0xa978
.long 0xa9c0,0xa9a0,0xa980,0xa9e0
.long 0xa9c8,0xa9a8,0xa988,0xa9e8
.long 0xa9d0,0xa9b0,0xa990,0xa9f0
.long 0xa9d8,0xa9b8,0xa998,0xa9f8
.long 0xab80,0xabe0,0xabc0,0xaba0
.long 0xab88,0xabe8,0xabc8,0xaba8
.long 0xab90,0xabf0,0xabd0,0xabb0
.long 0xab98,0xabf8,0xabd8,0xabb8
.long 0xac60,0xac00,0xac20,0xac40
.long 0xac68,0xac08,0xac28,0xac48
.long 0xac70,0xac10,0xac30,0xac50
.long 0xac78,0xac18,0xac38,0xac58
.long 0xace0,0xac80,0xaca0,0xacc0
.long 0xace8,0xac88,0xaca8,0xacc8
.long 0xacf0,0xac90,0xacb0,0xacd0
.long 0xacf8,0xac98,0xacb8,0xacd8
.long 0xad40,0xad20,0xad00,0xad60
.long 0xad48,0xad28,0xad08,0xad68
.long 0xad50,0xad30,0xad10,0xad70
.long 0xad58,0xad38,0xad18,0xad78
.long 0xaf00,0xaf60,0xaf40,0xaf20
.long 0xaf08,0xaf68,0xaf48,0xaf28
.long 0xaf10,0xaf70,0xaf50,0xaf30
.long 0xaf18,0xaf78,0xaf58,0xaf38
.long 0xaf80,0xafe0,0xafc0,0xafa0
.long 0xaf88,0xafe8,0xafc8,0xafa8
.long 0xaf90,0xaff0,0xafd0,0xafb0
.long 0xaf98,0xaff8,0xafd8,0xafb8
.long 0xb060,0xb000,0xb020,0xb040
.long 0xb068,0xb008,0xb028,0xb048
.long 0xb070,0xb010,0xb030,0xb050
.long 0xb078,0xb018,0xb038,0xb058
.long 0xb0e0,0xb080,0xb0a0,0xb0c0
.long 0xb0e8,0xb088,0xb0a8,0xb0c8
.long 0xb0f0,0xb090,0xb0b0,0xb0d0
.long 0xb0f8,0xb098,0xb0b8,0xb0d8
.long 0xb2a0,0xb2c0,0xb2e0,0xb280
.long 0xb2a8,0xb2c8,0xb2e8,0xb288
.long 0xb2b0,0xb2d0,0xb2f0,0xb290
.long 0xb2b8,0xb2d8,0xb2f8,0xb298
.long 0xb300,0xb360,0xb340,0xb320
.long 0xb308,0xb368,0xb348,0xb328
.long 0xb310,0xb370,0xb350,0xb330
.long 0xb318,0xb378,0xb358,0xb338
.long 0xb380,0xb3e0,0xb3c0,0xb3a0
.long 0xb388,0xb3e8,0xb3c8,0xb3a8
.long 0xb390,0xb3f0,0xb3d0,0xb3b0
.long 0xb398,0xb3f8,0xb3d8,0xb3b8
.long 0xb460,0xb400,0xb420,0xb440
.long 0xb468,0xb408,0xb428,0xb448
.long 0xb470,0xb410,0xb430,0xb450
.long 0xb478,0xb418,0xb438,0xb458
.long 0x1800,0x21800,0x60,0x0
.long 0x3800,0x23800,0x60,0x0
.long 0x5800,0x25800,0x60,0x0
.long 0x7800,0x27800,0x60,0x0
.long 0x9800,0x29800,0x60,0x0
.long 0xb800,0x2b800,0x60,0x0
.long 0xd800,0x2d800,0x60,0x0
.long 0xf800,0x2f800,0x60,0x0
.long 0x11800,0x31800,0x60,0x0
.long 0x13800,0x33800,0x60,0x0
.long 0x15800,0x35800,0x60,0x0
.long 0x17800,0x37800,0x60,0x0
.long 0x19800,0x40000000,0x60,0x0
.long 0x1b800,0x40000000,0x60,0x0
.long 0x1d800,0x40000000,0x60,0x0
.long 0x1f800,0x40000000,0x60,0x0
.long 0x1810,0x21810,0x68,0x0
.long 0x3810,0x23810,0x68,0x0
.long 0x5810,0x25810,0x68,0x0
.long 0x7810,0x27810,0x68,0x0
.long 0x9810,0x29810,0x68,0x0
.long 0xb810,0x2b810,0x68,0x0
.long 0xd810,0x2d810,0x68,0x0
.long 0xf810,0x2f810,0x68,0x0
.long 0x11810,0x31810,0x68,0x0
.long 0x13810,0x33810,0x68,0x0
.long 0x15810,0x35810,0x68,0x0
.long 0x17810,0x37810,0x68,0x0
.long 0x19810,0x40000000,0x68,0x0
.long 0x1b810,0x40000000,0x68,0x0
.long 0x1d810,0x40000000,0x68,0x0
.long 0x1f810,0x40000000,0x68,0x0
.long 0x1820,0x21820,0x70,0x0
.long 0x3820,0x23820,0x70,0x0
.long 0x5820,0x25820,0x70,0x0
.long 0x7820,0x27820,0x70,0x0
.long 0x9820,0x29820,0x70,0x0
.long 0xb820,0x2b820,0x70,0x0
.long 0xd820,0x2d820,0x70,0x0
.long 0xf820,0x2f820,0x70,0x0
.long 0x11820,0x31820,0x70,0x0
.long 0x13820,0x33820,0x70,0x0
.long 0x15820,0x35820,0x70,0x0
.long 0x17820,0x37820,0x70,0x0
.long 0x19820,0x40000000,0x70,0x0
.long 0x1b820,0x40000000,0x70,0x0
.long 0x1d820,0x40000000,0x70,0x0
.long 0x1f820,0x40000000,0x70,0x0
.long 0x1830,0x21830,0x78,0x0
.long 0x3830,0x23830,0x78,0x0
.long 0x5830,0x25830,0x78,0x0
.long 0x7830,0x27830,0x78,0x0
.long 0x9830,0x29830,0x78,0x0
.long 0xb830,0x2b830,0x78,0x0
.long 0xd830,0x2d830,0x78,0x0
.long 0xf830,0x2f830,0x78,0x0
.long 0x11830,0x31830,0x78,0x0
.long 0x13830,0x33830,0x78,0x0
.long 0x15830,0x35830,0x78,0x0
.long 0x17830,0x37830,0x78,0x0
.long 0x19830,0x40000000,0x78,0x0
.long 0x1b830,0x40000000,0x78,0x0
.long 0x1d830,0x40000000,0x78,0x0
.long 0x1f830,0x40000000,0x78,0x0
L_tabend:
.section .rodata,"a"
.p2align 6
.amdhsa_kernel recurrent_scan__mha_block__moe_arch_mod__prompt_kernel
  .amdhsa_next_free_vgpr 512
  .amdhsa_next_free_sgpr 102
  .amdhsa_accum_offset 256
  .amdhsa_group_segment_fixed_size 0
  .amdhsa_kernarg_size 88
  .amdhsa_user_sgpr_count 2
  .amdhsa_user_sgpr_kernarg_segment_ptr 1
  .amdhsa_system_sgpr_workgroup_id_x 1
.end_amdhsa_kernel
```
